```python
import torch

def _softmax(x, axis=-1):
    return torch.softmax(x, dim=axis)

def _gelu(x):
    return torch.nn.functional.gelu(x, approximate='tanh')

def _silu(x):
    return torch.nn.functional.silu(x)

def _sigmoid(x):
    return torch.sigmoid(x)

def _layernorm(x, axis=-1, eps=1e-05):
    m = x.mean(dim=axis, keepdim=True)
    v = x.var(dim=axis, keepdim=True, unbiased=False)
    return (x - m) / torch.sqrt(v + eps)

def _scatter_add(tgt, idx, src, axis=0):
    return tgt.clone().index_add_(axis, idx, src)

def _segment_sum(src, seg, n):
    out = torch.zeros((n,) + src.shape[1:], dtype=src.dtype)
    return out.index_add_(0, seg, src)

def _pad(x, pw):
    flat = tuple((v for pair in reversed(pw) for v in pair))
    return torch.nn.functional.pad(x, flat)
kernel_name = 'standalone__autoregressive_conv_wavenet__speech'

def setup_inputs():

    _w = lambda a: (lambda t: t.to(torch.bfloat16) if t.is_floating_point() else t)(torch.as_tensor(a))
    B, T, D, K = (2, 16000, 144, 31)
    return {'x': _w((lambda *s: torch.randn(*s, dtype=torch.bfloat16) * 0.1)(B, T, D)), 'w': _w((lambda *s: torch.randn(*s, dtype=torch.bfloat16) * 0.1)(K, D, 2 * D)), 'w_o': _w((lambda *s: torch.randn(*s, dtype=torch.bfloat16) * 0.05)(D, D))}

def reference(x, w, w_o):
    B, T, D = x.shape
    K = w.shape[0]
    dil = 2
    pad = (K - 1) * dil
    xp = _pad(x, ((0, 0), (pad, 0), (0, 0)))
    h = torch.einsum('btc,cd->btd', xp[:, pad:pad + T, :], w[0])
    for i in range(1, K):
        off = pad - i * dil
        h = h + torch.einsum('btc,cd->btd', xp[:, off:off + T, :], w[i])
    f = h[..., :D].clone()
    g = h[..., D:].clone()
    z = torch.tanh(f) * _sigmoid(g)
    return z @ w_o
```

```asm
; @launch grid=(256,1,1) block=(256,1,1) lds=163840
.amdgcn_target "amdgcn-amd-amdhsa--gfx950"
.text
.macro M d, a, b
v_mfma_f32_16x16x32_bf16 \d, \a, \b, \d
.endm
.globl standalone__autoregressive_conv_wavenet__speech_kernel
.p2align 8
.type standalone__autoregressive_conv_wavenet__speech_kernel,@function
standalone__autoregressive_conv_wavenet__speech_kernel:
s_cmp_ge_u32 s2, 256
s_cbranch_scc1 L_end
s_mov_b32 s100, s2
s_and_b32 s3, s2, 3
s_lshr_b32 s4, s2, 3
s_lshl_b32 s5, s3, 5
s_sub_u32 s6, s3, 1
s_max_i32 s7, s6, 0
s_sub_u32 s5, s5, s7
s_cmp_lt_u32 s6, 2
s_cselect_b32 s6, 31, 32
s_cmp_ge_u32 s4, s6
s_cbranch_scc1 L_end
s_add_u32 s5, s5, s4
s_bitcmp1_b32 s2, 2
s_cselect_b32 s2, 126, 0
s_add_u32 s2, s2, s5
s_load_dwordx8 s[4:11], s[0:1], 0
s_load_dwordx4 s[56:59], s[0:1], 32
s_memrealtime s[54:55]
v_lshrrev_b32 v1, 6, v0
v_mov_b32 v19, v0
v_and_b32 v0, 63, v0
v_readfirstlane_b32 s28, v1
v_lshlrev_b32 v1, 4, v0
s_lshl_b32 s63, s2, 2
s_add_u32 s63, s63, s28
s_mul_i32 s3, s63, 10923
s_lshr_b32 s48, s3, 16
s_mul_i32 s3, s48, 6
s_sub_u32 s49, s63, s3
s_lshr_b32 s50, s48, 2
s_cmp_ge_u32 s50, 18
s_cselect_b32 s51, 1, 0
s_mul_i32 s3, s51, 18
s_sub_u32 s52, s50, s3
s_and_b32 s3, s48, 3
s_lshl_b32 s3, s3, 1
s_add_u32 s51, s51, s3
s_mul_i32 s40, s51, 331776
s_mul_i32 s3, s52, 4608
s_add_u32 s40, s40, s3
s_mul_i32 s3, s49, 48
s_add_u32 s40, s40, s3
s_add_u32 s41, s40, 82944
v_and_b32 v21, 30, v0
v_and_b32 v22, 1, v0
v_mul_u32_u24 v22, 144, v22
v_add_lshl_u32 v24, v21, v22, 1
v_lshrrev_b32 v20, 5, v0
v_mul_u32_u24 v21, 165888, v20
v_add_u32 v24, v24, v21
s_cmp_ge_u32 s2, 126
s_cselect_b32 s32, 1, 0
s_mul_i32 s3, s32, 126
s_sub_u32 s33, s2, s3
s_and_b32 s39, s33, 1
s_lshl_b32 s31, s33, 7
s_sub_u32 s31, s31, 128
s_and_b32 s29, s28, 1
s_lshr_b32 s30, s28, 1
s_mul_i32 s3, s32, 4608000
s_mov_b32 s22, 2571264
s_mov_b32 s23, 0x20000
s_mov_b32 s14, 4608000
s_mov_b32 s15, 0x20000
s_mov_b32 s46, 256
s_mov_b32 s47, 0x20000
s_mov_b32 s18, 14811136
s_mov_b32 s19, 0x20000
v_mov_b32 v30, 0
v_mov_b32 v26, 2130706432
v_mov_b32 v27, 2130706432
s_waitcnt lgkmcnt(0)
s_mov_b32 s20, s6
s_and_b32 s21, s7, 0xffff
s_add_u32 s12, s4, s3
s_addc_u32 s13, s5, 0
s_and_b32 s13, s13, 0xffff
s_mov_b32 s44, s56
s_and_b32 s45, s57, 0xffff
s_cmp_lg_u32 s63, 0
s_cbranch_scc1 L_noep
s_or_b32 s54, s54, 1
v_mov_b32 v29, s54
s_mov_b64 exec, 1
buffer_store_dword v29, v30, s[44:47], 0 offen sc1
s_mov_b64 exec, -1
L_noep:
s_cmp_ge_u32 s63, 864
s_cbranch_scc1 L_wo_ld
s_mov_b32 exec_lo, 0xffffff
s_mov_b32 exec_hi, 0xffffff
buffer_load_dword v32, v24, s[20:23], s40 offen offset:0
buffer_load_dword v40, v24, s[20:23], s41 offen offset:0
buffer_load_dword v33, v24, s[20:23], s40 offen offset:576
buffer_load_dword v41, v24, s[20:23], s41 offen offset:576
buffer_load_dword v34, v24, s[20:23], s40 offen offset:1152
buffer_load_dword v42, v24, s[20:23], s41 offen offset:1152
buffer_load_dword v35, v24, s[20:23], s40 offen offset:1728
buffer_load_dword v43, v24, s[20:23], s41 offen offset:1728
buffer_load_dword v36, v24, s[20:23], s40 offen offset:2304
buffer_load_dword v44, v24, s[20:23], s41 offen offset:2304
buffer_load_dword v37, v24, s[20:23], s40 offen offset:2880
buffer_load_dword v45, v24, s[20:23], s41 offen offset:2880
buffer_load_dword v38, v24, s[20:23], s40 offen offset:3456
buffer_load_dword v46, v24, s[20:23], s41 offen offset:3456
buffer_load_dword v39, v24, s[20:23], s40 offen offset:4032
buffer_load_dword v47, v24, s[20:23], s41 offen offset:4032
s_mov_b64 exec, -1
s_branch L_ld_done
L_wo_ld:
s_mov_b32 s20, s8
s_and_b32 s21, s9, 0xffff
s_mov_b32 s22, 41472
s_sub_u32 s48, s63, 864
s_lshr_b32 s49, s48, 2
s_sub_u32 s50, s48, 36
s_cmp_ge_i32 s50, 9
s_cselect_b32 s51, 1, 0
s_mul_i32 s3, s51, 9
s_sub_u32 s52, s50, s3
s_cmp_lt_u32 s48, 36
s_cselect_b32 s49, s49, s52
v_and_b32 v20, 15, v0
v_lshrrev_b32 v21, 4, v0
v_lshrrev_b32 v22, 2, v20
v_lshlrev_b32 v22, 4, v22
v_and_b32 v23, 3, v20
v_lshl_add_u32 v22, v23, 1, v22
s_lshr_b32 s3, s49, 1
s_lshl_b32 s3, s3, 6
s_and_b32 s52, s49, 1
s_lshl_b32 s52, s52, 3
s_add_u32 s3, s3, s52
v_lshlrev_b32 v23, 1, v20
s_cmp_eq_u32 s49, 8
s_cselect_b64 vcc, -1, 0
v_cndmask_b32 v22, v22, v23, vcc
v_add_u32 v22, s3, v22
v_mul_u32_u24 v23, 576, v21
v_add_u32 v24, v22, v23
s_and_b32 s3, s48, 3
s_lshr_b32 s52, s3, 1
s_mul_i32 s52, s52, 20736
s_and_b32 s3, s3, 1
s_mul_i32 s3, s3, 9216
s_add_u32 s52, s52, s3
s_mul_i32 s53, s51, 20736
s_add_u32 s53, s53, 18432
s_cmp_eq_u32 s51, 0
s_mov_b32 s3, -20736
s_cselect_b32 s54, 20736, s3
s_cmp_lt_u32 s48, 36
s_cselect_b32 s52, s52, s53
s_cselect_b32 s54, 2304, s54
buffer_load_ushort v32, v24, s[20:23], s52 offen
buffer_load_ushort v36, v24, s[20:23], s52 offen offset:288
s_add_u32 s52, s52, s54
buffer_load_ushort v33, v24, s[20:23], s52 offen
buffer_load_ushort v37, v24, s[20:23], s52 offen offset:288
s_add_u32 s52, s52, s54
s_cmp_lt_u32 s48, 36
s_cselect_b32 s52, s52, 0
s_cselect_b32 s54, s54, 0
buffer_load_ushort v34, v24, s[20:23], s52 offen
buffer_load_ushort v38, v24, s[20:23], s52 offen offset:288
s_add_u32 s52, s52, s54
buffer_load_ushort v35, v24, s[20:23], s52 offen
buffer_load_ushort v39, v24, s[20:23], s52 offen offset:288
L_ld_done:
s_add_u32 s101, s31, 128
s_mul_i32 s101, s101, 288
s_mul_i32 s3, s28, 9216
s_add_u32 s101, s101, s3
v_min_u32 v16, 19, v0
v_mul_u32_u24 v17, 13108, v16
v_lshrrev_b32 v17, 16, v17
v_mul_u32_u24 v18, 1664, v17
v_lshl_add_u32 v17, v16, 7, v18
v_add_u32 v17, s101, v17
s_lshr_b32 s3, s100, 3
s_lshl_b32 s35, s3, 7
s_sub_u32 s35, s31, s35
s_sub_u32 s35, s35, 64
s_mul_i32 s35, s35, 288
s_lshl_b32 s3, s3, 2
s_add_u32 s3, s3, s28
s_lshl_b32 s3, s3, 9
s_add_u32 s35, s35, s3
v_and_b32 v18, 3, v0
v_lshlrev_b32 v18, 7, v18
v_cmp_le_u32 vcc, 20, v0
v_add_u32 v18, s35, v18
s_nop 0
v_cndmask_b32 v17, v17, v18, vcc
buffer_load_dword v31, v17, s[12:15], 0 offen nt
s_mov_b32 s60, s58
s_mov_b32 s61, s59
s_mov_b32 s16, s58
s_and_b32 s17, s59, 0xffff
s_mov_b32 s38, 0xffff0000
s_mov_b32 s40, 0
s_cmp_ge_u32 s63, 864
s_cbranch_scc1 L_wo_st
s_mul_i32 s3, s28, 7168
s_add_u32 s3, s3, 73728
v_and_b32 v22, 31, v0
v_lshlrev_b32 v22, 5, v22
v_add_u32 v22, s3, v22
v_lshl_add_u32 v21, v20, 4, v22
v_mul_u32_u24 v20, 768, v20
v_add_u32 v22, v22, v20
v_add_u32 v23, s3, v1
s_and_b32 s53, s48, 1
s_cmp_ge_u32 s49, 3
s_cselect_b32 s55, 1, 0
s_mul_i32 s3, s55, 3
s_sub_u32 s3, s49, s3
s_mul_i32 s3, s3, 3
v_lshrrev_b32 v18, 4, v0
v_add_u32 v18, s3, v18
v_and_b32 v28, 15, v0
v_lshlrev_b32 v28, 4, v28
v_mov_b32 v16, s53
v_cmp_eq_u32 vcc, 8, v18
v_lshrrev_b32 v17, 2, v18
v_and_b32 v18, 3, v18
v_cndmask_b32 v17, v17, v16, vcc
v_cndmask_b32 v18, v18, 4, vcc
v_cmp_ne_u32 vcc, v17, v16
v_mul_u32_u24 v17, 746496, v17
v_add_u32 v29, 5, v18
v_cndmask_b32 v18, v18, v29, vcc
v_lshl_add_u32 v18, v18, 10, v28
v_cmp_gt_u32 vcc, 48, v0
v_add_u32 v17, v17, v18
s_lshr_b32 s3, s50, 2
s_mul_i32 s52, s3, 9216
s_and_b32 s3, s50, 3
s_lshl_b32 s3, s3, 8
s_add_u32 s52, s52, s3
v_cndmask_b32 v26, v26, v17, vcc
s_mul_i32 s3, s55, 2985984
s_add_u32 s52, s52, s3
s_bfe_u32 s55, s48, 0x10001
s_mul_i32 s3, s55, 82944
s_add_u32 s40, s52, s3
s_add_u32 s40, s40, 248832
s_mul_i32 s3, s55, 1492992
s_add_u32 s52, s52, s3
s_add_u32 s53, s52, 82944
s_add_u32 s54, s53, 82944
s_mov_b32 s36, 0x05040100
s_mov_b32 s37, 0x07060302
s_waitcnt vmcnt(15)
v_lshlrev_b32 v64, 16, v32
v_and_b32 v65, s38, v32
v_lshlrev_b32 v66, 16, v40
v_and_b32 v67, s38, v40
v_pk_add_f32 v[96:97], v[64:65], v[66:67]
s_waitcnt vmcnt(13)
v_lshlrev_b32 v64, 16, v33
v_and_b32 v65, s38, v33
v_lshlrev_b32 v66, 16, v41
v_and_b32 v67, s38, v41
v_pk_add_f32 v[98:99], v[64:65], v[66:67]
s_waitcnt vmcnt(11)
v_lshlrev_b32 v64, 16, v34
v_and_b32 v65, s38, v34
v_lshlrev_b32 v66, 16, v42
v_and_b32 v67, s38, v42
v_pk_add_f32 v[100:101], v[64:65], v[66:67]
s_waitcnt vmcnt(9)
v_lshlrev_b32 v64, 16, v35
v_and_b32 v65, s38, v35
v_lshlrev_b32 v66, 16, v43
v_and_b32 v67, s38, v43
v_pk_add_f32 v[102:103], v[64:65], v[66:67]
s_waitcnt vmcnt(7)
v_lshlrev_b32 v64, 16, v36
v_and_b32 v65, s38, v36
v_lshlrev_b32 v66, 16, v44
v_and_b32 v67, s38, v44
v_pk_add_f32 v[104:105], v[64:65], v[66:67]
s_waitcnt vmcnt(5)
v_lshlrev_b32 v64, 16, v37
v_and_b32 v65, s38, v37
v_lshlrev_b32 v66, 16, v45
v_and_b32 v67, s38, v45
v_pk_add_f32 v[106:107], v[64:65], v[66:67]
s_waitcnt vmcnt(3)
v_lshlrev_b32 v64, 16, v38
v_and_b32 v65, s38, v38
v_lshlrev_b32 v66, 16, v46
v_and_b32 v67, s38, v46
v_pk_add_f32 v[108:109], v[64:65], v[66:67]
s_waitcnt vmcnt(1)
v_lshlrev_b32 v64, 16, v39
v_and_b32 v65, s38, v39
v_lshlrev_b32 v66, 16, v47
v_and_b32 v67, s38, v47
v_pk_add_f32 v[110:111], v[64:65], v[66:67]
v_cvt_pk_bf16_f32 v112, v96, v98
v_cvt_pk_bf16_f32 v113, v100, v102
v_cvt_pk_bf16_f32 v114, v104, v106
v_cvt_pk_bf16_f32 v115, v108, v110
v_cvt_pk_bf16_f32 v116, v97, v99
v_cvt_pk_bf16_f32 v117, v101, v103
v_cvt_pk_bf16_f32 v118, v105, v107
v_cvt_pk_bf16_f32 v119, v109, v111
v_permlane32_swap_b32 v96, v97
v_permlane32_swap_b32 v98, v99
v_permlane32_swap_b32 v100, v101
v_permlane32_swap_b32 v102, v103
v_permlane32_swap_b32 v104, v105
v_permlane32_swap_b32 v106, v107
v_permlane32_swap_b32 v108, v109
v_permlane32_swap_b32 v110, v111
v_add_f32 v96, v96, v97
v_add_f32 v98, v98, v99
v_add_f32 v100, v100, v101
v_add_f32 v102, v102, v103
v_add_f32 v104, v104, v105
v_add_f32 v106, v106, v107
v_add_f32 v108, v108, v109
v_add_f32 v110, v110, v111
v_cvt_pk_bf16_f32 v120, v96, v98
v_cvt_pk_bf16_f32 v121, v100, v102
v_cvt_pk_bf16_f32 v122, v104, v106
v_cvt_pk_bf16_f32 v123, v108, v110
s_mov_b32 exec_lo, 0xffffff
s_mov_b32 exec_hi, 0xffffff
ds_write_b128 v21, v[120:123] offset:6144
ds_write_b128 v22, v[112:115] offset:0
ds_write_b128 v22, v[116:119] offset:16
s_mov_b64 exec, -1
ds_read_b128 v[124:127], v23 offset:6144
ds_read_b128 v[128:131], v23
ds_read_b128 v[132:135], v23 offset:768
v_perm_b32 v136, v33, v32, s36
v_perm_b32 v137, v35, v34, s36
v_perm_b32 v138, v37, v36, s36
v_perm_b32 v139, v39, v38, s36
v_perm_b32 v140, v33, v32, s37
v_perm_b32 v141, v35, v34, s37
v_perm_b32 v142, v37, v36, s37
v_perm_b32 v143, v39, v38, s37
v_perm_b32 v144, v41, v40, s36
v_perm_b32 v145, v43, v42, s36
v_perm_b32 v146, v45, v44, s36
v_perm_b32 v147, v47, v46, s36
v_perm_b32 v148, v41, v40, s37
v_perm_b32 v149, v43, v42, s37
v_perm_b32 v150, v45, v44, s37
v_perm_b32 v151, v47, v46, s37
s_waitcnt lgkmcnt(2)
buffer_store_dwordx4 v[124:127], v26, s[16:19], s52 offen sc1
s_waitcnt lgkmcnt(1)
buffer_store_dwordx4 v[128:131], v26, s[16:19], s53 offen sc1
s_waitcnt lgkmcnt(0)
buffer_store_dwordx4 v[132:135], v26, s[16:19], s54 offen sc1
v_permlane32_swap_b32 v32, v40
v_permlane32_swap_b32 v33, v41
v_permlane32_swap_b32 v34, v42
v_permlane32_swap_b32 v35, v43
v_permlane32_swap_b32 v36, v44
v_permlane32_swap_b32 v37, v45
v_permlane32_swap_b32 v38, v46
v_permlane32_swap_b32 v39, v47
s_nop 0
v_lshlrev_b32 v64, 16, v32
v_and_b32 v65, s38, v32
v_lshlrev_b32 v66, 16, v40
v_and_b32 v67, s38, v40
v_pk_add_f32 v[96:97], v[64:65], v[66:67]
v_lshlrev_b32 v64, 16, v33
v_and_b32 v65, s38, v33
v_lshlrev_b32 v66, 16, v41
v_and_b32 v67, s38, v41
v_pk_add_f32 v[98:99], v[64:65], v[66:67]
v_lshlrev_b32 v64, 16, v34
v_and_b32 v65, s38, v34
v_lshlrev_b32 v66, 16, v42
v_and_b32 v67, s38, v42
v_pk_add_f32 v[100:101], v[64:65], v[66:67]
v_lshlrev_b32 v64, 16, v35
v_and_b32 v65, s38, v35
v_lshlrev_b32 v66, 16, v43
v_and_b32 v67, s38, v43
v_pk_add_f32 v[102:103], v[64:65], v[66:67]
v_lshlrev_b32 v64, 16, v36
v_and_b32 v65, s38, v36
v_lshlrev_b32 v66, 16, v44
v_and_b32 v67, s38, v44
v_pk_add_f32 v[104:105], v[64:65], v[66:67]
v_lshlrev_b32 v64, 16, v37
v_and_b32 v65, s38, v37
v_lshlrev_b32 v66, 16, v45
v_and_b32 v67, s38, v45
v_pk_add_f32 v[106:107], v[64:65], v[66:67]
v_lshlrev_b32 v64, 16, v38
v_and_b32 v65, s38, v38
v_lshlrev_b32 v66, 16, v46
v_and_b32 v67, s38, v46
v_pk_add_f32 v[108:109], v[64:65], v[66:67]
v_lshlrev_b32 v64, 16, v39
v_and_b32 v65, s38, v39
v_lshlrev_b32 v66, 16, v47
v_and_b32 v67, s38, v47
v_pk_add_f32 v[110:111], v[64:65], v[66:67]
v_cvt_pk_bf16_f32 v112, v96, v98
v_cvt_pk_bf16_f32 v113, v100, v102
v_cvt_pk_bf16_f32 v114, v104, v106
v_cvt_pk_bf16_f32 v115, v108, v110
v_cvt_pk_bf16_f32 v116, v97, v99
v_cvt_pk_bf16_f32 v117, v101, v103
v_cvt_pk_bf16_f32 v118, v105, v107
v_cvt_pk_bf16_f32 v119, v109, v111
s_mov_b32 exec_lo, 0xffffff
s_mov_b32 exec_hi, 0xffffff
ds_write_b128 v22, v[112:115] offset:1536
ds_write_b128 v22, v[116:119] offset:1552
ds_write_b128 v22, v[136:139] offset:3072
ds_write_b128 v22, v[140:143] offset:3088
ds_write_b128 v22, v[144:147] offset:4608
ds_write_b128 v22, v[148:151] offset:4624
s_mov_b64 exec, -1
ds_read_b128 v[208:211], v23 offset:1536
ds_read_b128 v[212:215], v23 offset:3072
ds_read_b128 v[216:219], v23 offset:3840
ds_read_b128 v[220:223], v23 offset:2304
ds_read_b128 v[224:227], v23 offset:4608
ds_read_b128 v[228:231], v23 offset:5376
s_branch L_st_done
L_wo_st:
s_cmp_ge_u32 s48, 54
s_cbranch_scc1 L_st_done
s_waitcnt vmcnt(1)
v_lshl_or_b32 v32, v36, 16, v32
v_lshl_or_b32 v33, v37, 16, v33
v_lshl_or_b32 v34, v38, 16, v34
v_lshl_or_b32 v35, v39, 16, v35
s_cmp_ge_u32 s48, 36
s_cbranch_scc1 L_wo8_st
s_lshl_b32 s3, s48, 10
s_add_u32 s3, s3, 6291456
buffer_store_dwordx4 v[32:35], v1, s[16:19], s3 offen sc1
s_branch L_st_done
L_wo8_st:
v_lshlrev_b32 v25, 3, v0
s_lshl_b32 s3, s50, 9
s_add_u32 s3, s3, 6328320
buffer_store_dwordx2 v[32:33], v25, s[16:19], s3 offen sc1
L_st_done:
buffer_load_dword v29, v30, s[44:47], 0 offen sc1
s_mov_b32 s36, 0x4000
v_cmp_eq_u32 vcc, 0, v19
v_mov_b32 v28, 2130706432
s_lshl_b32 s4, s2, 7
s_add_u32 s4, s4, 6422528
v_cndmask_b32 v28, v28, 0, vcc
s_sub_u32 s3, s31, 56
s_mul_i32 s3, s3, 288
v_mul_u32_u24 v16, 1821, v19
v_lshlrev_b32 v17, 4, v19
v_add_u32 v17, s3, v17
s_movk_i32 s42, 1728
s_lshl_b32 s41, s28, 10
s_add_u32 s41, s41, 6144
s_cmp_lt_u32 s2, 120
s_cbranch_scc1 L_pub
L_dma:
v_lshrrev_b32 v18, 16, v16
s_mov_b32 m0, s41
v_mad_u32_u24 v18, v18, s42, v17
v_add_u32 v16, 466176, v16
buffer_load_dwordx4 v18, s[12:15], 0 offen nt lds
v_add_u32 v17, 4096, v17
s_add_u32 s41, s41, 4096
v_lshrrev_b32 v18, 16, v16
s_mov_b32 m0, s41
v_mad_u32_u24 v18, v18, s42, v17
v_add_u32 v16, 466176, v16
buffer_load_dwordx4 v18, s[12:15], 0 offen nt lds
v_add_u32 v17, 4096, v17
s_add_u32 s41, s41, 4096
v_lshrrev_b32 v18, 16, v16
s_mov_b32 m0, s41
v_mad_u32_u24 v18, v18, s42, v17
v_add_u32 v16, 466176, v16
buffer_load_dwordx4 v18, s[12:15], 0 offen nt lds
v_add_u32 v17, 4096, v17
s_add_u32 s41, s41, 4096
v_lshrrev_b32 v18, 16, v16
s_mov_b32 m0, s41
v_mad_u32_u24 v18, v18, s42, v17
v_add_u32 v16, 466176, v16
buffer_load_dwordx4 v18, s[12:15], 0 offen nt lds
v_add_u32 v17, 4096, v17
s_add_u32 s41, s41, 4096
v_lshrrev_b32 v18, 16, v16
s_mov_b32 m0, s41
v_mad_u32_u24 v18, v18, s42, v17
v_add_u32 v16, 466176, v16
buffer_load_dwordx4 v18, s[12:15], 0 offen nt lds
v_add_u32 v17, 4096, v17
s_add_u32 s41, s41, 4096
v_lshrrev_b32 v18, 16, v16
s_mov_b32 m0, s41
v_mad_u32_u24 v18, v18, s42, v17
v_add_u32 v16, 466176, v16
buffer_load_dwordx4 v18, s[12:15], 0 offen nt lds
v_add_u32 v17, 4096, v17
s_add_u32 s41, s41, 4096
s_cmp_lt_u32 s2, 120
s_cbranch_scc1 L_after
L_pub:
s_waitcnt vmcnt(0)
s_branch L_epchk
L_ep:
buffer_load_dword v29, v30, s[44:47], 0 offen sc1
s_waitcnt vmcnt(0)
L_epchk:
v_readfirstlane_b32 s62, v29
s_cmp_lg_u32 s62, 0
s_cbranch_scc1 L_epok
s_sub_u32 s36, s36, 1
s_cmp_lg_u32 s36, 0
s_cbranch_scc1 L_ep
L_epok:
s_waitcnt lgkmcnt(0)
s_barrier
buffer_store_dword v29, v28, s[16:19], s4 offen sc1
s_lshl_b32 s5, s2, 2
s_add_u32 s5, s5, 6459392
buffer_store_dword v29, v28, s[16:19], s5 offen sc1
s_cmp_lt_u32 s2, 120
s_cbranch_scc1 L_dma
L_after:
s_mul_i32 s6, s28, 3840
s_add_u32 s6, s6, 6422528
v_min_u32 v25, 29, v0
v_lshlrev_b32 v25, 7, v25
s_mov_b32 s5, 0x4000
buffer_load_dword v24, v25, s[16:19], s6 offen sc1
v_min_u32 v16, 51, v0
v_mul_u32_u24 v17, 5042, v16
v_lshrrev_b32 v17, 16, v17
v_mul_u32_u24 v17, 640, v17
v_lshl_add_u32 v17, v16, 7, v17
buffer_load_dword v31, v17, s[12:15], s101 offen offset:640 nt
s_getpc_b64 s[46:47]
L_pc:
s_lshr_b32 s3, s100, 3
s_lshl_b32 s3, s3, 2
s_add_u32 s3, s3, s28
s_lshl_b32 s3, s3, 9
v_and_b32 v20, 7, v0
v_lshlrev_b32 v20, 6, v20
v_add_u32 v20, s3, v20
v_min_u32 v22, L_codeend-L_pc-4, v20
global_load_dword v31, v22, s[46:47]
s_mov_b32 s24, s10
s_and_b32 s25, s11, 0xffff
s_mov_b32 s26, 9216000
s_mov_b32 s27, 0x20000
s_lshl_b32 s3, s39, 2
s_add_u32 s3, s3, s28
s_mul_i32 s34, s3, 746496
v_and_b32 v20, 15, v0
v_lshrrev_b32 v21, 4, v0
v_mul_u32_u24 v22, 288, v20
v_lshl_add_u32 v22, v21, 4, v22
s_mul_i32 s3, s30, 2304
s_sub_u32 s3, 6144, s3
v_add_u32 v22, s3, v22
s_mul_i32 s8, s29, 1152
s_sub_u32 s9, 1152, s8
s_mul_i32 s10, s29, 4608
s_sub_u32 s11, 4608, s10
s_add_u32 s3, s9, s10
v_add_u32 v2, s3, v22
s_add_u32 s3, s9, s11
v_add_u32 v3, s3, v22
s_add_u32 s3, s8, s10
v_add_u32 v4, s3, v22
s_add_u32 s3, s8, s11
v_add_u32 v5, s3, v22
v_lshrrev_b32 v21, 1, v21
v_mul_u32_u24 v21, 864, v21
v_sub_u32 v6, v2, v21
v_sub_u32 v7, v3, v21
v_sub_u32 v8, v4, v21
v_sub_u32 v9, v5, v21
s_lshr_b32 s37, s100, 3
s_lshl_b32 s37, s37, 2
s_add_u32 s37, s37, s28
s_lshl_b32 s37, s37, 6
s_add_u32 s37, s37, 4096
s_mul_i32 s8, s30, 24832
s_add_u32 s8, s8, 22528
s_mov_b32 s9, -112640
s_movk_i32 s10, 22528
s_mov_b32 s11, 45056
v_min_u32 v20, 251, v19
v_mul_u32_u24 v21, 1821, v20
v_lshrrev_b32 v21, 16, v21
v_mul_u32_u24 v22, 36, v21
v_sub_u32 v20, v20, v22
v_mul_u32_u24 v21, 6, v21
v_min_u32 v21, 33, v21
v_mul_u32_u24 v22, 576, v21
v_lshl_add_u32 v22, v20, 4, v22
v_add_u32 v10, 6144, v22
v_add_u32 v13, 73728, v22
v_add_u32 v12, 141312, v22
v_mul_u32_u24 v21, 1728, v21
s_sub_u32 s3, s31, 62
s_mul_i32 s3, s3, 288
v_add3_u32 v11, v22, v21, s3
s_lshl_b32 s7, s2, 2
s_add_u32 s7, s7, 6455296
s_mov_b32 s46, 6455296
s_mov_b32 s45, 6459392
s_waitcnt vmcnt(2)
s_branch L_poll1_c
L_poll1:
buffer_load_dword v24, v25, s[16:19], s6 offen sc1
s_waitcnt vmcnt(0)
L_poll1_c:
v_cmp_ne_u32 vcc, s62, v24
s_nop 1
s_cmp_eq_u64 vcc, 0
s_cbranch_scc1 L_poll1_ok
s_sleep 1
s_sub_u32 s5, s5, 1
s_cmp_lg_u32 s5, 0
s_cbranch_scc1 L_poll1
L_poll1_ok:
s_barrier
buffer_load_dwordx4 v[32:35], v1, s[16:19], s34 offen offset:0 sc1
buffer_load_dwordx4 v[36:39], v1, s[16:19], s34 offen offset:1024 sc1
buffer_load_dwordx4 v[40:43], v1, s[16:19], s34 offen offset:2048 sc1
buffer_load_dwordx4 v[44:47], v1, s[16:19], s34 offen offset:3072 sc1
s_add_u32 s34, s34, 4096
buffer_load_dwordx4 v[48:51], v1, s[16:19], s34 offen offset:0 sc1
buffer_load_dwordx4 v[52:55], v1, s[16:19], s34 offen offset:1024 sc1
buffer_load_dwordx4 v[56:59], v1, s[16:19], s34 offen offset:2048 sc1
buffer_load_dwordx4 v[60:63], v1, s[16:19], s34 offen offset:3072 sc1
s_add_u32 s34, s34, 4096
buffer_load_dwordx4 v[64:67], v1, s[16:19], s34 offen offset:0 sc1
s_add_u32 s34, s34, 1024
buffer_load_dwordx4 v[68:71], v1, s[16:19], s34 offen offset:0 sc1
buffer_load_dwordx4 v[72:75], v1, s[16:19], s34 offen offset:1024 sc1
buffer_load_dwordx4 v[76:79], v1, s[16:19], s34 offen offset:2048 sc1
buffer_load_dwordx4 v[80:83], v1, s[16:19], s34 offen offset:3072 sc1
s_add_u32 s34, s34, 4096
buffer_load_dwordx4 v[84:87], v1, s[16:19], s34 offen offset:0 sc1
ds_read_b128 a[160:163], v2 offset:2880
ds_read_b128 a[164:167], v3 offset:2880
ds_read_b128 a[168:171], v2 offset:12096
ds_read_b128 a[172:175], v3 offset:12096
ds_read_b128 a[176:179], v5 offset:12096
ds_read_b128 a[180:183], v4 offset:12096
ds_read_b128 a[184:187], v5 offset:2880
s_waitcnt lgkmcnt(0)
s_waitcnt vmcnt(9)
buffer_load_dwordx4 v[20:23], v1, s[16:19], s45 offen sc1
buffer_load_dwordx4 v[88:91], v1, s[16:19], s34 offen offset:1024 sc1
v_mfma_f32_16x16x32_bf16 a[80:83], v[32:35], a[160:163], 0
ds_read_b128 a[188:191], v4 offset:2880
v_mfma_f32_16x16x32_bf16 a[84:87], v[36:39], a[160:163], 0
buffer_load_dwordx4 v[92:95], v1, s[16:19], s34 offen offset:2048 sc1
v_add_u32 v24, 576, v11
v_mfma_f32_16x16x32_bf16 a[88:91], v[40:43], a[160:163], 0
buffer_load_dwordx4 v[96:99], v24, s[12:15], 0 offen
v_mfma_f32_16x16x32_bf16 a[92:95], v[44:47], a[160:163], 0
buffer_load_dwordx4 a[192:195], v1, s[16:19], s34 offen offset:3072 sc1
s_add_u32 s34, s34, 4096
v_mfma_f32_16x16x32_bf16 a[96:99], v[48:51], a[160:163], 0
v_mfma_f32_16x16x32_bf16 a[116:119], v[48:51], a[164:167], 0
ds_read_b128 a[160:163], v2 offset:2944
buffer_load_dwordx4 a[196:199], v1, s[16:19], s34 offen offset:0 sc1
v_mfma_f32_16x16x32_bf16 a[112:115], v[44:47], a[164:167], 0
s_add_u32 s34, s34, 1024
v_mfma_f32_16x16x32_bf16 a[108:111], v[40:43], a[164:167], 0
v_mfma_f32_16x16x32_bf16 a[104:107], v[36:39], a[164:167], 0
buffer_load_dwordx4 a[200:203], v1, s[16:19], s34 offen offset:0 sc1
v_add_u32 v24, 2880, v11
v_mfma_f32_16x16x32_bf16 a[100:103], v[32:35], a[164:167], 0
buffer_load_dwordx4 v[100:103], v24, s[12:15], 0 offen
v_mfma_f32_16x16x32_bf16 a[120:123], v[32:35], a[168:171], 0
ds_read_b128 a[164:167], v3 offset:2944
buffer_load_dwordx4 a[204:207], v1, s[16:19], s34 offen offset:1024 sc1
v_mfma_f32_16x16x32_bf16 a[124:127], v[36:39], a[168:171], 0
v_mfma_f32_16x16x32_bf16 a[128:131], v[40:43], a[168:171], 0
buffer_load_dwordx4 a[208:211], v1, s[16:19], s34 offen offset:2048 sc1
v_mfma_f32_16x16x32_bf16 a[132:135], v[44:47], a[168:171], 0
v_mfma_f32_16x16x32_bf16 a[136:139], v[48:51], a[168:171], 0
buffer_load_dwordx4 a[212:215], v1, s[16:19], s34 offen offset:3072 sc1
s_add_u32 s34, s34, 4096
v_mfma_f32_16x16x32_bf16 a[156:159], v[48:51], a[172:175], 0
ds_read_b128 a[168:171], v2 offset:12160
v_add_u32 v24, 5184, v11
v_mfma_f32_16x16x32_bf16 a[152:155], v[44:47], a[172:175], 0
buffer_load_dwordx4 a[216:219], v1, s[16:19], s34 offen offset:0 sc1
buffer_load_dwordx4 v[104:107], v24, s[12:15], 0 offen
v_mfma_f32_16x16x32_bf16 a[148:151], v[40:43], a[172:175], 0
v_mfma_f32_16x16x32_bf16 a[144:147], v[36:39], a[172:175], 0
buffer_load_dwordx4 a[220:223], v1, s[16:19], s34 offen offset:1024 sc1
v_mfma_f32_16x16x32_bf16 a[140:143], v[32:35], a[172:175], 0
s_waitcnt vmcnt(19)
M a[140:143],v[52:55],a[176:179]
ds_read_b128 a[172:175], v3 offset:12160
buffer_load_dwordx4 a[224:227], v1, s[16:19], s34 offen offset:2048 sc1
M a[144:147],v[56:59],a[176:179]
M a[148:151],v[60:63],a[176:179]
buffer_load_dwordx4 a[228:231], v1, s[16:19], s34 offen offset:3072 sc1
s_add_u32 s34, s34, 4096
M a[152:155],v[64:67],a[176:179]
v_add_u32 v24, 7488, v11
M a[132:135],v[64:67],a[180:183]
ds_read_b128 a[176:179], v5 offset:12160
buffer_load_dwordx4 a[232:235], v1, s[16:19], s34 offen offset:0 sc1
M a[128:131],v[60:63],a[180:183]
s_add_u32 s34, s34, 1024
buffer_load_dwordx4 v[108:111], v24, s[12:15], 0 offen
M a[124:127],v[56:59],a[180:183]
M a[120:123],v[52:55],a[180:183]
buffer_load_dwordx4 a[236:239], v1, s[16:19], s34 offen offset:0 sc1
M a[100:103],v[52:55],a[184:187]
ds_read_b128 a[180:183], v4 offset:12160
M a[104:107],v[56:59],a[184:187]
buffer_load_dwordx4 a[240:243], v1, s[16:19], s34 offen offset:1024 sc1
M a[108:111],v[60:63],a[184:187]
M a[112:115],v[64:67],a[184:187]
s_waitcnt lgkmcnt(5)
buffer_load_dwordx4 a[244:247], v1, s[16:19], s34 offen offset:2048 sc1
v_add_u32 v24, 9792, v11
M a[92:95],v[64:67],a[188:191]
ds_read_b128 a[184:187], v5 offset:2944
buffer_load_dwordx4 v[112:115], v24, s[12:15], 0 offen
M a[88:91],v[60:63],a[188:191]
buffer_load_dwordx4 a[248:251], v1, s[16:19], s34 offen offset:3072 sc1
s_add_u32 s34, s34, 4096
M a[84:87],v[56:59],a[188:191]
M a[80:83],v[52:55],a[188:191]
s_waitcnt vmcnt(23)
buffer_load_dwordx4 a[252:255], v1, s[16:19], s34 offen offset:0 sc1
ds_read_b128 v[124:127], v10 offset:0
M a[80:83],v[68:71],a[160:163]
ds_read_b128 a[188:191], v4 offset:2944
M a[84:87],v[72:75],a[160:163]
buffer_load_dwordx4 v[48:51], v1, s[16:19], s34 offen offset:1024 sc1
M a[88:91],v[76:79],a[160:163]
ds_read_b128 v[128:131], v10 offset:576
v_add_u32 v24, 12096, v11
M a[92:95],v[80:83],a[160:163]
buffer_load_dwordx4 v[44:47], v1, s[16:19], s34 offen offset:2048 sc1
buffer_load_dwordx4 v[116:119], v24, s[12:15], 0 offen
M a[96:99],v[84:87],a[160:163]
s_waitcnt lgkmcnt(7)
M a[116:119],v[84:87],a[164:167]
ds_read_b128 a[160:163], v2 offset:3008
buffer_load_dwordx4 v[40:43], v1, s[16:19], s34 offen offset:3072 sc1
M a[112:115],v[80:83],a[164:167]
s_add_u32 s34, s34, 4096
ds_read_b128 v[132:135], v10 offset:1152
M a[108:111],v[76:79],a[164:167]
M a[104:107],v[72:75],a[164:167]
buffer_load_dwordx4 v[36:39], v1, s[16:19], s34 offen offset:0 sc1
s_add_u32 s34, s34, 1024
M a[100:103],v[68:71],a[164:167]
ds_read_b128 v[136:139], v10 offset:1728
v_add_u32 v24, 14400, v11
M a[120:123],v[68:71],a[168:171]
ds_read_b128 a[164:167], v3 offset:3008
buffer_load_dwordx4 v[32:35], v1, s[16:19], s34 offen offset:0 sc1
M a[124:127],v[72:75],a[168:171]
s_waitcnt vmcnt(22)
v_xor_b32 v20, s62, v20
v_xor_b32 v21, s62, v21
M a[128:131],v[76:79],a[168:171]
v_xor_b32 v22, s62, v22
v_xor_b32 v23, s62, v23
M a[132:135],v[80:83],a[168:171]
v_or3_b32 v20, v20, v21, v22
v_or_b32 v20, v20, v23
M a[136:139],v[84:87],a[168:171]
s_waitcnt lgkmcnt(9)
buffer_load_dwordx4 v[64:67], v1, s[16:19], s34 offen offset:1024 sc1
v_cmp_ne_u32 s[4:5], 0, v20
M a[156:159],v[84:87],a[172:175]
ds_read_b128 a[168:171], v2 offset:12224
buffer_load_dwordx4 v[120:123], v24, s[12:15], 0 offen
M a[152:155],v[80:83],a[172:175]
s_and_b32 s5, s5, 0x7fffffff
buffer_load_dwordx4 v[60:63], v1, s[16:19], s34 offen offset:2048 sc1
M a[148:151],v[76:79],a[172:175]
s_cmp_lg_u64 s[4:5], 0
s_cbranch_scc1 L_sl1
L_sl1_ret:
M a[144:147],v[72:75],a[172:175]
buffer_load_dwordx4 v[56:59], v1, s[16:19], s34 offen offset:3072 sc1
s_add_u32 s34, s34, 4096
M a[140:143],v[68:71],a[172:175]
s_waitcnt vmcnt(28)
ds_read_b128 v[140:143], v10 offset:2304
M a[140:143],v[88:91],a[176:179]
ds_read_b128 a[172:175], v3 offset:12224
buffer_load_dwordx4 v[52:55], v1, s[16:19], s34 offen offset:0 sc1
M a[144:147],v[92:95],a[176:179]
M a[148:151],a[192:195],a[176:179]
buffer_load_dwordx4 v[84:87], v1, s[16:19], s34 offen offset:1024 sc1
ds_read_b128 v[144:147], v10 offset:2880
M a[152:155],a[196:199],a[176:179]
s_waitcnt lgkmcnt(11)
M a[132:135],a[196:199],a[180:183]
ds_read_b128 a[176:179], v5 offset:12224
buffer_load_dwordx4 v[80:83], v1, s[16:19], s34 offen offset:2048 sc1
M a[128:131],a[192:195],a[180:183]
M a[124:127],v[92:95],a[180:183]
buffer_load_dwordx4 v[76:79], v1, s[16:19], s34 offen offset:3072 sc1
s_add_u32 s34, s34, 4096
M a[120:123],v[88:91],a[180:183]
M a[100:103],v[88:91],a[184:187]
ds_read_b128 a[180:183], v4 offset:12224
buffer_load_dwordx4 v[72:75], v1, s[16:19], s34 offen offset:0 sc1
M a[104:107],v[92:95],a[184:187]
s_add_u32 s34, s34, 1024
M a[108:111],a[192:195],a[184:187]
M a[112:115],a[196:199],a[184:187]
s_waitcnt lgkmcnt(9)
buffer_load_dwordx4 v[68:71], v1, s[16:19], s34 offen offset:0 sc1
M a[92:95],a[196:199],a[188:191]
ds_read_b128 a[184:187], v5 offset:3008
M a[88:91],a[192:195],a[188:191]
buffer_load_dwordx4 a[196:199], v1, s[16:19], s34 offen offset:1024 sc1
M a[84:87],v[92:95],a[188:191]
M a[80:83],v[88:91],a[188:191]
s_waitcnt vmcnt(29)
buffer_load_dwordx4 a[192:195], v1, s[16:19], s34 offen offset:2048 sc1
s_waitcnt vmcnt(38)
v_lshlrev_b32 v168, 16, v96
M a[80:83],a[200:203],a[160:163]
ds_read_b128 a[188:191], v4 offset:3008
v_and_b32 v169, s38, v96
M a[84:87],a[204:207],a[160:163]
buffer_load_dwordx4 v[92:95], v1, s[16:19], s34 offen offset:3072 sc1
s_add_u32 s34, s34, 4096
M a[88:91],a[208:211],a[160:163]
v_lshlrev_b32 v170, 16, v97
v_and_b32 v171, s38, v97
M a[92:95],a[212:215],a[160:163]
buffer_load_dwordx4 v[88:91], v1, s[16:19], s34 offen offset:0 sc1
v_lshlrev_b32 v172, 16, v98
M a[96:99],a[216:219],a[160:163]
s_waitcnt lgkmcnt(7)
v_and_b32 v173, s38, v98
v_lshlrev_b32 v174, 16, v99
M a[116:119],a[216:219],a[164:167]
ds_read_b128 a[160:163], v2 offset:3072
v_and_b32 v175, s38, v99
M a[112:115],a[212:215],a[164:167]
s_waitcnt lgkmcnt(15)
s_waitcnt vmcnt(36)
v_lshlrev_b32 v14, 16, v124
v_and_b32 v15, s38, v124
M a[108:111],a[208:211],a[164:167]
s_add_u32 s41, s40, 0
v_lshlrev_b32 v176, 16, v100
M a[104:107],a[204:207],a[164:167]
buffer_store_dwordx4 v[208:211], v26, s[16:19], s41 offen sc1
M a[100:103],a[200:203],a[164:167]
v_and_b32 v177, s38, v100
v_sub_f32 v168, v168, v14
M a[120:123],a[200:203],a[168:171]
ds_read_b128 a[164:167], v3 offset:3072
v_sub_f32 v169, v169, v15
M a[124:127],a[204:207],a[168:171]
v_sub_f32 v14, v176, v14
v_sub_f32 v15, v177, v15
M a[128:131],a[208:211],a[168:171]
v_cvt_pk_bf16_f32 v192, v168, v169
v_cvt_pk_bf16_f32 v196, v14, v15
M a[132:135],a[212:215],a[168:171]
v_lshlrev_b32 v16, 16, v125
v_and_b32 v17, s38, v125
M a[136:139],a[216:219],a[168:171]
s_waitcnt lgkmcnt(5)
v_lshlrev_b32 v178, 16, v101
v_and_b32 v179, s38, v101
M a[156:159],a[216:219],a[172:175]
ds_read_b128 a[168:171], v2 offset:12288
buffer_load_dwordx4 a[216:219], v1, s[16:19], s34 offen offset:1024 sc1
M a[152:155],a[212:215],a[172:175]
v_sub_f32 v170, v170, v16
v_sub_f32 v171, v171, v17
M a[148:151],a[208:211],a[172:175]
buffer_load_dwordx4 a[212:215], v1, s[16:19], s34 offen offset:2048 sc1
v_sub_f32 v16, v178, v16
M a[144:147],a[204:207],a[172:175]
v_sub_f32 v17, v179, v17
v_cvt_pk_bf16_f32 v193, v170, v171
M a[140:143],a[200:203],a[172:175]
s_waitcnt vmcnt(30)
buffer_load_dwordx4 a[208:211], v1, s[16:19], s34 offen offset:3072 sc1
s_add_u32 s34, s34, 4096
M a[140:143],a[220:223],a[176:179]
ds_read_b128 a[172:175], v3 offset:12288
v_cvt_pk_bf16_f32 v197, v16, v17
M a[144:147],a[224:227],a[176:179]
buffer_load_dwordx4 a[204:207], v1, s[16:19], s34 offen offset:0 sc1
s_add_u32 s34, s34, 1024
M a[148:151],a[228:231],a[176:179]
v_lshlrev_b32 v14, 16, v126
v_and_b32 v15, s38, v126
M a[152:155],a[232:235],a[176:179]
s_waitcnt lgkmcnt(5)
buffer_load_dwordx4 a[200:203], v1, s[16:19], s34 offen offset:0 sc1
v_lshlrev_b32 v180, 16, v102
M a[132:135],a[232:235],a[180:183]
ds_read_b128 a[176:179], v5 offset:12288
v_and_b32 v181, s38, v102
M a[128:131],a[228:231],a[180:183]
v_sub_f32 v172, v172, v14
v_sub_f32 v173, v173, v15
M a[124:127],a[224:227],a[180:183]
v_sub_f32 v14, v180, v14
v_sub_f32 v15, v181, v15
M a[120:123],a[220:223],a[180:183]
v_cvt_pk_bf16_f32 v194, v172, v173
v_cvt_pk_bf16_f32 v198, v14, v15
M a[100:103],a[220:223],a[184:187]
ds_read_b128 a[180:183], v4 offset:12288
v_lshlrev_b32 v16, 16, v127
M a[104:107],a[224:227],a[184:187]
v_and_b32 v17, s38, v127
v_lshlrev_b32 v182, 16, v103
M a[108:111],a[228:231],a[184:187]
v_and_b32 v183, s38, v103
v_sub_f32 v174, v174, v16
M a[112:115],a[232:235],a[184:187]
s_waitcnt lgkmcnt(5)
v_sub_f32 v175, v175, v17
v_sub_f32 v16, v182, v16
M a[92:95],a[232:235],a[188:191]
ds_read_b128 a[184:187], v5 offset:3072
buffer_load_dwordx4 a[232:235], v1, s[16:19], s34 offen offset:1024 sc1
M a[88:91],a[228:231],a[188:191]
v_sub_f32 v17, v183, v17
v_cvt_pk_bf16_f32 v195, v174, v175
M a[84:87],a[224:227],a[188:191]
buffer_load_dwordx4 a[228:231], v1, s[16:19], s34 offen offset:2048 sc1
v_cvt_pk_bf16_f32 v199, v16, v17
M a[80:83],a[220:223],a[188:191]
s_waitcnt vmcnt(28)
ds_write_b128 v10, v[192:195] offset:45056
M a[80:83],a[236:239],a[160:163]
ds_read_b128 a[188:191], v4 offset:3072
buffer_load_dwordx4 a[224:227], v1, s[16:19], s34 offen offset:3072 sc1
M a[84:87],a[240:243],a[160:163]
s_add_u32 s34, s34, 4096
M a[88:91],a[244:247],a[160:163]
ds_write_b128 v10, v[196:199] offset:22528
M a[92:95],a[248:251],a[160:163]
buffer_load_dwordx4 a[220:223], v1, s[16:19], s34 offen offset:0 sc1
s_waitcnt lgkmcnt(15)
s_waitcnt vmcnt(41)
v_lshlrev_b32 v14, 16, v128
M a[96:99],a[252:255],a[160:163]
s_waitcnt lgkmcnt(7)
v_and_b32 v15, s38, v128
v_lshlrev_b32 v168, 16, v104
M a[116:119],a[252:255],a[164:167]
ds_read_b128 a[160:163], v6 offset:3136
v_and_b32 v169, s38, v104
M a[112:115],a[248:251],a[164:167]
v_sub_f32 v176, v176, v14
v_sub_f32 v177, v177, v15
M a[108:111],a[244:247],a[164:167]
v_sub_f32 v14, v168, v14
v_sub_f32 v15, v169, v15
M a[104:107],a[240:243],a[164:167]
v_cvt_pk_bf16_f32 v192, v176, v177
v_cvt_pk_bf16_f32 v196, v14, v15
M a[100:103],a[236:239],a[164:167]
v_lshlrev_b32 v16, 16, v129
v_and_b32 v17, s38, v129
M a[120:123],a[236:239],a[168:171]
ds_read_b128 a[164:167], v7 offset:3136
v_lshlrev_b32 v170, 16, v105
M a[124:127],a[240:243],a[168:171]
v_and_b32 v171, s38, v105
v_sub_f32 v178, v178, v16
M a[128:131],a[244:247],a[168:171]
v_sub_f32 v179, v179, v17
v_sub_f32 v16, v170, v16
M a[132:135],a[248:251],a[168:171]
v_sub_f32 v17, v171, v17
v_cvt_pk_bf16_f32 v193, v178, v179
M a[136:139],a[252:255],a[168:171]
s_waitcnt lgkmcnt(7)
v_cvt_pk_bf16_f32 v197, v16, v17
v_lshlrev_b32 v14, 16, v130
M a[156:159],a[252:255],a[172:175]
ds_read_b128 a[168:171], v6 offset:12352
buffer_load_dwordx4 a[252:255], v1, s[16:19], s34 offen offset:1024 sc1
M a[152:155],a[248:251],a[172:175]
v_and_b32 v15, s38, v130
v_lshlrev_b32 v172, 16, v106
M a[148:151],a[244:247],a[172:175]
buffer_load_dwordx4 a[248:251], v1, s[16:19], s34 offen offset:2048 sc1
v_and_b32 v173, s38, v106
M a[144:147],a[240:243],a[172:175]
v_sub_f32 v180, v180, v14
v_sub_f32 v181, v181, v15
M a[140:143],a[236:239],a[172:175]
s_waitcnt vmcnt(27)
buffer_load_dwordx4 a[244:247], v1, s[16:19], s34 offen offset:3072 sc1
s_add_u32 s34, s34, 4096
M a[140:143],v[48:51],a[176:179]
ds_read_b128 a[172:175], v7 offset:12352
v_sub_f32 v14, v172, v14
M a[144:147],v[44:47],a[176:179]
buffer_load_dwordx4 a[240:243], v1, s[16:19], s34 offen offset:0 sc1
s_add_u32 s34, s34, 1024
M a[148:151],v[40:43],a[176:179]
v_sub_f32 v15, v173, v15
v_cvt_pk_bf16_f32 v194, v180, v181
M a[152:155],v[36:39],a[176:179]
s_waitcnt lgkmcnt(7)
buffer_load_dwordx4 a[236:239], v1, s[16:19], s34 offen offset:0 sc1
v_cvt_pk_bf16_f32 v198, v14, v15
M a[132:135],v[36:39],a[180:183]
ds_read_b128 a[176:179], v9 offset:12352
v_lshlrev_b32 v16, 16, v131
M a[128:131],v[40:43],a[180:183]
v_and_b32 v17, s38, v131
v_lshlrev_b32 v174, 16, v107
M a[124:127],v[44:47],a[180:183]
v_and_b32 v175, s38, v107
v_sub_f32 v182, v182, v16
M a[120:123],v[48:51],a[180:183]
v_sub_f32 v183, v183, v17
v_sub_f32 v16, v174, v16
M a[100:103],v[48:51],a[184:187]
ds_read_b128 a[180:183], v8 offset:12352
v_sub_f32 v17, v175, v17
M a[104:107],v[44:47],a[184:187]
v_cvt_pk_bf16_f32 v195, v182, v183
v_cvt_pk_bf16_f32 v199, v16, v17
M a[108:111],v[40:43],a[184:187]
ds_write_b128 v10, v[192:195] offset:45632
M a[112:115],v[36:39],a[184:187]
s_waitcnt lgkmcnt(6)
ds_write_b128 v10, v[196:199] offset:23104
M a[92:95],v[36:39],a[188:191]
ds_read_b128 a[184:187], v9 offset:3136
buffer_load_dwordx4 v[36:39], v1, s[16:19], s34 offen offset:1024 sc1
s_waitcnt lgkmcnt(15)
s_waitcnt vmcnt(42)
M a[88:91],v[40:43],a[188:191]
v_lshlrev_b32 v14, 16, v132
v_and_b32 v15, s38, v132
M a[84:87],v[44:47],a[188:191]
buffer_load_dwordx4 v[40:43], v1, s[16:19], s34 offen offset:2048 sc1
v_lshlrev_b32 v176, 16, v108
M a[80:83],v[48:51],a[188:191]
s_waitcnt vmcnt(26)
v_and_b32 v177, s38, v108
v_sub_f32 v168, v168, v14
M a[80:83],v[32:35],a[160:163]
ds_read_b128 a[188:191], v8 offset:3136
buffer_load_dwordx4 v[44:47], v1, s[16:19], s34 offen offset:3072 sc1
M a[84:87],v[64:67],a[160:163]
s_add_u32 s34, s34, 4096
v_sub_f32 v169, v169, v15
M a[88:91],v[60:63],a[160:163]
v_sub_f32 v14, v176, v14
v_sub_f32 v15, v177, v15
M a[92:95],v[56:59],a[160:163]
buffer_load_dwordx4 v[48:51], v1, s[16:19], s34 offen offset:0 sc1
v_cvt_pk_bf16_f32 v192, v168, v169
M a[96:99],v[52:55],a[160:163]
s_waitcnt lgkmcnt(7)
v_cvt_pk_bf16_f32 v196, v14, v15
v_lshlrev_b32 v16, 16, v133
M a[116:119],v[52:55],a[164:167]
ds_read_b128 a[160:163], v2 offset:2336
v_and_b32 v17, s38, v133
M a[112:115],v[56:59],a[164:167]
v_lshlrev_b32 v178, 16, v109
v_and_b32 v179, s38, v109
M a[108:111],v[60:63],a[164:167]
s_add_u32 s41, s40, 165888
v_sub_f32 v170, v170, v16
M a[104:107],v[64:67],a[164:167]
buffer_store_dwordx4 v[212:215], v26, s[16:19], s41 offen sc1
M a[100:103],v[32:35],a[164:167]
v_sub_f32 v171, v171, v17
v_sub_f32 v16, v178, v16
M a[120:123],v[32:35],a[168:171]
ds_read_b128 a[164:167], v3 offset:2336
v_sub_f32 v17, v179, v17
M a[124:127],v[64:67],a[168:171]
v_cvt_pk_bf16_f32 v193, v170, v171
v_cvt_pk_bf16_f32 v197, v16, v17
M a[128:131],v[60:63],a[168:171]
v_lshlrev_b32 v14, 16, v134
v_and_b32 v15, s38, v134
M a[132:135],v[56:59],a[168:171]
v_lshlrev_b32 v180, 16, v110
v_and_b32 v181, s38, v110
M a[136:139],v[52:55],a[168:171]
s_waitcnt lgkmcnt(7)
v_sub_f32 v172, v172, v14
v_sub_f32 v173, v173, v15
M a[156:159],v[52:55],a[172:175]
ds_read_b128 a[168:171], v2 offset:11552
buffer_load_dwordx4 v[52:55], v1, s[16:19], s34 offen offset:1024 sc1
M a[152:155],v[56:59],a[172:175]
v_sub_f32 v14, v180, v14
v_sub_f32 v15, v181, v15
M a[148:151],v[60:63],a[172:175]
buffer_load_dwordx4 v[56:59], v1, s[16:19], s34 offen offset:2048 sc1
v_cvt_pk_bf16_f32 v194, v172, v173
M a[144:147],v[64:67],a[172:175]
v_cvt_pk_bf16_f32 v198, v14, v15
v_lshlrev_b32 v16, 16, v135
M a[140:143],v[32:35],a[172:175]
s_waitcnt vmcnt(27)
buffer_load_dwordx4 v[60:63], v1, s[16:19], s34 offen offset:3072 sc1
s_add_u32 s34, s34, 4096
M a[140:143],v[84:87],a[176:179]
ds_read_b128 a[172:175], v3 offset:11552
v_and_b32 v17, s38, v135
M a[144:147],v[80:83],a[176:179]
buffer_load_dwordx4 v[64:67], v1, s[16:19], s34 offen offset:0 sc1
s_add_u32 s34, s34, 1024
M a[148:151],v[76:79],a[176:179]
v_lshlrev_b32 v182, 16, v111
v_and_b32 v183, s38, v111
M a[152:155],v[72:75],a[176:179]
s_waitcnt lgkmcnt(5)
buffer_load_dwordx4 v[32:35], v1, s[16:19], s34 offen offset:0 sc1
v_sub_f32 v174, v174, v16
M a[132:135],v[72:75],a[180:183]
ds_read_b128 a[176:179], v5 offset:11552
v_sub_f32 v175, v175, v17
M a[128:131],v[76:79],a[180:183]
v_sub_f32 v16, v182, v16
v_sub_f32 v17, v183, v17
M a[124:127],v[80:83],a[180:183]
v_cvt_pk_bf16_f32 v195, v174, v175
v_cvt_pk_bf16_f32 v199, v16, v17
M a[120:123],v[84:87],a[180:183]
ds_write_b128 v10, v[192:195] offset:46208
M a[100:103],v[84:87],a[184:187]
ds_read_b128 a[180:183], v4 offset:11552
M a[104:107],v[80:83],a[184:187]
ds_write_b128 v10, v[196:199] offset:23680
M a[108:111],v[76:79],a[184:187]
s_waitcnt lgkmcnt(15)
s_waitcnt vmcnt(47)
v_lshlrev_b32 v14, 16, v136
v_and_b32 v15, s38, v136
M a[112:115],v[72:75],a[184:187]
s_waitcnt lgkmcnt(7)
v_lshlrev_b32 v168, 16, v112
v_and_b32 v169, s38, v112
M a[92:95],v[72:75],a[188:191]
ds_read_b128 a[184:187], v5 offset:2336
buffer_load_dwordx4 v[72:75], v1, s[16:19], s34 offen offset:1024 sc1
M a[88:91],v[76:79],a[188:191]
v_sub_f32 v176, v176, v14
v_sub_f32 v177, v177, v15
M a[84:87],v[80:83],a[188:191]
buffer_load_dwordx4 v[76:79], v1, s[16:19], s34 offen offset:2048 sc1
v_sub_f32 v14, v168, v14
M a[80:83],v[84:87],a[188:191]
s_waitcnt vmcnt(27)
v_sub_f32 v15, v169, v15
v_cvt_pk_bf16_f32 v192, v176, v177
M a[80:83],v[68:71],a[160:163]
ds_read_b128 a[188:191], v4 offset:2336
buffer_load_dwordx4 v[80:83], v1, s[16:19], s34 offen offset:3072 sc1
M a[84:87],a[196:199],a[160:163]
s_add_u32 s34, s34, 4096
v_cvt_pk_bf16_f32 v196, v14, v15
M a[88:91],a[192:195],a[160:163]
v_lshlrev_b32 v16, 16, v137
v_and_b32 v17, s38, v137
M a[92:95],v[92:95],a[160:163]
buffer_load_dwordx4 v[84:87], v1, s[16:19], s34 offen offset:0 sc1
v_lshlrev_b32 v170, 16, v113
M a[96:99],v[88:91],a[160:163]
s_waitcnt lgkmcnt(7)
v_and_b32 v171, s38, v113
v_sub_f32 v178, v178, v16
M a[116:119],v[88:91],a[164:167]
ds_read_b128 a[160:163], v2 offset:2400
v_sub_f32 v179, v179, v17
M a[112:115],v[92:95],a[164:167]
v_sub_f32 v16, v170, v16
v_sub_f32 v17, v171, v17
M a[108:111],a[192:195],a[164:167]
v_cvt_pk_bf16_f32 v193, v178, v179
v_cvt_pk_bf16_f32 v197, v16, v17
M a[104:107],a[196:199],a[164:167]
v_lshlrev_b32 v14, 16, v138
v_and_b32 v15, s38, v138
M a[100:103],v[68:71],a[164:167]
v_lshlrev_b32 v172, 16, v114
v_and_b32 v173, s38, v114
M a[120:123],v[68:71],a[168:171]
ds_read_b128 a[164:167], v3 offset:2400
v_sub_f32 v180, v180, v14
M a[124:127],a[196:199],a[168:171]
v_sub_f32 v181, v181, v15
v_sub_f32 v14, v172, v14
M a[128:131],a[192:195],a[168:171]
v_sub_f32 v15, v173, v15
v_cvt_pk_bf16_f32 v194, v180, v181
M a[132:135],v[92:95],a[168:171]
v_cvt_pk_bf16_f32 v198, v14, v15
v_lshlrev_b32 v16, 16, v139
M a[136:139],v[88:91],a[168:171]
s_waitcnt lgkmcnt(7)
v_and_b32 v17, s38, v139
v_lshlrev_b32 v174, 16, v115
M a[156:159],v[88:91],a[172:175]
ds_read_b128 a[168:171], v2 offset:11616
buffer_load_dwordx4 v[88:91], v1, s[16:19], s34 offen offset:1024 sc1
M a[152:155],v[92:95],a[172:175]
v_and_b32 v175, s38, v115
v_sub_f32 v182, v182, v16
M a[148:151],a[192:195],a[172:175]
buffer_load_dwordx4 v[92:95], v1, s[16:19], s34 offen offset:2048 sc1
v_sub_f32 v183, v183, v17
M a[144:147],a[196:199],a[172:175]
v_sub_f32 v16, v174, v16
v_sub_f32 v17, v175, v17
M a[140:143],v[68:71],a[172:175]
s_waitcnt vmcnt(26)
buffer_load_dwordx4 a[192:195], v1, s[16:19], s34 offen offset:3072 sc1
s_add_u32 s34, s34, 4096
M a[140:143],a[216:219],a[176:179]
ds_read_b128 a[172:175], v3 offset:11616
v_cvt_pk_bf16_f32 v195, v182, v183
M a[144:147],a[212:215],a[176:179]
buffer_load_dwordx4 a[196:199], v1, s[16:19], s34 offen offset:0 sc1
s_add_u32 s34, s34, 1024
M a[148:151],a[208:211],a[176:179]
v_cvt_pk_bf16_f32 v199, v16, v17
M a[152:155],a[204:207],a[176:179]
s_waitcnt lgkmcnt(5)
buffer_load_dwordx4 v[68:71], v1, s[16:19], s34 offen offset:0 sc1
M a[132:135],a[204:207],a[180:183]
ds_read_b128 a[176:179], v5 offset:11616
M a[128:131],a[208:211],a[180:183]
ds_write_b128 v10, v[192:195] offset:46784
M a[124:127],a[212:215],a[180:183]
ds_write_b128 v10, v[196:199] offset:24256
M a[120:123],a[216:219],a[180:183]
s_waitcnt lgkmcnt(15)
s_waitcnt vmcnt(51)
v_lshlrev_b32 v14, 16, v140
v_and_b32 v15, s38, v140
M a[100:103],a[216:219],a[184:187]
ds_read_b128 a[180:183], v4 offset:11616
v_lshlrev_b32 v176, 16, v116
M a[104:107],a[212:215],a[184:187]
v_and_b32 v177, s38, v116
v_sub_f32 v168, v168, v14
M a[108:111],a[208:211],a[184:187]
v_sub_f32 v169, v169, v15
v_sub_f32 v14, v176, v14
M a[112:115],a[204:207],a[184:187]
s_waitcnt lgkmcnt(7)
v_sub_f32 v15, v177, v15
v_cvt_pk_bf16_f32 v192, v168, v169
M a[92:95],a[204:207],a[188:191]
ds_read_b128 a[184:187], v5 offset:2400
buffer_load_dwordx4 a[204:207], v1, s[16:19], s34 offen offset:1024 sc1
M a[88:91],a[208:211],a[188:191]
v_cvt_pk_bf16_f32 v196, v14, v15
v_lshlrev_b32 v16, 16, v141
M a[84:87],a[212:215],a[188:191]
buffer_load_dwordx4 a[208:211], v1, s[16:19], s34 offen offset:2048 sc1
v_and_b32 v17, s38, v141
M a[80:83],a[216:219],a[188:191]
s_waitcnt vmcnt(26)
v_lshlrev_b32 v178, 16, v117
v_and_b32 v179, s38, v117
M a[80:83],a[200:203],a[160:163]
ds_read_b128 a[188:191], v4 offset:2400
buffer_load_dwordx4 a[212:215], v1, s[16:19], s34 offen offset:3072 sc1
M a[84:87],a[232:235],a[160:163]
s_add_u32 s34, s34, 4096
v_sub_f32 v170, v170, v16
M a[88:91],a[228:231],a[160:163]
v_sub_f32 v171, v171, v17
v_sub_f32 v16, v178, v16
M a[92:95],a[224:227],a[160:163]
buffer_load_dwordx4 a[216:219], v1, s[16:19], s34 offen offset:0 sc1
v_sub_f32 v17, v179, v17
M a[96:99],a[220:223],a[160:163]
s_waitcnt lgkmcnt(7)
v_cvt_pk_bf16_f32 v193, v170, v171
v_cvt_pk_bf16_f32 v197, v16, v17
M a[116:119],a[220:223],a[164:167]
ds_read_b128 a[160:163], v2 offset:2464
v_lshlrev_b32 v14, 16, v142
M a[112:115],a[224:227],a[164:167]
v_and_b32 v15, s38, v142
v_lshlrev_b32 v180, 16, v118
M a[108:111],a[228:231],a[164:167]
s_add_u32 s41, s40, 331776
v_and_b32 v181, s38, v118
M a[104:107],a[232:235],a[164:167]
buffer_store_dwordx4 v[216:219], v26, s[16:19], s41 offen sc1
M a[100:103],a[200:203],a[164:167]
v_sub_f32 v172, v172, v14
v_sub_f32 v173, v173, v15
M a[120:123],a[200:203],a[168:171]
ds_read_b128 a[164:167], v3 offset:2464
v_sub_f32 v14, v180, v14
M a[124:127],a[232:235],a[168:171]
v_sub_f32 v15, v181, v15
v_cvt_pk_bf16_f32 v194, v172, v173
M a[128:131],a[228:231],a[168:171]
v_cvt_pk_bf16_f32 v198, v14, v15
v_lshlrev_b32 v16, 16, v143
M a[132:135],a[224:227],a[168:171]
v_and_b32 v17, s38, v143
v_lshlrev_b32 v182, 16, v119
M a[136:139],a[220:223],a[168:171]
s_waitcnt lgkmcnt(7)
v_and_b32 v183, s38, v119
v_sub_f32 v174, v174, v16
M a[156:159],a[220:223],a[172:175]
ds_read_b128 a[168:171], v2 offset:11680
buffer_load_dwordx4 a[220:223], v1, s[16:19], s34 offen offset:1024 sc1
M a[152:155],a[224:227],a[172:175]
v_sub_f32 v175, v175, v17
v_sub_f32 v16, v182, v16
M a[148:151],a[228:231],a[172:175]
buffer_load_dwordx4 a[224:227], v1, s[16:19], s34 offen offset:2048 sc1
v_sub_f32 v17, v183, v17
M a[144:147],a[232:235],a[172:175]
v_cvt_pk_bf16_f32 v195, v174, v175
v_cvt_pk_bf16_f32 v199, v16, v17
M a[140:143],a[200:203],a[172:175]
s_waitcnt vmcnt(27)
buffer_load_dwordx4 a[228:231], v1, s[16:19], s34 offen offset:3072 sc1
s_add_u32 s34, s34, 4096
M a[140:143],a[252:255],a[176:179]
ds_read_b128 a[172:175], v3 offset:11680
v_add_u32 v24, 0, v11
M a[144:147],a[248:251],a[176:179]
buffer_load_dwordx4 a[232:235], v1, s[16:19], s34 offen offset:0 sc1
s_add_u32 s34, s34, 1024
M a[148:151],a[244:247],a[176:179]
ds_write_b128 v10, v[192:195] offset:47360
M a[152:155],a[240:243],a[176:179]
s_waitcnt lgkmcnt(6)
buffer_load_dwordx4 a[200:203], v1, s[16:19], s34 offen offset:0 sc1
buffer_load_dwordx4 v[148:151], v24, s[12:15], 0 offen
M a[132:135],a[240:243],a[180:183]
ds_read_b128 a[176:179], v5 offset:11680
v_add_u32 v24, 1152, v11
M a[128:131],a[244:247],a[180:183]
ds_write_b128 v10, v[196:199] offset:24832
M a[124:127],a[248:251],a[180:183]
s_waitcnt lgkmcnt(15)
s_waitcnt vmcnt(57)
v_lshlrev_b32 v14, 16, v144
v_and_b32 v15, s38, v144
M a[120:123],a[252:255],a[180:183]
v_lshlrev_b32 v168, 16, v120
v_and_b32 v169, s38, v120
M a[100:103],a[252:255],a[184:187]
ds_read_b128 a[180:183], v4 offset:11680
v_sub_f32 v176, v176, v14
M a[104:107],a[248:251],a[184:187]
v_sub_f32 v177, v177, v15
v_sub_f32 v14, v168, v14
M a[108:111],a[244:247],a[184:187]
v_sub_f32 v15, v169, v15
v_cvt_pk_bf16_f32 v192, v176, v177
M a[112:115],a[240:243],a[184:187]
s_waitcnt lgkmcnt(7)
v_cvt_pk_bf16_f32 v196, v14, v15
v_lshlrev_b32 v16, 16, v145
M a[92:95],a[240:243],a[188:191]
ds_read_b128 a[184:187], v5 offset:2464
buffer_load_dwordx4 a[240:243], v1, s[16:19], s34 offen offset:1024 sc1
M a[88:91],a[244:247],a[188:191]
v_and_b32 v17, s38, v145
v_lshlrev_b32 v170, 16, v121
M a[84:87],a[248:251],a[188:191]
buffer_load_dwordx4 a[244:247], v1, s[16:19], s34 offen offset:2048 sc1
v_and_b32 v171, s38, v121
M a[80:83],a[252:255],a[188:191]
s_waitcnt vmcnt(28)
v_sub_f32 v178, v178, v16
v_sub_f32 v179, v179, v17
M a[80:83],a[236:239],a[160:163]
ds_read_b128 a[188:191], v4 offset:2464
buffer_load_dwordx4 a[248:251], v1, s[16:19], s34 offen offset:3072 sc1
M a[84:87],v[36:39],a[160:163]
s_add_u32 s34, s34, 4096
v_sub_f32 v16, v170, v16
M a[88:91],v[40:43],a[160:163]
v_sub_f32 v17, v171, v17
v_cvt_pk_bf16_f32 v193, v178, v179
M a[92:95],v[44:47],a[160:163]
buffer_load_dwordx4 a[252:255], v1, s[16:19], s34 offen offset:0 sc1
v_cvt_pk_bf16_f32 v197, v16, v17
M a[96:99],v[48:51],a[160:163]
s_waitcnt lgkmcnt(7)
v_lshlrev_b32 v14, 16, v146
v_and_b32 v15, s38, v146
M a[116:119],v[48:51],a[164:167]
ds_read_b128 a[160:163], v2 offset:2528
v_lshlrev_b32 v172, 16, v122
M a[112:115],v[44:47],a[164:167]
v_and_b32 v173, s38, v122
v_sub_f32 v180, v180, v14
M a[108:111],v[40:43],a[164:167]
v_sub_f32 v181, v181, v15
v_sub_f32 v14, v172, v14
M a[104:107],v[36:39],a[164:167]
v_sub_f32 v15, v173, v15
v_cvt_pk_bf16_f32 v194, v180, v181
M a[100:103],a[236:239],a[164:167]
v_cvt_pk_bf16_f32 v198, v14, v15
v_lshlrev_b32 v16, 16, v147
M a[120:123],a[236:239],a[168:171]
ds_read_b128 a[164:167], v3 offset:2528
v_and_b32 v17, s38, v147
M a[124:127],v[36:39],a[168:171]
v_lshlrev_b32 v174, 16, v123
v_and_b32 v175, s38, v123
M a[128:131],v[40:43],a[168:171]
v_sub_f32 v182, v182, v16
v_sub_f32 v183, v183, v17
M a[132:135],v[44:47],a[168:171]
v_sub_f32 v16, v174, v16
v_sub_f32 v17, v175, v17
M a[136:139],v[48:51],a[168:171]
s_waitcnt lgkmcnt(6)
v_cvt_pk_bf16_f32 v195, v182, v183
v_cvt_pk_bf16_f32 v199, v16, v17
M a[156:159],v[48:51],a[172:175]
ds_read_b128 a[168:171], v2 offset:11744
buffer_load_dwordx4 v[48:51], v1, s[16:19], s34 offen offset:1024 sc1
M a[152:155],v[44:47],a[172:175]
ds_write_b128 v10, v[192:195] offset:47936
M a[148:151],v[40:43],a[172:175]
buffer_load_dwordx4 v[44:47], v1, s[16:19], s34 offen offset:2048 sc1
buffer_load_dwordx4 v[152:155], v24, s[12:15], 0 offen
M a[144:147],v[36:39],a[172:175]
ds_write_b128 v10, v[196:199] offset:25408
M a[140:143],a[236:239],a[172:175]
s_waitcnt vmcnt(28)
buffer_load_dwordx4 v[40:43], v1, s[16:19], s34 offen offset:3072 sc1
s_add_u32 s34, s34, 4096
M a[140:143],v[52:55],a[176:179]
ds_read_b128 a[172:175], v3 offset:11744
v_add_u32 v24, 2304, v11
M a[144:147],v[56:59],a[176:179]
buffer_load_dwordx4 v[36:39], v1, s[16:19], s34 offen offset:0 sc1
s_add_u32 s34, s34, 1024
M a[148:151],v[60:63],a[176:179]
buffer_load_dwordx4 v[156:159], v24, s[12:15], 0 offen
v_add_u32 v24, 3456, v11
M a[152:155],v[64:67],a[176:179]
s_waitcnt lgkmcnt(7)
buffer_load_dwordx4 a[236:239], v1, s[16:19], s34 offen offset:0 sc1
buffer_load_dwordx4 v[160:163], v24, s[12:15], 0 offen
M a[132:135],v[64:67],a[180:183]
ds_read_b128 a[176:179], v5 offset:11744
M a[128:131],v[60:63],a[180:183]
M a[124:127],v[56:59],a[180:183]
M a[120:123],v[52:55],a[180:183]
M a[100:103],v[52:55],a[184:187]
ds_read_b128 a[180:183], v4 offset:11744
M a[104:107],v[56:59],a[184:187]
M a[108:111],v[60:63],a[184:187]
M a[112:115],v[64:67],a[184:187]
s_waitcnt lgkmcnt(7)
M a[92:95],v[64:67],a[188:191]
ds_read_b128 a[184:187], v5 offset:2528
buffer_load_dwordx4 v[64:67], v1, s[16:19], s34 offen offset:1024 sc1
M a[88:91],v[60:63],a[188:191]
M a[84:87],v[56:59],a[188:191]
buffer_load_dwordx4 v[60:63], v1, s[16:19], s34 offen offset:2048 sc1
M a[80:83],v[52:55],a[188:191]
s_waitcnt vmcnt(30)
s_waitcnt lgkmcnt(0)
s_barrier
M a[80:83],v[32:35],a[160:163]
ds_read_b128 a[188:191], v4 offset:2528
buffer_load_dwordx4 v[56:59], v1, s[16:19], s34 offen offset:3072 sc1
M a[84:87],v[72:75],a[160:163]
s_waitcnt vmcnt(8)
v_add_u32 v2, s10, v2
v_add_u32 v3, s10, v3
M a[88:91],v[76:79],a[160:163]
v_add_u32 v4, s10, v4
v_add_u32 v5, s10, v5
M a[92:95],v[80:83],a[160:163]
v_add_u32 v6, s10, v6
v_add_u32 v7, s10, v7
M a[96:99],v[84:87],a[160:163]
s_waitcnt lgkmcnt(7)
v_add_u32 v8, s10, v8
v_add_u32 v9, s10, v9
M a[116:119],v[84:87],a[164:167]
ds_read_b128 a[160:163], v2 offset:2880
s_add_u32 s34, s34, 4096
M a[112:115],v[80:83],a[164:167]
v_lshlrev_b32 v14, 16, v96
v_and_b32 v15, s38, v96
M a[108:111],v[76:79],a[164:167]
buffer_load_dwordx4 v[52:55], v1, s[16:19], s34 offen offset:0 sc1
s_add_u32 s41, s40, 1492992
M a[104:107],v[72:75],a[164:167]
buffer_store_dwordx4 v[220:223], v26, s[16:19], s41 offen sc1
M a[100:103],v[32:35],a[164:167]
v_lshlrev_b32 v184, 16, v148
v_and_b32 v185, s38, v148
M a[120:123],v[32:35],a[168:171]
ds_read_b128 a[164:167], v3 offset:2880
v_lshlrev_b32 v168, 16, v152
M a[124:127],v[72:75],a[168:171]
v_and_b32 v169, s38, v152
v_sub_f32 v184, v184, v14
M a[128:131],v[76:79],a[168:171]
v_sub_f32 v185, v185, v15
v_sub_f32 v176, v168, v14
M a[132:135],v[80:83],a[168:171]
v_sub_f32 v177, v169, v15
v_lshlrev_b32 v14, 16, v97
M a[136:139],v[84:87],a[168:171]
s_waitcnt lgkmcnt(5)
v_and_b32 v15, s38, v97
v_lshlrev_b32 v186, 16, v149
M a[156:159],v[84:87],a[172:175]
ds_read_b128 a[168:171], v2 offset:12096
buffer_load_dwordx4 v[84:87], v1, s[16:19], s34 offen offset:1024 sc1
M a[152:155],v[80:83],a[172:175]
v_and_b32 v187, s38, v149
v_lshlrev_b32 v170, 16, v153
M a[148:151],v[76:79],a[172:175]
buffer_load_dwordx4 v[80:83], v1, s[16:19], s34 offen offset:2048 sc1
v_and_b32 v171, s38, v153
M a[144:147],v[72:75],a[172:175]
v_sub_f32 v186, v186, v14
v_sub_f32 v187, v187, v15
M a[140:143],v[32:35],a[172:175]
s_waitcnt vmcnt(31)
buffer_load_dwordx4 v[76:79], v1, s[16:19], s34 offen offset:3072 sc1
s_add_u32 s34, s34, 4096
M a[140:143],v[88:91],a[176:179]
ds_read_b128 a[172:175], v3 offset:12096
v_sub_f32 v178, v170, v14
M a[144:147],v[92:95],a[176:179]
buffer_load_dwordx4 v[72:75], v1, s[16:19], s34 offen offset:0 sc1
s_add_u32 s34, s34, 1024
M a[148:151],a[192:195],a[176:179]
v_sub_f32 v179, v171, v15
v_lshlrev_b32 v14, 16, v98
M a[152:155],a[196:199],a[176:179]
s_waitcnt lgkmcnt(5)
buffer_load_dwordx4 v[32:35], v1, s[16:19], s34 offen offset:0 sc1
v_and_b32 v15, s38, v98
M a[132:135],a[196:199],a[180:183]
ds_read_b128 a[176:179], v5 offset:12096
v_lshlrev_b32 v188, 16, v150
M a[128:131],a[192:195],a[180:183]
v_and_b32 v189, s38, v150
v_lshlrev_b32 v172, 16, v154
M a[124:127],v[92:95],a[180:183]
v_and_b32 v173, s38, v154
v_sub_f32 v188, v188, v14
M a[120:123],v[88:91],a[180:183]
v_sub_f32 v189, v189, v15
v_sub_f32 v180, v172, v14
M a[100:103],v[88:91],a[184:187]
ds_read_b128 a[180:183], v4 offset:12096
v_sub_f32 v181, v173, v15
M a[104:107],v[92:95],a[184:187]
v_lshlrev_b32 v14, 16, v99
v_and_b32 v15, s38, v99
M a[108:111],a[192:195],a[184:187]
v_lshlrev_b32 v190, 16, v151
v_and_b32 v191, s38, v151
M a[112:115],a[196:199],a[184:187]
s_waitcnt lgkmcnt(5)
v_lshlrev_b32 v174, 16, v155
v_and_b32 v175, s38, v155
M a[92:95],a[196:199],a[188:191]
ds_read_b128 a[184:187], v5 offset:2880
buffer_load_dwordx4 a[196:199], v1, s[16:19], s34 offen offset:1024 sc1
M a[88:91],a[192:195],a[188:191]
v_sub_f32 v190, v190, v14
v_sub_f32 v191, v191, v15
M a[84:87],v[92:95],a[188:191]
buffer_load_dwordx4 a[192:195], v1, s[16:19], s34 offen offset:2048 sc1
v_sub_f32 v182, v174, v14
M a[80:83],v[88:91],a[188:191]
s_waitcnt vmcnt(31)
v_sub_f32 v183, v175, v15
v_add_u32 v24, 4608, v11
v_mfma_f32_16x16x32_bf16 a[0:3], v[68:71], a[160:163], a[80:83]
ds_read_b128 a[188:191], v4 offset:2880
buffer_load_dwordx4 v[92:95], v1, s[16:19], s34 offen offset:3072 sc1
v_mfma_f32_16x16x32_bf16 a[4:7], a[204:207], a[160:163], a[84:87]
s_add_u32 s34, s34, 4096
buffer_load_dwordx4 v[164:167], v24, s[12:15], 0 offen
v_mfma_f32_16x16x32_bf16 a[8:11], a[208:211], a[160:163], a[88:91]
v_add_u32 v24, 5760, v11
v_mfma_f32_16x16x32_bf16 a[12:15], a[212:215], a[160:163], a[92:95]
buffer_load_dwordx4 v[88:91], v1, s[16:19], s34 offen offset:0 sc1
buffer_load_dwordx4 v[148:151], v24, s[12:15], 0 offen
s_waitcnt vmcnt(16)
v_mfma_f32_16x16x32_bf16 a[16:19], a[216:219], a[160:163], a[96:99]
s_waitcnt lgkmcnt(5)
v_lshlrev_b32 v14, 16, v124
v_and_b32 v15, s38, v124
v_mfma_f32_16x16x32_bf16 a[36:39], a[216:219], a[164:167], a[116:119]
ds_read_b128 a[160:163], v2 offset:2944
v_lshlrev_b32 v16, 16, v156
v_mfma_f32_16x16x32_bf16 a[32:35], a[212:215], a[164:167], a[112:115]
v_and_b32 v17, s38, v156
v_lshlrev_b32 v18, 16, v100
v_mfma_f32_16x16x32_bf16 a[28:31], a[208:211], a[164:167], a[108:111]
v_and_b32 v19, s38, v100
v_sub_f32 v168, v168, v14
v_mfma_f32_16x16x32_bf16 a[24:27], a[204:207], a[164:167], a[104:107]
v_sub_f32 v169, v169, v15
v_sub_f32 v184, v184, v168
v_mfma_f32_16x16x32_bf16 a[20:23], v[68:71], a[164:167], a[100:103]
v_sub_f32 v185, v185, v169
v_cvt_pk_bf16_f32 v96, v184, v185
v_mfma_f32_16x16x32_bf16 a[40:43], v[68:71], a[168:171], a[120:123]
ds_read_b128 a[164:167], v3 offset:2944
v_sub_f32 v184, v16, v18
v_mfma_f32_16x16x32_bf16 a[44:47], a[204:207], a[168:171], a[124:127]
v_sub_f32 v185, v17, v19
v_sub_f32 v16, v16, v14
v_mfma_f32_16x16x32_bf16 a[48:51], a[208:211], a[168:171], a[128:131]
v_sub_f32 v17, v17, v15
v_sub_f32 v176, v176, v16
v_mfma_f32_16x16x32_bf16 a[52:55], a[212:215], a[168:171], a[132:135]
v_sub_f32 v177, v177, v17
v_cvt_pk_bf16_f32 v124, v176, v177
v_mfma_f32_16x16x32_bf16 a[56:59], a[216:219], a[168:171], a[136:139]
s_waitcnt lgkmcnt(5)
v_sub_f32 v14, v184, v168
v_sub_f32 v15, v185, v169
v_mfma_f32_16x16x32_bf16 a[76:79], a[216:219], a[172:175], a[156:159]
ds_read_b128 a[168:171], v2 offset:12160
buffer_load_dwordx4 a[216:219], v1, s[16:19], s34 offen offset:1024 sc1
v_mfma_f32_16x16x32_bf16 a[72:75], a[212:215], a[172:175], a[152:155]
v_cvt_pk_bf16_f32 v204, v14, v15
v_cvt_pk_bf16_f32 v192, v16, v17
v_mfma_f32_16x16x32_bf16 a[68:71], a[208:211], a[172:175], a[148:151]
buffer_load_dwordx4 a[212:215], v1, s[16:19], s34 offen offset:2048 sc1
v_cvt_pk_bf16_f32 v196, v168, v169
v_mfma_f32_16x16x32_bf16 a[64:67], a[204:207], a[172:175], a[144:147]
v_lshlrev_b32 v168, 16, v160
v_and_b32 v169, s38, v160
v_mfma_f32_16x16x32_bf16 a[60:63], v[68:71], a[172:175], a[140:143]
s_waitcnt vmcnt(32)
buffer_load_dwordx4 a[208:211], v1, s[16:19], s34 offen offset:3072 sc1
s_add_u32 s34, s34, 4096
M a[60:63],a[220:223],a[176:179]
ds_read_b128 a[172:175], v3 offset:12160
v_sub_f32 v176, v168, v18
M a[64:67],a[224:227],a[176:179]
buffer_load_dwordx4 a[204:207], v1, s[16:19], s34 offen offset:0 sc1
s_add_u32 s34, s34, 1024
M a[68:71],a[228:231],a[176:179]
v_sub_f32 v177, v169, v19
v_sub_f32 v14, v176, v16
M a[72:75],a[232:235],a[176:179]
s_waitcnt lgkmcnt(5)
buffer_load_dwordx4 v[68:71], v1, s[16:19], s34 offen offset:0 sc1
v_sub_f32 v15, v177, v17
M a[52:55],a[232:235],a[180:183]
ds_read_b128 a[176:179], v5 offset:12160
v_cvt_pk_bf16_f32 v200, v14, v15
M a[48:51],a[228:231],a[180:183]
v_lshlrev_b32 v14, 16, v125
v_and_b32 v15, s38, v125
M a[44:47],a[224:227],a[180:183]
v_lshlrev_b32 v16, 16, v157
v_and_b32 v17, s38, v157
M a[40:43],a[220:223],a[180:183]
v_lshlrev_b32 v18, 16, v101
v_and_b32 v19, s38, v101
M a[20:23],a[220:223],a[184:187]
ds_read_b128 a[180:183], v4 offset:12160
v_sub_f32 v170, v170, v14
M a[24:27],a[224:227],a[184:187]
v_sub_f32 v171, v171, v15
v_sub_f32 v186, v186, v170
M a[28:31],a[228:231],a[184:187]
v_sub_f32 v187, v187, v171
v_cvt_pk_bf16_f32 v97, v186, v187
M a[32:35],a[232:235],a[184:187]
s_waitcnt lgkmcnt(5)
v_sub_f32 v186, v16, v18
v_sub_f32 v187, v17, v19
M a[12:15],a[232:235],a[188:191]
ds_read_b128 a[184:187], v5 offset:2944
buffer_load_dwordx4 a[232:235], v1, s[16:19], s34 offen offset:1024 sc1
M a[8:11],a[228:231],a[188:191]
v_sub_f32 v16, v16, v14
v_sub_f32 v17, v17, v15
M a[4:7],a[224:227],a[188:191]
buffer_load_dwordx4 a[228:231], v1, s[16:19], s34 offen offset:2048 sc1
v_sub_f32 v178, v178, v16
M a[0:3],a[220:223],a[188:191]
s_waitcnt vmcnt(31)
v_sub_f32 v179, v179, v17
v_cvt_pk_bf16_f32 v125, v178, v179
M a[0:3],a[200:203],a[160:163]
ds_read_b128 a[188:191], v4 offset:2944
buffer_load_dwordx4 a[224:227], v1, s[16:19], s34 offen offset:3072 sc1
M a[4:7],a[240:243],a[160:163]
s_add_u32 s34, s34, 4096
v_sub_f32 v14, v186, v170
M a[8:11],a[244:247],a[160:163]
v_sub_f32 v15, v187, v171
v_cvt_pk_bf16_f32 v205, v14, v15
M a[12:15],a[248:251],a[160:163]
buffer_load_dwordx4 a[220:223], v1, s[16:19], s34 offen offset:0 sc1
v_cvt_pk_bf16_f32 v193, v16, v17
M a[16:19],a[252:255],a[160:163]
s_waitcnt lgkmcnt(5)
v_cvt_pk_bf16_f32 v197, v170, v171
v_lshlrev_b32 v170, 16, v161
M a[36:39],a[252:255],a[164:167]
ds_read_b128 a[160:163], v2 offset:3008
v_and_b32 v171, s38, v161
M a[32:35],a[248:251],a[164:167]
v_sub_f32 v178, v170, v18
v_sub_f32 v179, v171, v19
M a[28:31],a[244:247],a[164:167]
s_add_u32 s41, s40, 1658880
v_sub_f32 v14, v178, v16
M a[24:27],a[240:243],a[164:167]
buffer_store_dwordx4 v[224:227], v26, s[16:19], s41 offen sc1
M a[20:23],a[200:203],a[164:167]
v_sub_f32 v15, v179, v17
v_cvt_pk_bf16_f32 v201, v14, v15
M a[40:43],a[200:203],a[168:171]
ds_read_b128 a[164:167], v3 offset:3008
v_lshlrev_b32 v14, 16, v126
M a[44:47],a[240:243],a[168:171]
v_and_b32 v15, s38, v126
v_lshlrev_b32 v16, 16, v158
M a[48:51],a[244:247],a[168:171]
v_and_b32 v17, s38, v158
v_lshlrev_b32 v18, 16, v102
M a[52:55],a[248:251],a[168:171]
v_and_b32 v19, s38, v102
v_sub_f32 v172, v172, v14
M a[56:59],a[252:255],a[168:171]
s_waitcnt lgkmcnt(5)
v_sub_f32 v173, v173, v15
v_sub_f32 v188, v188, v172
M a[76:79],a[252:255],a[172:175]
ds_read_b128 a[168:171], v2 offset:12224
buffer_load_dwordx4 a[252:255], v1, s[16:19], s34 offen offset:1024 sc1
M a[72:75],a[248:251],a[172:175]
v_sub_f32 v189, v189, v173
v_cvt_pk_bf16_f32 v98, v188, v189
M a[68:71],a[244:247],a[172:175]
buffer_load_dwordx4 a[248:251], v1, s[16:19], s34 offen offset:2048 sc1
v_sub_f32 v188, v16, v18
M a[64:67],a[240:243],a[172:175]
v_sub_f32 v189, v17, v19
v_sub_f32 v16, v16, v14
M a[60:63],a[200:203],a[172:175]
s_waitcnt vmcnt(31)
buffer_load_dwordx4 a[244:247], v1, s[16:19], s34 offen offset:3072 sc1
s_add_u32 s34, s34, 4096
M a[60:63],v[48:51],a[176:179]
ds_read_b128 a[172:175], v3 offset:12224
v_sub_f32 v17, v17, v15
M a[64:67],v[44:47],a[176:179]
buffer_load_dwordx4 a[240:243], v1, s[16:19], s34 offen offset:0 sc1
s_add_u32 s34, s34, 1024
M a[68:71],v[40:43],a[176:179]
v_sub_f32 v180, v180, v16
v_sub_f32 v181, v181, v17
M a[72:75],v[36:39],a[176:179]
s_waitcnt lgkmcnt(5)
buffer_load_dwordx4 a[200:203], v1, s[16:19], s34 offen offset:0 sc1
v_cvt_pk_bf16_f32 v126, v180, v181
M a[52:55],v[36:39],a[180:183]
ds_read_b128 a[176:179], v5 offset:12224
v_sub_f32 v14, v188, v172
M a[48:51],v[40:43],a[180:183]
v_sub_f32 v15, v189, v173
v_cvt_pk_bf16_f32 v206, v14, v15
M a[44:47],v[44:47],a[180:183]
v_cvt_pk_bf16_f32 v194, v16, v17
v_cvt_pk_bf16_f32 v198, v172, v173
M a[40:43],v[48:51],a[180:183]
v_lshlrev_b32 v172, 16, v162
v_and_b32 v173, s38, v162
M a[20:23],v[48:51],a[184:187]
ds_read_b128 a[180:183], v4 offset:12224
v_sub_f32 v180, v172, v18
M a[24:27],v[44:47],a[184:187]
v_sub_f32 v181, v173, v19
v_sub_f32 v14, v180, v16
M a[28:31],v[40:43],a[184:187]
v_sub_f32 v15, v181, v17
v_cvt_pk_bf16_f32 v202, v14, v15
M a[32:35],v[36:39],a[184:187]
s_waitcnt lgkmcnt(5)
v_lshlrev_b32 v14, 16, v127
v_and_b32 v15, s38, v127
M a[12:15],v[36:39],a[188:191]
ds_read_b128 a[184:187], v5 offset:3008
buffer_load_dwordx4 v[36:39], v1, s[16:19], s34 offen offset:1024 sc1
M a[8:11],v[40:43],a[188:191]
v_lshlrev_b32 v16, 16, v159
v_and_b32 v17, s38, v159
M a[4:7],v[44:47],a[188:191]
buffer_load_dwordx4 v[40:43], v1, s[16:19], s34 offen offset:2048 sc1
v_lshlrev_b32 v18, 16, v103
M a[0:3],v[48:51],a[188:191]
s_waitcnt vmcnt(29)
v_and_b32 v19, s38, v103
v_sub_f32 v174, v174, v14
M a[0:3],a[236:239],a[160:163]
ds_read_b128 a[188:191], v4 offset:3008
buffer_load_dwordx4 v[44:47], v1, s[16:19], s34 offen offset:3072 sc1
M a[4:7],v[64:67],a[160:163]
s_add_u32 s34, s34, 4096
v_sub_f32 v175, v175, v15
M a[8:11],v[60:63],a[160:163]
v_sub_f32 v190, v190, v174
v_sub_f32 v191, v191, v175
M a[12:15],v[56:59],a[160:163]
buffer_load_dwordx4 v[48:51], v1, s[16:19], s34 offen offset:0 sc1
v_cvt_pk_bf16_f32 v99, v190, v191
M a[16:19],v[52:55],a[160:163]
s_waitcnt lgkmcnt(5)
v_sub_f32 v190, v16, v18
v_sub_f32 v191, v17, v19
M a[36:39],v[52:55],a[164:167]
ds_read_b128 a[160:163], v2 offset:3072
v_sub_f32 v16, v16, v14
M a[32:35],v[56:59],a[164:167]
v_sub_f32 v17, v17, v15
v_sub_f32 v182, v182, v16
M a[28:31],v[60:63],a[164:167]
v_sub_f32 v183, v183, v17
v_cvt_pk_bf16_f32 v127, v182, v183
M a[24:27],v[64:67],a[164:167]
v_sub_f32 v14, v190, v174
v_sub_f32 v15, v191, v175
M a[20:23],a[236:239],a[164:167]
v_cvt_pk_bf16_f32 v207, v14, v15
v_cvt_pk_bf16_f32 v195, v16, v17
M a[40:43],a[236:239],a[168:171]
ds_read_b128 a[164:167], v3 offset:3072
v_cvt_pk_bf16_f32 v199, v174, v175
M a[44:47],v[64:67],a[168:171]
v_lshlrev_b32 v174, 16, v163
v_and_b32 v175, s38, v163
M a[48:51],v[60:63],a[168:171]
v_sub_f32 v182, v174, v18
v_sub_f32 v183, v175, v19
M a[52:55],v[56:59],a[168:171]
v_sub_f32 v14, v182, v16
v_sub_f32 v15, v183, v17
M a[56:59],v[52:55],a[168:171]
s_waitcnt lgkmcnt(5)
v_cvt_pk_bf16_f32 v203, v14, v15
M a[76:79],v[52:55],a[172:175]
ds_read_b128 a[168:171], v2 offset:12288
buffer_load_dwordx4 v[52:55], v1, s[16:19], s34 offen offset:1024 sc1
M a[72:75],v[56:59],a[172:175]
ds_write_b128 v13, v[192:195] offset:0
M a[68:71],v[60:63],a[172:175]
buffer_load_dwordx4 v[56:59], v1, s[16:19], s34 offen offset:2048 sc1
M a[64:67],v[64:67],a[172:175]
ds_write_b128 v13, v[196:199] offset:22528
M a[60:63],a[236:239],a[172:175]
s_waitcnt vmcnt(28)
buffer_load_dwordx4 v[60:63], v1, s[16:19], s34 offen offset:3072 sc1
s_add_u32 s34, s34, 4096
M a[60:63],v[84:87],a[176:179]
ds_read_b128 a[172:175], v3 offset:12288
M a[64:67],v[80:83],a[176:179]
buffer_load_dwordx4 v[64:67], v1, s[16:19], s34 offen offset:0 sc1
s_add_u32 s34, s34, 1024
M a[68:71],v[76:79],a[176:179]
ds_write_b128 v13, v[200:203] offset:45056
M a[72:75],v[72:75],a[176:179]
s_waitcnt lgkmcnt(8)
buffer_load_dwordx4 a[236:239], v1, s[16:19], s34 offen offset:0 sc1
M a[52:55],v[72:75],a[180:183]
ds_read_b128 a[176:179], v5 offset:12288
M a[48:51],v[76:79],a[180:183]
ds_write_b128 v12, v[204:207] offset:0
M a[44:47],v[80:83],a[180:183]
v_add_u32 v24, 6912, v11
M a[40:43],v[84:87],a[180:183]
buffer_load_dwordx4 v[152:155], v24, s[12:15], 0 offen
v_add_u32 v24, 8064, v11
M a[20:23],v[84:87],a[184:187]
ds_read_b128 a[180:183], v4 offset:12288
buffer_load_dwordx4 v[156:159], v24, s[12:15], 0 offen
s_waitcnt vmcnt(26)
M a[24:27],v[80:83],a[184:187]
v_lshlrev_b32 v14, 16, v128
v_and_b32 v15, s38, v128
M a[28:31],v[76:79],a[184:187]
v_lshlrev_b32 v16, 16, v164
v_and_b32 v17, s38, v164
M a[32:35],v[72:75],a[184:187]
s_waitcnt lgkmcnt(9)
v_lshlrev_b32 v18, 16, v104
v_and_b32 v19, s38, v104
M a[12:15],v[72:75],a[188:191]
ds_read_b128 a[184:187], v5 offset:3072
buffer_load_dwordx4 v[72:75], v1, s[16:19], s34 offen offset:1024 sc1
M a[8:11],v[76:79],a[188:191]
v_sub_f32 v168, v168, v14
v_sub_f32 v169, v169, v15
M a[4:7],v[80:83],a[188:191]
buffer_load_dwordx4 v[76:79], v1, s[16:19], s34 offen offset:2048 sc1
v_sub_f32 v184, v184, v168
M a[0:3],v[84:87],a[188:191]
s_waitcnt vmcnt(29)
v_sub_f32 v185, v185, v169
v_cvt_pk_bf16_f32 v100, v184, v185
M a[0:3],v[32:35],a[160:163]
ds_read_b128 a[188:191], v4 offset:3072
buffer_load_dwordx4 v[80:83], v1, s[16:19], s34 offen offset:3072 sc1
M a[4:7],a[196:199],a[160:163]
s_add_u32 s34, s34, 4096
v_sub_f32 v184, v16, v18
M a[8:11],a[192:195],a[160:163]
v_sub_f32 v185, v17, v19
v_sub_f32 v16, v16, v14
M a[12:15],v[92:95],a[160:163]
buffer_load_dwordx4 v[84:87], v1, s[16:19], s34 offen offset:0 sc1
v_sub_f32 v17, v17, v15
M a[16:19],v[88:91],a[160:163]
s_waitcnt lgkmcnt(9)
v_sub_f32 v176, v176, v16
v_sub_f32 v177, v177, v17
M a[36:39],v[88:91],a[164:167]
ds_read_b128 a[160:163], v6 offset:3136
v_cvt_pk_bf16_f32 v128, v176, v177
M a[32:35],v[92:95],a[164:167]
v_sub_f32 v14, v184, v168
v_sub_f32 v15, v185, v169
M a[28:31],a[192:195],a[164:167]
s_add_u32 s41, s40, 1824768
v_cvt_pk_bf16_f32 v204, v14, v15
M a[24:27],a[196:199],a[164:167]
buffer_store_dwordx4 v[228:231], v26, s[16:19], s41 offen sc1
M a[20:23],v[32:35],a[164:167]
v_cvt_pk_bf16_f32 v192, v16, v17
v_cvt_pk_bf16_f32 v196, v168, v169
M a[40:43],v[32:35],a[168:171]
ds_read_b128 a[164:167], v7 offset:3136
v_lshlrev_b32 v168, 16, v148
M a[44:47],a[196:199],a[168:171]
v_and_b32 v169, s38, v148
v_sub_f32 v176, v168, v18
M a[48:51],a[192:195],a[168:171]
v_sub_f32 v177, v169, v19
v_sub_f32 v14, v176, v16
M a[52:55],v[92:95],a[168:171]
v_sub_f32 v15, v177, v17
v_cvt_pk_bf16_f32 v200, v14, v15
M a[56:59],v[88:91],a[168:171]
s_waitcnt lgkmcnt(6)
v_lshlrev_b32 v14, 16, v129
v_and_b32 v15, s38, v129
M a[76:79],v[88:91],a[172:175]
ds_read_b128 a[168:171], v6 offset:12352
buffer_load_dwordx4 v[88:91], v1, s[16:19], s34 offen offset:1024 sc1
M a[72:75],v[92:95],a[172:175]
v_lshlrev_b32 v16, 16, v165
v_and_b32 v17, s38, v165
M a[68:71],a[192:195],a[172:175]
buffer_load_dwordx4 v[92:95], v1, s[16:19], s34 offen offset:2048 sc1
v_lshlrev_b32 v18, 16, v105
M a[64:67],a[196:199],a[172:175]
v_and_b32 v19, s38, v105
v_sub_f32 v170, v170, v14
M a[60:63],v[32:35],a[172:175]
s_waitcnt vmcnt(29)
buffer_load_dwordx4 a[192:195], v1, s[16:19], s34 offen offset:3072 sc1
s_add_u32 s34, s34, 4096
M a[60:63],a[216:219],a[176:179]
ds_read_b128 a[172:175], v7 offset:12352
v_sub_f32 v171, v171, v15
M a[64:67],a[212:215],a[176:179]
buffer_load_dwordx4 a[196:199], v1, s[16:19], s34 offen offset:0 sc1
s_add_u32 s34, s34, 1024
M a[68:71],a[208:211],a[176:179]
v_sub_f32 v186, v186, v170
v_sub_f32 v187, v187, v171
M a[72:75],a[204:207],a[176:179]
s_waitcnt lgkmcnt(5)
buffer_load_dwordx4 v[32:35], v1, s[16:19], s34 offen offset:0 sc1
v_cvt_pk_bf16_f32 v101, v186, v187
M a[52:55],a[204:207],a[180:183]
ds_read_b128 a[176:179], v9 offset:12352
v_sub_f32 v186, v16, v18
M a[48:51],a[208:211],a[180:183]
v_sub_f32 v187, v17, v19
v_sub_f32 v16, v16, v14
M a[44:47],a[212:215],a[180:183]
v_sub_f32 v17, v17, v15
v_sub_f32 v178, v178, v16
M a[40:43],a[216:219],a[180:183]
v_sub_f32 v179, v179, v17
v_cvt_pk_bf16_f32 v129, v178, v179
M a[20:23],a[216:219],a[184:187]
ds_read_b128 a[180:183], v8 offset:12352
v_sub_f32 v14, v186, v170
M a[24:27],a[212:215],a[184:187]
v_sub_f32 v15, v187, v171
v_cvt_pk_bf16_f32 v205, v14, v15
M a[28:31],a[208:211],a[184:187]
v_cvt_pk_bf16_f32 v193, v16, v17
v_cvt_pk_bf16_f32 v197, v170, v171
M a[32:35],a[204:207],a[184:187]
s_waitcnt lgkmcnt(5)
v_lshlrev_b32 v170, 16, v149
v_and_b32 v171, s38, v149
M a[12:15],a[204:207],a[188:191]
ds_read_b128 a[184:187], v9 offset:3136
buffer_load_dwordx4 a[204:207], v1, s[16:19], s34 offen offset:1024 sc1
M a[8:11],a[208:211],a[188:191]
v_sub_f32 v178, v170, v18
v_sub_f32 v179, v171, v19
M a[4:7],a[212:215],a[188:191]
buffer_load_dwordx4 a[208:211], v1, s[16:19], s34 offen offset:2048 sc1
v_sub_f32 v14, v178, v16
M a[0:3],a[216:219],a[188:191]
s_waitcnt vmcnt(29)
v_sub_f32 v15, v179, v17
v_cvt_pk_bf16_f32 v201, v14, v15
M a[0:3],v[68:71],a[160:163]
ds_read_b128 a[188:191], v8 offset:3136
buffer_load_dwordx4 a[212:215], v1, s[16:19], s34 offen offset:3072 sc1
M a[4:7],a[232:235],a[160:163]
s_add_u32 s34, s34, 4096
v_lshlrev_b32 v14, 16, v130
M a[8:11],a[228:231],a[160:163]
v_and_b32 v15, s38, v130
v_lshlrev_b32 v16, 16, v166
M a[12:15],a[224:227],a[160:163]
buffer_load_dwordx4 a[216:219], v1, s[16:19], s34 offen offset:0 sc1
v_and_b32 v17, s38, v166
M a[16:19],a[220:223],a[160:163]
s_waitcnt lgkmcnt(5)
v_lshlrev_b32 v18, 16, v106
v_and_b32 v19, s38, v106
M a[36:39],a[220:223],a[164:167]
ds_read_b128 a[160:163], v2 offset:2336
v_sub_f32 v172, v172, v14
M a[32:35],a[224:227],a[164:167]
v_sub_f32 v173, v173, v15
v_sub_f32 v188, v188, v172
M a[28:31],a[228:231],a[164:167]
v_sub_f32 v189, v189, v173
v_cvt_pk_bf16_f32 v102, v188, v189
M a[24:27],a[232:235],a[164:167]
v_sub_f32 v188, v16, v18
v_sub_f32 v189, v17, v19
M a[20:23],v[68:71],a[164:167]
v_sub_f32 v16, v16, v14
v_sub_f32 v17, v17, v15
M a[40:43],v[68:71],a[168:171]
ds_read_b128 a[164:167], v3 offset:2336
v_sub_f32 v180, v180, v16
M a[44:47],a[232:235],a[168:171]
v_sub_f32 v181, v181, v17
v_cvt_pk_bf16_f32 v130, v180, v181
M a[48:51],a[228:231],a[168:171]
v_sub_f32 v14, v188, v172
v_sub_f32 v15, v189, v173
M a[52:55],a[224:227],a[168:171]
v_cvt_pk_bf16_f32 v206, v14, v15
v_cvt_pk_bf16_f32 v194, v16, v17
M a[56:59],a[220:223],a[168:171]
s_waitcnt lgkmcnt(5)
v_cvt_pk_bf16_f32 v198, v172, v173
v_lshlrev_b32 v172, 16, v150
M a[76:79],a[220:223],a[172:175]
ds_read_b128 a[168:171], v2 offset:11552
buffer_load_dwordx4 a[220:223], v1, s[16:19], s34 offen offset:1024 sc1
M a[72:75],a[224:227],a[172:175]
v_and_b32 v173, s38, v150
v_sub_f32 v180, v172, v18
M a[68:71],a[228:231],a[172:175]
buffer_load_dwordx4 a[224:227], v1, s[16:19], s34 offen offset:2048 sc1
v_sub_f32 v181, v173, v19
M a[64:67],a[232:235],a[172:175]
v_sub_f32 v14, v180, v16
v_sub_f32 v15, v181, v17
M a[60:63],v[68:71],a[172:175]
s_waitcnt vmcnt(28)
buffer_load_dwordx4 a[228:231], v1, s[16:19], s34 offen offset:3072 sc1
s_add_u32 s34, s34, 4096
M a[60:63],a[252:255],a[176:179]
ds_read_b128 a[172:175], v3 offset:11552
v_cvt_pk_bf16_f32 v202, v14, v15
M a[64:67],a[248:251],a[176:179]
buffer_load_dwordx4 a[232:235], v1, s[16:19], s34 offen offset:0 sc1
s_add_u32 s34, s34, 1024
M a[68:71],a[244:247],a[176:179]
v_lshlrev_b32 v14, 16, v131
v_and_b32 v15, s38, v131
M a[72:75],a[240:243],a[176:179]
s_waitcnt lgkmcnt(5)
buffer_load_dwordx4 v[68:71], v1, s[16:19], s34 offen offset:0 sc1
v_lshlrev_b32 v16, 16, v167
M a[52:55],a[240:243],a[180:183]
ds_read_b128 a[176:179], v5 offset:11552
v_and_b32 v17, s38, v167
M a[48:51],a[244:247],a[180:183]
v_lshlrev_b32 v18, 16, v107
v_and_b32 v19, s38, v107
M a[44:47],a[248:251],a[180:183]
v_sub_f32 v174, v174, v14
v_sub_f32 v175, v175, v15
M a[40:43],a[252:255],a[180:183]
v_sub_f32 v190, v190, v174
v_sub_f32 v191, v191, v175
M a[20:23],a[252:255],a[184:187]
ds_read_b128 a[180:183], v4 offset:11552
v_cvt_pk_bf16_f32 v103, v190, v191
M a[24:27],a[248:251],a[184:187]
v_sub_f32 v190, v16, v18
v_sub_f32 v191, v17, v19
M a[28:31],a[244:247],a[184:187]
v_sub_f32 v16, v16, v14
v_sub_f32 v17, v17, v15
M a[32:35],a[240:243],a[184:187]
s_waitcnt lgkmcnt(5)
v_sub_f32 v182, v182, v16
v_sub_f32 v183, v183, v17
M a[12:15],a[240:243],a[188:191]
ds_read_b128 a[184:187], v5 offset:2336
buffer_load_dwordx4 a[240:243], v1, s[16:19], s34 offen offset:1024 sc1
M a[8:11],a[244:247],a[188:191]
v_cvt_pk_bf16_f32 v131, v182, v183
v_sub_f32 v14, v190, v174
M a[4:7],a[248:251],a[188:191]
buffer_load_dwordx4 a[244:247], v1, s[16:19], s34 offen offset:2048 sc1
v_sub_f32 v15, v191, v175
M a[0:3],a[252:255],a[188:191]
s_waitcnt vmcnt(28)
v_cvt_pk_bf16_f32 v207, v14, v15
v_cvt_pk_bf16_f32 v195, v16, v17
M a[0:3],a[200:203],a[160:163]
ds_read_b128 a[188:191], v4 offset:2336
buffer_load_dwordx4 a[248:251], v1, s[16:19], s34 offen offset:3072 sc1
M a[4:7],v[36:39],a[160:163]
s_add_u32 s34, s34, 4096
v_cvt_pk_bf16_f32 v199, v174, v175
M a[8:11],v[40:43],a[160:163]
v_lshlrev_b32 v174, 16, v151
v_and_b32 v175, s38, v151
M a[12:15],v[44:47],a[160:163]
buffer_load_dwordx4 a[252:255], v1, s[16:19], s34 offen offset:0 sc1
v_sub_f32 v182, v174, v18
M a[16:19],v[48:51],a[160:163]
s_waitcnt lgkmcnt(5)
v_sub_f32 v183, v175, v19
v_sub_f32 v14, v182, v16
M a[36:39],v[48:51],a[164:167]
ds_read_b128 a[160:163], v2 offset:2400
v_sub_f32 v15, v183, v17
M a[32:35],v[44:47],a[164:167]
v_cvt_pk_bf16_f32 v203, v14, v15
M a[28:31],v[40:43],a[164:167]
ds_write_b128 v13, v[192:195] offset:576
M a[24:27],v[36:39],a[164:167]
ds_write_b128 v13, v[196:199] offset:23104
M a[20:23],a[200:203],a[164:167]
ds_write_b128 v13, v[200:203] offset:45632
M a[40:43],a[200:203],a[168:171]
ds_read_b128 a[164:167], v3 offset:2400
M a[44:47],v[36:39],a[168:171]
ds_write_b128 v12, v[204:207] offset:576
M a[48:51],v[40:43],a[168:171]
v_add_u32 v24, 9216, v11
M a[52:55],v[44:47],a[168:171]
buffer_load_dwordx4 v[160:163], v24, s[12:15], 0 offen
v_add_u32 v24, 10368, v11
M a[56:59],v[48:51],a[168:171]
s_waitcnt lgkmcnt(9)
buffer_load_dwordx4 v[164:167], v24, s[12:15], 0 offen
s_waitcnt vmcnt(25)
v_lshlrev_b32 v14, 16, v132
M a[76:79],v[48:51],a[172:175]
ds_read_b128 a[168:171], v2 offset:11616
buffer_load_dwordx4 v[48:51], v1, s[16:19], s34 offen offset:1024 sc1
M a[72:75],v[44:47],a[172:175]
v_and_b32 v15, s38, v132
v_lshlrev_b32 v16, 16, v152
M a[68:71],v[40:43],a[172:175]
buffer_load_dwordx4 v[44:47], v1, s[16:19], s34 offen offset:2048 sc1
v_and_b32 v17, s38, v152
M a[64:67],v[36:39],a[172:175]
v_lshlrev_b32 v18, 16, v108
v_and_b32 v19, s38, v108
M a[60:63],a[200:203],a[172:175]
s_waitcnt vmcnt(30)
buffer_load_dwordx4 v[40:43], v1, s[16:19], s34 offen offset:3072 sc1
s_add_u32 s34, s34, 4096
M a[60:63],v[52:55],a[176:179]
ds_read_b128 a[172:175], v3 offset:11616
v_sub_f32 v168, v168, v14
M a[64:67],v[56:59],a[176:179]
buffer_load_dwordx4 v[36:39], v1, s[16:19], s34 offen offset:0 sc1
s_add_u32 s34, s34, 1024
M a[68:71],v[60:63],a[176:179]
v_sub_f32 v169, v169, v15
v_sub_f32 v184, v184, v168
M a[72:75],v[64:67],a[176:179]
s_waitcnt lgkmcnt(9)
buffer_load_dwordx4 a[200:203], v1, s[16:19], s34 offen offset:0 sc1
v_sub_f32 v185, v185, v169
M a[52:55],v[64:67],a[180:183]
ds_read_b128 a[176:179], v5 offset:11616
v_cvt_pk_bf16_f32 v104, v184, v185
M a[48:51],v[60:63],a[180:183]
v_sub_f32 v184, v16, v18
v_sub_f32 v185, v17, v19
M a[44:47],v[56:59],a[180:183]
v_sub_f32 v16, v16, v14
v_sub_f32 v17, v17, v15
M a[40:43],v[52:55],a[180:183]
v_sub_f32 v176, v176, v16
v_sub_f32 v177, v177, v17
M a[20:23],v[52:55],a[184:187]
ds_read_b128 a[180:183], v4 offset:11616
v_cvt_pk_bf16_f32 v132, v176, v177
M a[24:27],v[56:59],a[184:187]
v_sub_f32 v14, v184, v168
v_sub_f32 v15, v185, v169
M a[28:31],v[60:63],a[184:187]
v_cvt_pk_bf16_f32 v204, v14, v15
v_cvt_pk_bf16_f32 v192, v16, v17
M a[32:35],v[64:67],a[184:187]
s_waitcnt lgkmcnt(9)
v_cvt_pk_bf16_f32 v196, v168, v169
v_lshlrev_b32 v168, 16, v156
M a[12:15],v[64:67],a[188:191]
ds_read_b128 a[184:187], v5 offset:2400
buffer_load_dwordx4 v[64:67], v1, s[16:19], s34 offen offset:1024 sc1
M a[8:11],v[60:63],a[188:191]
v_and_b32 v169, s38, v156
v_sub_f32 v176, v168, v18
M a[4:7],v[56:59],a[188:191]
buffer_load_dwordx4 v[60:63], v1, s[16:19], s34 offen offset:2048 sc1
v_sub_f32 v177, v169, v19
M a[0:3],v[52:55],a[188:191]
s_waitcnt vmcnt(28)
v_sub_f32 v14, v176, v16
v_sub_f32 v15, v177, v17
M a[0:3],a[236:239],a[160:163]
ds_read_b128 a[188:191], v4 offset:2400
buffer_load_dwordx4 v[56:59], v1, s[16:19], s34 offen offset:3072 sc1
M a[4:7],v[72:75],a[160:163]
s_add_u32 s34, s34, 4096
v_cvt_pk_bf16_f32 v200, v14, v15
M a[8:11],v[76:79],a[160:163]
v_lshlrev_b32 v14, 16, v133
v_and_b32 v15, s38, v133
M a[12:15],v[80:83],a[160:163]
buffer_load_dwordx4 v[52:55], v1, s[16:19], s34 offen offset:0 sc1
v_lshlrev_b32 v16, 16, v153
M a[16:19],v[84:87],a[160:163]
s_waitcnt lgkmcnt(5)
v_and_b32 v17, s38, v153
v_lshlrev_b32 v18, 16, v109
M a[36:39],v[84:87],a[164:167]
ds_read_b128 a[160:163], v2 offset:2464
v_and_b32 v19, s38, v109
M a[32:35],v[80:83],a[164:167]
v_sub_f32 v170, v170, v14
v_sub_f32 v171, v171, v15
M a[28:31],v[76:79],a[164:167]
v_sub_f32 v186, v186, v170
v_sub_f32 v187, v187, v171
M a[24:27],v[72:75],a[164:167]
v_cvt_pk_bf16_f32 v105, v186, v187
v_sub_f32 v186, v16, v18
M a[20:23],a[236:239],a[164:167]
v_sub_f32 v187, v17, v19
v_sub_f32 v16, v16, v14
M a[40:43],a[236:239],a[168:171]
ds_read_b128 a[164:167], v3 offset:2464
v_sub_f32 v17, v17, v15
M a[44:47],v[72:75],a[168:171]
v_sub_f32 v178, v178, v16
v_sub_f32 v179, v179, v17
M a[48:51],v[76:79],a[168:171]
v_cvt_pk_bf16_f32 v133, v178, v179
v_sub_f32 v14, v186, v170
M a[52:55],v[80:83],a[168:171]
v_sub_f32 v15, v187, v171
v_cvt_pk_bf16_f32 v205, v14, v15
M a[56:59],v[84:87],a[168:171]
s_waitcnt lgkmcnt(5)
v_cvt_pk_bf16_f32 v193, v16, v17
v_cvt_pk_bf16_f32 v197, v170, v171
M a[76:79],v[84:87],a[172:175]
ds_read_b128 a[168:171], v2 offset:11680
buffer_load_dwordx4 v[84:87], v1, s[16:19], s34 offen offset:1024 sc1
M a[72:75],v[80:83],a[172:175]
v_lshlrev_b32 v170, 16, v157
v_and_b32 v171, s38, v157
M a[68:71],v[76:79],a[172:175]
buffer_load_dwordx4 v[80:83], v1, s[16:19], s34 offen offset:2048 sc1
v_sub_f32 v178, v170, v18
M a[64:67],v[72:75],a[172:175]
v_sub_f32 v179, v171, v19
v_sub_f32 v14, v178, v16
M a[60:63],a[236:239],a[172:175]
s_waitcnt vmcnt(27)
buffer_load_dwordx4 v[76:79], v1, s[16:19], s34 offen offset:3072 sc1
s_add_u32 s34, s34, 4096
M a[60:63],v[88:91],a[176:179]
ds_read_b128 a[172:175], v3 offset:11680
v_sub_f32 v15, v179, v17
M a[64:67],v[92:95],a[176:179]
buffer_load_dwordx4 v[72:75], v1, s[16:19], s34 offen offset:0 sc1
s_add_u32 s34, s34, 1024
M a[68:71],a[192:195],a[176:179]
v_cvt_pk_bf16_f32 v201, v14, v15
v_lshlrev_b32 v14, 16, v134
M a[72:75],a[196:199],a[176:179]
s_waitcnt lgkmcnt(5)
buffer_load_dwordx4 a[236:239], v1, s[16:19], s34 offen offset:0 sc1
v_and_b32 v15, s38, v134
M a[52:55],a[196:199],a[180:183]
ds_read_b128 a[176:179], v5 offset:11680
v_lshlrev_b32 v16, 16, v154
M a[48:51],a[192:195],a[180:183]
v_and_b32 v17, s38, v154
v_lshlrev_b32 v18, 16, v110
M a[44:47],v[92:95],a[180:183]
v_and_b32 v19, s38, v110
v_sub_f32 v172, v172, v14
M a[40:43],v[88:91],a[180:183]
v_sub_f32 v173, v173, v15
v_sub_f32 v188, v188, v172
M a[20:23],v[88:91],a[184:187]
ds_read_b128 a[180:183], v4 offset:11680
v_sub_f32 v189, v189, v173
M a[24:27],v[92:95],a[184:187]
v_cvt_pk_bf16_f32 v106, v188, v189
v_sub_f32 v188, v16, v18
M a[28:31],a[192:195],a[184:187]
v_sub_f32 v189, v17, v19
v_sub_f32 v16, v16, v14
M a[32:35],a[196:199],a[184:187]
s_waitcnt lgkmcnt(5)
v_sub_f32 v17, v17, v15
v_sub_f32 v180, v180, v16
M a[12:15],a[196:199],a[188:191]
ds_read_b128 a[184:187], v5 offset:2464
buffer_load_dwordx4 a[196:199], v1, s[16:19], s34 offen offset:1024 sc1
M a[8:11],a[192:195],a[188:191]
v_sub_f32 v181, v181, v17
v_cvt_pk_bf16_f32 v134, v180, v181
M a[4:7],v[92:95],a[188:191]
buffer_load_dwordx4 a[192:195], v1, s[16:19], s34 offen offset:2048 sc1
v_sub_f32 v14, v188, v172
M a[0:3],v[88:91],a[188:191]
s_waitcnt vmcnt(27)
s_waitcnt vmcnt(36)
s_barrier
v_sub_f32 v15, v189, v173
v_cvt_pk_bf16_f32 v206, v14, v15
M a[0:3],v[32:35],a[160:163]
ds_read_b128 a[188:191], v4 offset:2464
buffer_load_dwordx4 v[92:95], v1, s[16:19], s34 offen offset:3072 sc1
M a[4:7],a[204:207],a[160:163]
s_add_u32 s34, s34, 4096
v_cvt_pk_bf16_f32 v194, v16, v17
M a[8:11],a[208:211],a[160:163]
buffer_store_dword v29, v28, s[16:19], s7 offen sc1
M a[12:15],a[212:215],a[160:163]
buffer_load_dwordx4 v[88:91], v1, s[16:19], s34 offen offset:0 sc1
v_cvt_pk_bf16_f32 v198, v172, v173
M a[16:19],a[216:219],a[160:163]
s_waitcnt lgkmcnt(5)
v_lshlrev_b32 v172, 16, v158
v_and_b32 v173, s38, v158
M a[36:39],a[216:219],a[164:167]
ds_read_b128 a[160:163], v2 offset:2528
v_sub_f32 v180, v172, v18
M a[32:35],a[212:215],a[164:167]
v_sub_f32 v181, v173, v19
v_sub_f32 v14, v180, v16
M a[28:31],a[208:211],a[164:167]
v_sub_f32 v15, v181, v17
v_cvt_pk_bf16_f32 v202, v14, v15
M a[24:27],a[204:207],a[164:167]
v_lshlrev_b32 v14, 16, v135
v_and_b32 v15, s38, v135
M a[20:23],v[32:35],a[164:167]
v_lshlrev_b32 v16, 16, v155
v_and_b32 v17, s38, v155
M a[40:43],v[32:35],a[168:171]
ds_read_b128 a[164:167], v3 offset:2528
v_lshlrev_b32 v18, 16, v111
M a[44:47],a[204:207],a[168:171]
v_and_b32 v19, s38, v111
v_sub_f32 v174, v174, v14
M a[48:51],a[208:211],a[168:171]
v_sub_f32 v175, v175, v15
v_sub_f32 v190, v190, v174
M a[52:55],a[212:215],a[168:171]
v_sub_f32 v191, v191, v175
v_cvt_pk_bf16_f32 v107, v190, v191
M a[56:59],a[216:219],a[168:171]
s_waitcnt lgkmcnt(5)
v_sub_f32 v190, v16, v18
v_sub_f32 v191, v17, v19
M a[76:79],a[216:219],a[172:175]
ds_read_b128 a[168:171], v2 offset:11744
buffer_load_dwordx4 a[216:219], v1, s[16:19], s34 offen offset:1024 sc1
M a[72:75],a[212:215],a[172:175]
v_sub_f32 v16, v16, v14
v_sub_f32 v17, v17, v15
M a[68:71],a[208:211],a[172:175]
buffer_load_dwordx4 a[212:215], v1, s[16:19], s34 offen offset:2048 sc1
v_sub_f32 v182, v182, v16
M a[64:67],a[204:207],a[172:175]
v_sub_f32 v183, v183, v17
v_cvt_pk_bf16_f32 v135, v182, v183
M a[60:63],v[32:35],a[172:175]
s_waitcnt vmcnt(28)
buffer_load_dwordx4 a[208:211], v1, s[16:19], s34 offen offset:3072 sc1
s_add_u32 s34, s34, 4096
M a[60:63],a[220:223],a[176:179]
ds_read_b128 a[172:175], v3 offset:11744
v_sub_f32 v14, v190, v174
M a[64:67],a[224:227],a[176:179]
buffer_load_dwordx4 a[204:207], v1, s[16:19], s34 offen offset:0 sc1
s_add_u32 s34, s34, 1024
M a[68:71],a[228:231],a[176:179]
v_sub_f32 v15, v191, v175
v_cvt_pk_bf16_f32 v207, v14, v15
M a[72:75],a[232:235],a[176:179]
s_waitcnt lgkmcnt(5)
buffer_load_dwordx4 v[32:35], v1, s[16:19], s34 offen offset:0 sc1
v_cvt_pk_bf16_f32 v195, v16, v17
M a[52:55],a[232:235],a[180:183]
ds_read_b128 a[176:179], v5 offset:11744
v_cvt_pk_bf16_f32 v199, v174, v175
M a[48:51],a[228:231],a[180:183]
v_lshlrev_b32 v174, 16, v159
v_and_b32 v175, s38, v159
M a[44:47],a[224:227],a[180:183]
v_sub_f32 v182, v174, v18
v_sub_f32 v183, v175, v19
M a[40:43],a[220:223],a[180:183]
v_sub_f32 v14, v182, v16
v_sub_f32 v15, v183, v17
M a[20:23],a[220:223],a[184:187]
ds_read_b128 a[180:183], v4 offset:11744
v_cvt_pk_bf16_f32 v203, v14, v15
M a[24:27],a[224:227],a[184:187]
ds_write_b128 v13, v[192:195] offset:1152
M a[28:31],a[228:231],a[184:187]
ds_write_b128 v13, v[196:199] offset:23680
M a[32:35],a[232:235],a[184:187]
s_waitcnt lgkmcnt(7)
ds_write_b128 v13, v[200:203] offset:46208
M a[12:15],a[232:235],a[188:191]
ds_read_b128 a[184:187], v5 offset:2528
buffer_load_dwordx4 a[232:235], v1, s[16:19], s34 offen offset:1024 sc1
M a[8:11],a[228:231],a[188:191]
ds_write_b128 v12, v[204:207] offset:1152
M a[4:7],a[224:227],a[188:191]
buffer_load_dwordx4 a[228:231], v1, s[16:19], s34 offen offset:2048 sc1
v_add_u32 v24, 11520, v11
M a[0:3],a[220:223],a[188:191]
s_waitcnt vmcnt(28)
buffer_load_dwordx4 v[148:151], v24, s[12:15], 0 offen
v_add_u32 v24, 12672, v11
M a[0:3],v[68:71],a[160:163]
ds_read_b128 a[188:191], v4 offset:2528
buffer_load_dwordx4 a[224:227], v1, s[16:19], s34 offen offset:3072 sc1
M a[4:7],a[240:243],a[160:163]
v_add_u32 v2, s10, v2
v_add_u32 v3, s10, v3
M a[8:11],a[244:247],a[160:163]
v_add_u32 v4, s10, v4
v_add_u32 v5, s10, v5
M a[12:15],a[248:251],a[160:163]
v_add_u32 v6, s10, v6
v_add_u32 v7, s10, v7
M a[16:19],a[252:255],a[160:163]
s_waitcnt lgkmcnt(9)
v_add_u32 v8, s10, v8
v_add_u32 v9, s10, v9
M a[36:39],a[252:255],a[164:167]
ds_read_b128 a[160:163], v2 offset:2880
s_add_u32 s34, s34, 4096
M a[32:35],a[248:251],a[164:167]
buffer_load_dwordx4 v[152:155], v24, s[12:15], 0 offen
s_waitcnt vmcnt(29)
v_lshlrev_b32 v14, 16, v136
M a[28:31],a[244:247],a[164:167]
buffer_load_dwordx4 a[220:223], v1, s[16:19], s34 offen offset:0 sc1
v_and_b32 v15, s38, v136
M a[24:27],a[240:243],a[164:167]
v_lshlrev_b32 v16, 16, v160
v_and_b32 v17, s38, v160
M a[20:23],v[68:71],a[164:167]
v_lshlrev_b32 v18, 16, v112
v_and_b32 v19, s38, v112
M a[40:43],v[68:71],a[168:171]
ds_read_b128 a[164:167], v3 offset:2880
v_sub_f32 v168, v168, v14
M a[44:47],a[240:243],a[168:171]
v_sub_f32 v169, v169, v15
v_sub_f32 v184, v184, v168
M a[48:51],a[244:247],a[168:171]
v_sub_f32 v185, v185, v169
v_cvt_pk_bf16_f32 v108, v184, v185
M a[52:55],a[248:251],a[168:171]
v_sub_f32 v184, v16, v18
v_sub_f32 v185, v17, v19
M a[56:59],a[252:255],a[168:171]
s_waitcnt lgkmcnt(9)
v_sub_f32 v16, v16, v14
v_sub_f32 v17, v17, v15
M a[76:79],a[252:255],a[172:175]
ds_read_b128 a[168:171], v2 offset:12096
buffer_load_dwordx4 a[252:255], v1, s[16:19], s34 offen offset:1024 sc1
M a[72:75],a[248:251],a[172:175]
v_sub_f32 v176, v176, v16
v_sub_f32 v177, v177, v17
M a[68:71],a[244:247],a[172:175]
buffer_load_dwordx4 a[248:251], v1, s[16:19], s34 offen offset:2048 sc1
v_cvt_pk_bf16_f32 v136, v176, v177
M a[64:67],a[240:243],a[172:175]
v_sub_f32 v14, v184, v168
v_sub_f32 v15, v185, v169
M a[60:63],v[68:71],a[172:175]
s_waitcnt vmcnt(28)
buffer_load_dwordx4 a[244:247], v1, s[16:19], s34 offen offset:3072 sc1
s_add_u32 s34, s34, 4096
M a[60:63],v[48:51],a[176:179]
ds_read_b128 a[172:175], v3 offset:12096
v_cvt_pk_bf16_f32 v204, v14, v15
M a[64:67],v[44:47],a[176:179]
buffer_load_dwordx4 a[240:243], v1, s[16:19], s34 offen offset:0 sc1
s_add_u32 s34, s34, 1024
M a[68:71],v[40:43],a[176:179]
v_cvt_pk_bf16_f32 v192, v16, v17
v_cvt_pk_bf16_f32 v196, v168, v169
M a[72:75],v[36:39],a[176:179]
s_waitcnt lgkmcnt(6)
buffer_load_dwordx4 v[68:71], v1, s[16:19], s34 offen offset:0 sc1
v_lshlrev_b32 v168, 16, v164
M a[52:55],v[36:39],a[180:183]
ds_read_b128 a[176:179], v5 offset:12096
v_and_b32 v169, s38, v164
M a[48:51],v[40:43],a[180:183]
v_sub_f32 v176, v168, v18
v_sub_f32 v177, v169, v19
M a[44:47],v[44:47],a[180:183]
v_sub_f32 v14, v176, v16
v_sub_f32 v15, v177, v17
M a[40:43],v[48:51],a[180:183]
v_cvt_pk_bf16_f32 v200, v14, v15
v_lshlrev_b32 v14, 16, v137
M a[20:23],v[48:51],a[184:187]
ds_read_b128 a[180:183], v4 offset:12096
v_and_b32 v15, s38, v137
M a[24:27],v[44:47],a[184:187]
v_lshlrev_b32 v16, 16, v161
v_and_b32 v17, s38, v161
M a[28:31],v[40:43],a[184:187]
v_lshlrev_b32 v18, 16, v113
v_and_b32 v19, s38, v113
M a[32:35],v[36:39],a[184:187]
s_waitcnt lgkmcnt(5)
v_sub_f32 v170, v170, v14
v_sub_f32 v171, v171, v15
M a[12:15],v[36:39],a[188:191]
ds_read_b128 a[184:187], v5 offset:2880
buffer_load_dwordx4 v[36:39], v1, s[16:19], s34 offen offset:1024 sc1
M a[8:11],v[40:43],a[188:191]
v_sub_f32 v186, v186, v170
v_sub_f32 v187, v187, v171
M a[4:7],v[44:47],a[188:191]
buffer_load_dwordx4 v[40:43], v1, s[16:19], s34 offen offset:2048 sc1
v_cvt_pk_bf16_f32 v109, v186, v187
M a[0:3],v[48:51],a[188:191]
s_waitcnt vmcnt(28)
v_sub_f32 v186, v16, v18
v_sub_f32 v187, v17, v19
M a[80:83],a[200:203],a[160:163]
ds_read_b128 a[188:191], v4 offset:2880
buffer_load_dwordx4 v[44:47], v1, s[16:19], s34 offen offset:3072 sc1
M a[84:87],v[64:67],a[160:163]
s_add_u32 s34, s34, 4096
v_sub_f32 v16, v16, v14
M a[88:91],v[60:63],a[160:163]
v_sub_f32 v17, v17, v15
v_sub_f32 v178, v178, v16
M a[92:95],v[56:59],a[160:163]
buffer_load_dwordx4 v[48:51], v1, s[16:19], s34 offen offset:0 sc1
v_sub_f32 v179, v179, v17
M a[96:99],v[52:55],a[160:163]
s_waitcnt lgkmcnt(5)
v_cvt_pk_bf16_f32 v137, v178, v179
v_sub_f32 v14, v186, v170
M a[116:119],v[52:55],a[164:167]
ds_read_b128 a[160:163], v2 offset:2944
v_sub_f32 v15, v187, v171
M a[112:115],v[56:59],a[164:167]
v_cvt_pk_bf16_f32 v205, v14, v15
v_cvt_pk_bf16_f32 v193, v16, v17
M a[108:111],v[60:63],a[164:167]
v_cvt_pk_bf16_f32 v197, v170, v171
v_lshlrev_b32 v170, 16, v165
M a[104:107],v[64:67],a[164:167]
v_and_b32 v171, s38, v165
v_sub_f32 v178, v170, v18
M a[100:103],a[200:203],a[164:167]
v_sub_f32 v179, v171, v19
v_sub_f32 v14, v178, v16
M a[120:123],a[200:203],a[168:171]
ds_read_b128 a[164:167], v3 offset:2944
v_sub_f32 v15, v179, v17
M a[124:127],v[64:67],a[168:171]
v_cvt_pk_bf16_f32 v201, v14, v15
v_lshlrev_b32 v14, 16, v138
M a[128:131],v[60:63],a[168:171]
v_and_b32 v15, s38, v138
v_lshlrev_b32 v16, 16, v162
M a[132:135],v[56:59],a[168:171]
v_and_b32 v17, s38, v162
v_lshlrev_b32 v18, 16, v114
M a[136:139],v[52:55],a[168:171]
s_waitcnt lgkmcnt(5)
v_and_b32 v19, s38, v114
v_sub_f32 v172, v172, v14
M a[156:159],v[52:55],a[172:175]
ds_read_b128 a[168:171], v2 offset:12160
buffer_load_dwordx4 v[52:55], v1, s[16:19], s34 offen offset:1024 sc1
M a[152:155],v[56:59],a[172:175]
v_sub_f32 v173, v173, v15
v_sub_f32 v188, v188, v172
M a[148:151],v[60:63],a[172:175]
buffer_load_dwordx4 v[56:59], v1, s[16:19], s34 offen offset:2048 sc1
v_sub_f32 v189, v189, v173
M a[144:147],v[64:67],a[172:175]
v_cvt_pk_bf16_f32 v110, v188, v189
v_sub_f32 v188, v16, v18
M a[140:143],a[200:203],a[172:175]
s_waitcnt vmcnt(28)
buffer_load_dwordx4 v[60:63], v1, s[16:19], s34 offen offset:3072 sc1
s_add_u32 s34, s34, 4096
M a[140:143],v[84:87],a[176:179]
ds_read_b128 a[172:175], v3 offset:12160
v_sub_f32 v189, v17, v19
M a[144:147],v[80:83],a[176:179]
buffer_load_dwordx4 v[64:67], v1, s[16:19], s34 offen offset:0 sc1
s_add_u32 s34, s34, 1024
M a[148:151],v[76:79],a[176:179]
v_sub_f32 v16, v16, v14
v_sub_f32 v17, v17, v15
M a[152:155],v[72:75],a[176:179]
s_waitcnt lgkmcnt(5)
buffer_load_dwordx4 a[200:203], v1, s[16:19], s34 offen offset:0 sc1
v_sub_f32 v180, v180, v16
M a[132:135],v[72:75],a[180:183]
ds_read_b128 a[176:179], v5 offset:12160
v_sub_f32 v181, v181, v17
M a[128:131],v[76:79],a[180:183]
v_cvt_pk_bf16_f32 v138, v180, v181
v_sub_f32 v14, v188, v172
M a[124:127],v[80:83],a[180:183]
v_sub_f32 v15, v189, v173
v_cvt_pk_bf16_f32 v206, v14, v15
M a[120:123],v[84:87],a[180:183]
v_cvt_pk_bf16_f32 v194, v16, v17
v_cvt_pk_bf16_f32 v198, v172, v173
M a[100:103],v[84:87],a[184:187]
ds_read_b128 a[180:183], v4 offset:12160
v_lshlrev_b32 v172, 16, v166
M a[104:107],v[80:83],a[184:187]
v_and_b32 v173, s38, v166
v_sub_f32 v180, v172, v18
M a[108:111],v[76:79],a[184:187]
v_sub_f32 v181, v173, v19
v_sub_f32 v14, v180, v16
M a[112:115],v[72:75],a[184:187]
s_waitcnt lgkmcnt(5)
v_sub_f32 v15, v181, v17
v_cvt_pk_bf16_f32 v202, v14, v15
M a[92:95],v[72:75],a[188:191]
ds_read_b128 a[184:187], v5 offset:2944
buffer_load_dwordx4 v[72:75], v1, s[16:19], s34 offen offset:1024 sc1
M a[88:91],v[76:79],a[188:191]
v_lshlrev_b32 v14, 16, v139
v_and_b32 v15, s38, v139
M a[84:87],v[80:83],a[188:191]
buffer_load_dwordx4 v[76:79], v1, s[16:19], s34 offen offset:2048 sc1
v_lshlrev_b32 v16, 16, v163
M a[80:83],v[84:87],a[188:191]
s_waitcnt vmcnt(27)
v_and_b32 v17, s38, v163
v_lshlrev_b32 v18, 16, v115
M a[80:83],a[236:239],a[160:163]
ds_read_b128 a[188:191], v4 offset:2944
buffer_load_dwordx4 v[80:83], v1, s[16:19], s34 offen offset:3072 sc1
M a[84:87],a[196:199],a[160:163]
s_add_u32 s34, s34, 4096
v_and_b32 v19, s38, v115
M a[88:91],a[192:195],a[160:163]
v_sub_f32 v174, v174, v14
v_sub_f32 v175, v175, v15
M a[92:95],v[92:95],a[160:163]
buffer_load_dwordx4 v[84:87], v1, s[16:19], s34 offen offset:0 sc1
v_sub_f32 v190, v190, v174
M a[96:99],v[88:91],a[160:163]
s_waitcnt lgkmcnt(5)
v_sub_f32 v191, v191, v175
v_cvt_pk_bf16_f32 v111, v190, v191
M a[116:119],v[88:91],a[164:167]
ds_read_b128 a[160:163], v2 offset:3008
v_sub_f32 v190, v16, v18
M a[112:115],v[92:95],a[164:167]
v_sub_f32 v191, v17, v19
v_sub_f32 v16, v16, v14
M a[108:111],a[192:195],a[164:167]
v_sub_f32 v17, v17, v15
v_sub_f32 v182, v182, v16
M a[104:107],a[196:199],a[164:167]
v_sub_f32 v183, v183, v17
v_cvt_pk_bf16_f32 v139, v182, v183
M a[100:103],a[236:239],a[164:167]
v_sub_f32 v14, v190, v174
v_sub_f32 v15, v191, v175
M a[120:123],a[236:239],a[168:171]
ds_read_b128 a[164:167], v3 offset:3008
v_cvt_pk_bf16_f32 v207, v14, v15
M a[124:127],a[196:199],a[168:171]
v_cvt_pk_bf16_f32 v195, v16, v17
v_cvt_pk_bf16_f32 v199, v174, v175
M a[128:131],a[192:195],a[168:171]
v_lshlrev_b32 v174, 16, v167
v_and_b32 v175, s38, v167
M a[132:135],v[92:95],a[168:171]
v_sub_f32 v182, v174, v18
v_sub_f32 v183, v175, v19
M a[136:139],v[88:91],a[168:171]
s_waitcnt lgkmcnt(5)
v_sub_f32 v14, v182, v16
v_sub_f32 v15, v183, v17
M a[156:159],v[88:91],a[172:175]
ds_read_b128 a[168:171], v2 offset:12224
buffer_load_dwordx4 v[88:91], v1, s[16:19], s34 offen offset:1024 sc1
M a[152:155],v[92:95],a[172:175]
v_cvt_pk_bf16_f32 v203, v14, v15
M a[148:151],a[192:195],a[172:175]
buffer_load_dwordx4 v[92:95], v1, s[16:19], s34 offen offset:2048 sc1
M a[144:147],a[196:199],a[172:175]
ds_write_b128 v13, v[192:195] offset:1728
M a[140:143],a[236:239],a[172:175]
s_waitcnt vmcnt(27)
buffer_load_dwordx4 a[192:195], v1, s[16:19], s34 offen offset:3072 sc1
s_add_u32 s34, s34, 4096
M a[140:143],a[216:219],a[176:179]
ds_read_b128 a[172:175], v3 offset:12224
M a[144:147],a[212:215],a[176:179]
buffer_load_dwordx4 a[196:199], v1, s[16:19], s34 offen offset:0 sc1
s_add_u32 s34, s34, 1024
M a[148:151],a[208:211],a[176:179]
ds_write_b128 v13, v[196:199] offset:24256
M a[152:155],a[204:207],a[176:179]
s_waitcnt lgkmcnt(7)
buffer_load_dwordx4 a[236:239], v1, s[16:19], s34 offen offset:0 sc1
M a[132:135],a[204:207],a[180:183]
ds_read_b128 a[176:179], v5 offset:12224
M a[128:131],a[208:211],a[180:183]
ds_write_b128 v13, v[200:203] offset:46784
M a[124:127],a[212:215],a[180:183]
ds_write_b128 v12, v[204:207] offset:1728
M a[120:123],a[216:219],a[180:183]
v_add_u32 v24, 13824, v11
M a[100:103],a[216:219],a[184:187]
ds_read_b128 a[180:183], v4 offset:12224
buffer_load_dwordx4 v[156:159], v24, s[12:15], 0 offen
M a[104:107],a[212:215],a[184:187]
v_add_u32 v24, 14976, v11
M a[108:111],a[208:211],a[184:187]
buffer_load_dwordx4 v[160:163], v24, s[12:15], 0 offen
s_waitcnt vmcnt(26)
v_lshlrev_b32 v14, 16, v140
M a[112:115],a[204:207],a[184:187]
s_waitcnt lgkmcnt(9)
v_and_b32 v15, s38, v140
v_lshlrev_b32 v16, 16, v148
M a[92:95],a[204:207],a[188:191]
ds_read_b128 a[184:187], v5 offset:3008
buffer_load_dwordx4 a[204:207], v1, s[16:19], s34 offen offset:1024 sc1
M a[88:91],a[208:211],a[188:191]
v_and_b32 v17, s38, v148
v_lshlrev_b32 v18, 16, v116
M a[84:87],a[212:215],a[188:191]
buffer_load_dwordx4 a[208:211], v1, s[16:19], s34 offen offset:2048 sc1
v_and_b32 v19, s38, v116
M a[80:83],a[216:219],a[188:191]
s_waitcnt vmcnt(27)
v_sub_f32 v168, v168, v14
v_sub_f32 v169, v169, v15
M a[80:83],v[32:35],a[160:163]
ds_read_b128 a[188:191], v4 offset:3008
buffer_load_dwordx4 a[212:215], v1, s[16:19], s34 offen offset:3072 sc1
M a[84:87],a[232:235],a[160:163]
s_add_u32 s34, s34, 4096
v_sub_f32 v184, v184, v168
M a[88:91],a[228:231],a[160:163]
v_sub_f32 v185, v185, v169
v_cvt_pk_bf16_f32 v112, v184, v185
M a[92:95],a[224:227],a[160:163]
buffer_load_dwordx4 a[216:219], v1, s[16:19], s34 offen offset:0 sc1
v_sub_f32 v184, v16, v18
M a[96:99],a[220:223],a[160:163]
s_waitcnt lgkmcnt(9)
v_sub_f32 v185, v17, v19
v_sub_f32 v16, v16, v14
M a[116:119],a[220:223],a[164:167]
ds_read_b128 a[160:163], v2 offset:3072
v_sub_f32 v17, v17, v15
M a[112:115],a[224:227],a[164:167]
v_sub_f32 v176, v176, v16
v_sub_f32 v177, v177, v17
M a[108:111],a[228:231],a[164:167]
v_cvt_pk_bf16_f32 v140, v176, v177
v_sub_f32 v14, v184, v168
M a[104:107],a[232:235],a[164:167]
v_sub_f32 v15, v185, v169
v_cvt_pk_bf16_f32 v204, v14, v15
M a[100:103],v[32:35],a[164:167]
v_cvt_pk_bf16_f32 v192, v16, v17
v_cvt_pk_bf16_f32 v196, v168, v169
M a[120:123],v[32:35],a[168:171]
ds_read_b128 a[164:167], v3 offset:3072
v_lshlrev_b32 v168, 16, v152
M a[124:127],a[232:235],a[168:171]
v_and_b32 v169, s38, v152
v_sub_f32 v176, v168, v18
M a[128:131],a[228:231],a[168:171]
v_sub_f32 v177, v169, v19
v_sub_f32 v14, v176, v16
M a[132:135],a[224:227],a[168:171]
v_sub_f32 v15, v177, v17
v_cvt_pk_bf16_f32 v200, v14, v15
M a[136:139],a[220:223],a[168:171]
s_waitcnt lgkmcnt(7)
v_lshlrev_b32 v14, 16, v141
v_and_b32 v15, s38, v141
M a[156:159],a[220:223],a[172:175]
ds_read_b128 a[168:171], v2 offset:12288
buffer_load_dwordx4 a[220:223], v1, s[16:19], s34 offen offset:1024 sc1
M a[152:155],a[224:227],a[172:175]
v_lshlrev_b32 v16, 16, v149
v_and_b32 v17, s38, v149
M a[148:151],a[228:231],a[172:175]
buffer_load_dwordx4 a[224:227], v1, s[16:19], s34 offen offset:2048 sc1
v_lshlrev_b32 v18, 16, v117
M a[144:147],a[232:235],a[172:175]
v_and_b32 v19, s38, v117
v_sub_f32 v170, v170, v14
M a[140:143],v[32:35],a[172:175]
s_waitcnt vmcnt(27)
buffer_load_dwordx4 a[228:231], v1, s[16:19], s34 offen offset:3072 sc1
s_add_u32 s34, s34, 4096
M a[140:143],a[252:255],a[176:179]
ds_read_b128 a[172:175], v3 offset:12288
v_sub_f32 v171, v171, v15
M a[144:147],a[248:251],a[176:179]
buffer_load_dwordx4 a[232:235], v1, s[16:19], s34 offen offset:0 sc1
s_add_u32 s34, s34, 1024
M a[148:151],a[244:247],a[176:179]
v_sub_f32 v186, v186, v170
v_sub_f32 v187, v187, v171
M a[152:155],a[240:243],a[176:179]
s_waitcnt lgkmcnt(5)
buffer_load_dwordx4 v[32:35], v1, s[16:19], s34 offen offset:0 sc1
v_cvt_pk_bf16_f32 v113, v186, v187
M a[132:135],a[240:243],a[180:183]
ds_read_b128 a[176:179], v5 offset:12288
v_sub_f32 v186, v16, v18
M a[128:131],a[244:247],a[180:183]
v_sub_f32 v187, v17, v19
v_sub_f32 v16, v16, v14
M a[124:127],a[248:251],a[180:183]
v_sub_f32 v17, v17, v15
v_sub_f32 v178, v178, v16
M a[120:123],a[252:255],a[180:183]
v_sub_f32 v179, v179, v17
v_cvt_pk_bf16_f32 v141, v178, v179
M a[100:103],a[252:255],a[184:187]
ds_read_b128 a[180:183], v4 offset:12288
v_sub_f32 v14, v186, v170
M a[104:107],a[248:251],a[184:187]
v_sub_f32 v15, v187, v171
v_cvt_pk_bf16_f32 v205, v14, v15
M a[108:111],a[244:247],a[184:187]
v_cvt_pk_bf16_f32 v193, v16, v17
v_cvt_pk_bf16_f32 v197, v170, v171
M a[112:115],a[240:243],a[184:187]
s_waitcnt lgkmcnt(5)
v_lshlrev_b32 v170, 16, v153
v_and_b32 v171, s38, v153
M a[92:95],a[240:243],a[188:191]
ds_read_b128 a[184:187], v5 offset:3072
buffer_load_dwordx4 a[240:243], v1, s[16:19], s34 offen offset:1024 sc1
M a[88:91],a[244:247],a[188:191]
v_sub_f32 v178, v170, v18
v_sub_f32 v179, v171, v19
M a[84:87],a[248:251],a[188:191]
buffer_load_dwordx4 a[244:247], v1, s[16:19], s34 offen offset:2048 sc1
v_sub_f32 v14, v178, v16
M a[80:83],a[252:255],a[188:191]
s_waitcnt vmcnt(27)
v_sub_f32 v15, v179, v17
v_cvt_pk_bf16_f32 v201, v14, v15
M a[80:83],v[68:71],a[160:163]
ds_read_b128 a[188:191], v4 offset:3072
buffer_load_dwordx4 a[248:251], v1, s[16:19], s34 offen offset:3072 sc1
M a[84:87],v[36:39],a[160:163]
s_add_u32 s34, s34, 4096
v_lshlrev_b32 v14, 16, v142
M a[88:91],v[40:43],a[160:163]
v_and_b32 v15, s38, v142
v_lshlrev_b32 v16, 16, v150
M a[92:95],v[44:47],a[160:163]
buffer_load_dwordx4 a[252:255], v1, s[16:19], s34 offen offset:0 sc1
v_and_b32 v17, s38, v150
M a[96:99],v[48:51],a[160:163]
s_waitcnt lgkmcnt(5)
v_lshlrev_b32 v18, 16, v118
v_and_b32 v19, s38, v118
M a[116:119],v[48:51],a[164:167]
ds_read_b128 a[160:163], v6 offset:3136
v_sub_f32 v172, v172, v14
M a[112:115],v[44:47],a[164:167]
v_sub_f32 v173, v173, v15
v_sub_f32 v188, v188, v172
M a[108:111],v[40:43],a[164:167]
v_sub_f32 v189, v189, v173
v_cvt_pk_bf16_f32 v114, v188, v189
M a[104:107],v[36:39],a[164:167]
v_sub_f32 v188, v16, v18
v_sub_f32 v189, v17, v19
M a[100:103],v[68:71],a[164:167]
buffer_load_dwordx4 v[20:23], v1, s[16:19], s46 offen sc1
v_sub_f32 v16, v16, v14
M a[120:123],v[68:71],a[168:171]
ds_read_b128 a[164:167], v7 offset:3136
v_sub_f32 v17, v17, v15
M a[124:127],v[36:39],a[168:171]
v_sub_f32 v180, v180, v16
v_sub_f32 v181, v181, v17
M a[128:131],v[40:43],a[168:171]
v_cvt_pk_bf16_f32 v142, v180, v181
v_sub_f32 v14, v188, v172
M a[132:135],v[44:47],a[168:171]
v_sub_f32 v15, v189, v173
v_cvt_pk_bf16_f32 v206, v14, v15
M a[136:139],v[48:51],a[168:171]
s_waitcnt lgkmcnt(5)
v_cvt_pk_bf16_f32 v194, v16, v17
v_cvt_pk_bf16_f32 v198, v172, v173
M a[156:159],v[48:51],a[172:175]
ds_read_b128 a[168:171], v6 offset:12352
buffer_load_dwordx4 v[48:51], v1, s[16:19], s34 offen offset:1024 sc1
M a[152:155],v[44:47],a[172:175]
v_lshlrev_b32 v172, 16, v154
v_and_b32 v173, s38, v154
M a[148:151],v[40:43],a[172:175]
buffer_load_dwordx4 v[44:47], v1, s[16:19], s34 offen offset:2048 sc1
v_sub_f32 v180, v172, v18
M a[144:147],v[36:39],a[172:175]
v_sub_f32 v181, v173, v19
v_sub_f32 v14, v180, v16
M a[140:143],v[68:71],a[172:175]
s_waitcnt vmcnt(28)
buffer_load_dwordx4 v[40:43], v1, s[16:19], s34 offen offset:3072 sc1
s_add_u32 s34, s34, 4096
M a[140:143],v[52:55],a[176:179]
ds_read_b128 a[172:175], v7 offset:12352
v_sub_f32 v15, v181, v17
M a[144:147],v[56:59],a[176:179]
buffer_load_dwordx4 v[36:39], v1, s[16:19], s34 offen offset:0 sc1
s_add_u32 s34, s34, 1024
M a[148:151],v[60:63],a[176:179]
v_cvt_pk_bf16_f32 v202, v14, v15
v_lshlrev_b32 v14, 16, v143
M a[152:155],v[64:67],a[176:179]
s_waitcnt lgkmcnt(5)
buffer_load_dwordx4 v[68:71], v1, s[16:19], s34 offen offset:0 sc1
v_and_b32 v15, s38, v143
M a[132:135],v[64:67],a[180:183]
ds_read_b128 a[176:179], v9 offset:12352
v_lshlrev_b32 v16, 16, v151
M a[128:131],v[60:63],a[180:183]
v_and_b32 v17, s38, v151
v_lshlrev_b32 v18, 16, v119
M a[124:127],v[56:59],a[180:183]
v_and_b32 v19, s38, v119
v_sub_f32 v174, v174, v14
M a[120:123],v[52:55],a[180:183]
v_sub_f32 v175, v175, v15
v_sub_f32 v190, v190, v174
M a[100:103],v[52:55],a[184:187]
ds_read_b128 a[180:183], v8 offset:12352
v_sub_f32 v191, v191, v175
M a[104:107],v[56:59],a[184:187]
v_cvt_pk_bf16_f32 v115, v190, v191
v_sub_f32 v190, v16, v18
M a[108:111],v[60:63],a[184:187]
v_sub_f32 v191, v17, v19
v_sub_f32 v16, v16, v14
M a[112:115],v[64:67],a[184:187]
s_waitcnt lgkmcnt(5)
v_sub_f32 v17, v17, v15
v_sub_f32 v182, v182, v16
M a[92:95],v[64:67],a[188:191]
ds_read_b128 a[184:187], v9 offset:3136
buffer_load_dwordx4 v[64:67], v1, s[16:19], s34 offen offset:1024 sc1
M a[88:91],v[60:63],a[188:191]
v_sub_f32 v183, v183, v17
v_cvt_pk_bf16_f32 v143, v182, v183
M a[84:87],v[56:59],a[188:191]
buffer_load_dwordx4 v[60:63], v1, s[16:19], s34 offen offset:2048 sc1
v_sub_f32 v14, v190, v174
M a[80:83],v[52:55],a[188:191]
s_waitcnt vmcnt(28)
v_sub_f32 v15, v191, v175
v_cvt_pk_bf16_f32 v207, v14, v15
M a[80:83],a[200:203],a[160:163]
ds_read_b128 a[188:191], v8 offset:3136
buffer_load_dwordx4 v[56:59], v1, s[16:19], s34 offen offset:3072 sc1
M a[84:87],v[72:75],a[160:163]
s_add_u32 s34, s34, 4096
v_cvt_pk_bf16_f32 v195, v16, v17
M a[88:91],v[76:79],a[160:163]
v_cvt_pk_bf16_f32 v199, v174, v175
v_lshlrev_b32 v174, 16, v155
M a[92:95],v[80:83],a[160:163]
buffer_load_dwordx4 v[52:55], v1, s[16:19], s34 offen offset:0 sc1
v_and_b32 v175, s38, v155
M a[96:99],v[84:87],a[160:163]
s_waitcnt lgkmcnt(5)
v_sub_f32 v182, v174, v18
v_sub_f32 v183, v175, v19
M a[116:119],v[84:87],a[164:167]
ds_read_b128 a[160:163], v2 offset:2336
v_sub_f32 v14, v182, v16
M a[112:115],v[80:83],a[164:167]
v_sub_f32 v15, v183, v17
v_cvt_pk_bf16_f32 v203, v14, v15
M a[108:111],v[76:79],a[164:167]
ds_write_b128 v13, v[192:195] offset:2304
M a[104:107],v[72:75],a[164:167]
ds_write_b128 v13, v[196:199] offset:24832
M a[100:103],a[200:203],a[164:167]
ds_write_b128 v13, v[200:203] offset:47360
M a[120:123],a[200:203],a[168:171]
ds_read_b128 a[164:167], v3 offset:2336
M a[124:127],v[72:75],a[168:171]
ds_write_b128 v12, v[204:207] offset:2304
M a[128:131],v[76:79],a[168:171]
s_waitcnt vmcnt(23)
v_lshlrev_b32 v14, 16, v144
v_and_b32 v15, s38, v144
M a[132:135],v[80:83],a[168:171]
v_lshlrev_b32 v16, 16, v156
v_and_b32 v17, s38, v156
M a[136:139],v[84:87],a[168:171]
s_waitcnt lgkmcnt(9)
v_lshlrev_b32 v18, 16, v120
v_and_b32 v19, s38, v120
M a[156:159],v[84:87],a[172:175]
ds_read_b128 a[168:171], v2 offset:11552
buffer_load_dwordx4 v[84:87], v1, s[16:19], s34 offen offset:1024 sc1
M a[152:155],v[80:83],a[172:175]
v_sub_f32 v168, v168, v14
v_sub_f32 v169, v169, v15
M a[148:151],v[76:79],a[172:175]
buffer_load_dwordx4 v[80:83], v1, s[16:19], s34 offen offset:2048 sc1
v_sub_f32 v184, v184, v168
M a[144:147],v[72:75],a[172:175]
v_sub_f32 v185, v185, v169
v_cvt_pk_bf16_f32 v116, v184, v185
M a[140:143],a[200:203],a[172:175]
s_waitcnt vmcnt(28)
buffer_load_dwordx4 v[76:79], v1, s[16:19], s34 offen offset:3072 sc1
s_add_u32 s34, s34, 4096
M a[140:143],v[88:91],a[176:179]
ds_read_b128 a[172:175], v3 offset:11552
v_sub_f32 v184, v16, v18
M a[144:147],v[92:95],a[176:179]
buffer_load_dwordx4 v[72:75], v1, s[16:19], s34 offen offset:0 sc1
s_add_u32 s34, s34, 1024
M a[148:151],a[192:195],a[176:179]
v_sub_f32 v185, v17, v19
v_sub_f32 v16, v16, v14
M a[152:155],a[196:199],a[176:179]
s_waitcnt lgkmcnt(9)
buffer_load_dwordx4 a[200:203], v1, s[16:19], s34 offen offset:0 sc1
v_sub_f32 v17, v17, v15
M a[132:135],a[196:199],a[180:183]
ds_read_b128 a[176:179], v5 offset:11552
v_sub_f32 v176, v176, v16
M a[128:131],a[192:195],a[180:183]
v_sub_f32 v177, v177, v17
v_cvt_pk_bf16_f32 v144, v176, v177
M a[124:127],v[92:95],a[180:183]
v_sub_f32 v14, v184, v168
v_sub_f32 v15, v185, v169
M a[120:123],v[88:91],a[180:183]
v_cvt_pk_bf16_f32 v204, v14, v15
v_cvt_pk_bf16_f32 v192, v16, v17
M a[100:103],v[88:91],a[184:187]
ds_read_b128 a[180:183], v4 offset:11552
v_cvt_pk_bf16_f32 v196, v168, v169
M a[104:107],v[92:95],a[184:187]
s_waitcnt vmcnt(14)
v_xor_b32 v20, s62, v20
v_xor_b32 v21, s62, v21
M a[108:111],a[192:195],a[184:187]
v_xor_b32 v22, s62, v22
v_xor_b32 v23, s62, v23
M a[112:115],a[196:199],a[184:187]
s_waitcnt lgkmcnt(9)
v_or3_b32 v20, v20, v21, v22
v_or_b32 v20, v20, v23
M a[92:95],a[196:199],a[188:191]
ds_read_b128 a[184:187], v5 offset:2336
buffer_load_dwordx4 a[196:199], v1, s[16:19], s34 offen offset:1024 sc1
M a[88:91],a[192:195],a[188:191]
v_cmp_ne_u32 s[4:5], 0, v20
v_lshlrev_b32 v168, 16, v160
M a[84:87],v[92:95],a[188:191]
buffer_load_dwordx4 a[192:195], v1, s[16:19], s34 offen offset:2048 sc1
v_and_b32 v169, s38, v160
M a[80:83],v[88:91],a[188:191]
s_waitcnt vmcnt(26)
s_and_b32 s5, s5, 0x7fffffff
v_sub_f32 v176, v168, v18
M a[80:83],a[236:239],a[160:163]
ds_read_b128 a[188:191], v4 offset:2336
buffer_load_dwordx4 v[92:95], v1, s[16:19], s34 offen offset:3072 sc1
M a[84:87],a[204:207],a[160:163]
s_add_u32 s34, s34, 4096
v_sub_f32 v177, v169, v19
M a[88:91],a[208:211],a[160:163]
s_cmp_lg_u64 s[4:5], 0
s_cbranch_scc1 L_sl2
L_sl2_ret:
M a[92:95],a[212:215],a[160:163]
buffer_load_dwordx4 v[88:91], v1, s[16:19], s34 offen offset:0 sc1
v_sub_f32 v14, v176, v16
M a[96:99],a[216:219],a[160:163]
s_waitcnt lgkmcnt(5)
v_sub_f32 v15, v177, v17
v_cvt_pk_bf16_f32 v200, v14, v15
M a[116:119],a[216:219],a[164:167]
ds_read_b128 a[160:163], v2 offset:2400
v_lshlrev_b32 v14, 16, v145
M a[112:115],a[212:215],a[164:167]
v_and_b32 v15, s38, v145
v_lshlrev_b32 v16, 16, v157
M a[108:111],a[208:211],a[164:167]
v_and_b32 v17, s38, v157
v_lshlrev_b32 v18, 16, v121
M a[104:107],a[204:207],a[164:167]
v_and_b32 v19, s38, v121
v_sub_f32 v170, v170, v14
M a[100:103],a[236:239],a[164:167]
v_sub_f32 v171, v171, v15
v_sub_f32 v186, v186, v170
M a[120:123],a[236:239],a[168:171]
ds_read_b128 a[164:167], v3 offset:2400
v_sub_f32 v187, v187, v171
M a[124:127],a[204:207],a[168:171]
v_cvt_pk_bf16_f32 v117, v186, v187
v_sub_f32 v186, v16, v18
M a[128:131],a[208:211],a[168:171]
v_sub_f32 v187, v17, v19
v_sub_f32 v16, v16, v14
M a[132:135],a[212:215],a[168:171]
v_sub_f32 v17, v17, v15
v_sub_f32 v178, v178, v16
M a[136:139],a[216:219],a[168:171]
s_waitcnt lgkmcnt(5)
v_sub_f32 v179, v179, v17
v_cvt_pk_bf16_f32 v145, v178, v179
M a[156:159],a[216:219],a[172:175]
ds_read_b128 a[168:171], v2 offset:11616
buffer_load_dwordx4 a[216:219], v1, s[16:19], s34 offen offset:1024 sc1
M a[152:155],a[212:215],a[172:175]
v_sub_f32 v14, v186, v170
v_sub_f32 v15, v187, v171
M a[148:151],a[208:211],a[172:175]
buffer_load_dwordx4 a[212:215], v1, s[16:19], s34 offen offset:2048 sc1
v_cvt_pk_bf16_f32 v205, v14, v15
M a[144:147],a[204:207],a[172:175]
v_cvt_pk_bf16_f32 v193, v16, v17
v_cvt_pk_bf16_f32 v197, v170, v171
M a[140:143],a[236:239],a[172:175]
s_waitcnt vmcnt(26)
buffer_load_dwordx4 a[208:211], v1, s[16:19], s34 offen offset:3072 sc1
s_add_u32 s34, s34, 4096
M a[140:143],a[220:223],a[176:179]
ds_read_b128 a[172:175], v3 offset:11616
v_lshlrev_b32 v170, 16, v161
M a[144:147],a[224:227],a[176:179]
buffer_load_dwordx4 a[204:207], v1, s[16:19], s34 offen offset:0 sc1
s_add_u32 s34, s34, 1024
M a[148:151],a[228:231],a[176:179]
v_and_b32 v171, s38, v161
v_sub_f32 v178, v170, v18
M a[152:155],a[232:235],a[176:179]
s_waitcnt lgkmcnt(5)
buffer_load_dwordx4 a[236:239], v1, s[16:19], s34 offen offset:0 sc1
v_sub_f32 v179, v171, v19
M a[132:135],a[232:235],a[180:183]
ds_read_b128 a[176:179], v5 offset:11616
v_sub_f32 v14, v178, v16
M a[128:131],a[228:231],a[180:183]
v_sub_f32 v15, v179, v17
v_cvt_pk_bf16_f32 v201, v14, v15
M a[124:127],a[224:227],a[180:183]
v_lshlrev_b32 v14, 16, v146
v_and_b32 v15, s38, v146
M a[120:123],a[220:223],a[180:183]
v_lshlrev_b32 v16, 16, v158
v_and_b32 v17, s38, v158
M a[100:103],a[220:223],a[184:187]
ds_read_b128 a[180:183], v4 offset:11616
v_lshlrev_b32 v18, 16, v122
M a[104:107],a[224:227],a[184:187]
v_and_b32 v19, s38, v122
v_sub_f32 v172, v172, v14
M a[108:111],a[228:231],a[184:187]
v_sub_f32 v173, v173, v15
v_sub_f32 v188, v188, v172
M a[112:115],a[232:235],a[184:187]
s_waitcnt lgkmcnt(5)
v_sub_f32 v189, v189, v173
v_cvt_pk_bf16_f32 v118, v188, v189
M a[92:95],a[232:235],a[188:191]
ds_read_b128 a[184:187], v5 offset:2400
buffer_load_dwordx4 a[232:235], v1, s[16:19], s34 offen offset:1024 sc1
M a[88:91],a[228:231],a[188:191]
v_sub_f32 v188, v16, v18
v_sub_f32 v189, v17, v19
M a[84:87],a[224:227],a[188:191]
buffer_load_dwordx4 a[228:231], v1, s[16:19], s34 offen offset:2048 sc1
v_sub_f32 v16, v16, v14
M a[80:83],a[220:223],a[188:191]
s_waitcnt vmcnt(26)
v_sub_f32 v17, v17, v15
v_sub_f32 v180, v180, v16
M a[80:83],v[32:35],a[160:163]
ds_read_b128 a[188:191], v4 offset:2400
buffer_load_dwordx4 a[224:227], v1, s[16:19], s34 offen offset:3072 sc1
M a[84:87],a[240:243],a[160:163]
s_add_u32 s34, s34, 4096
v_sub_f32 v181, v181, v17
M a[88:91],a[244:247],a[160:163]
v_cvt_pk_bf16_f32 v146, v180, v181
v_sub_f32 v14, v188, v172
M a[92:95],a[248:251],a[160:163]
buffer_load_dwordx4 a[220:223], v1, s[16:19], s34 offen offset:0 sc1
v_sub_f32 v15, v189, v173
M a[96:99],a[252:255],a[160:163]
s_waitcnt lgkmcnt(5)
v_cvt_pk_bf16_f32 v206, v14, v15
v_cvt_pk_bf16_f32 v194, v16, v17
M a[116:119],a[252:255],a[164:167]
ds_read_b128 a[160:163], v2 offset:2464
v_cvt_pk_bf16_f32 v198, v172, v173
M a[112:115],a[248:251],a[164:167]
v_lshlrev_b32 v172, 16, v162
v_and_b32 v173, s38, v162
M a[108:111],a[244:247],a[164:167]
v_sub_f32 v180, v172, v18
v_sub_f32 v181, v173, v19
M a[104:107],a[240:243],a[164:167]
v_sub_f32 v14, v180, v16
v_sub_f32 v15, v181, v17
M a[100:103],v[32:35],a[164:167]
v_cvt_pk_bf16_f32 v202, v14, v15
v_lshlrev_b32 v14, 16, v147
M a[120:123],v[32:35],a[168:171]
ds_read_b128 a[164:167], v3 offset:2464
v_and_b32 v15, s38, v147
M a[124:127],a[240:243],a[168:171]
v_lshlrev_b32 v16, 16, v159
v_and_b32 v17, s38, v159
M a[128:131],a[244:247],a[168:171]
v_lshlrev_b32 v18, 16, v123
v_and_b32 v19, s38, v123
M a[132:135],a[248:251],a[168:171]
v_sub_f32 v174, v174, v14
v_sub_f32 v175, v175, v15
M a[136:139],a[252:255],a[168:171]
s_waitcnt lgkmcnt(5)
v_sub_f32 v190, v190, v174
v_sub_f32 v191, v191, v175
M a[156:159],a[252:255],a[172:175]
ds_read_b128 a[168:171], v2 offset:11680
buffer_load_dwordx4 a[252:255], v1, s[16:19], s34 offen offset:1024 sc1
M a[152:155],a[248:251],a[172:175]
v_cvt_pk_bf16_f32 v119, v190, v191
v_sub_f32 v190, v16, v18
M a[148:151],a[244:247],a[172:175]
buffer_load_dwordx4 a[248:251], v1, s[16:19], s34 offen offset:2048 sc1
v_sub_f32 v191, v17, v19
M a[144:147],a[240:243],a[172:175]
v_sub_f32 v16, v16, v14
v_sub_f32 v17, v17, v15
M a[140:143],v[32:35],a[172:175]
s_waitcnt vmcnt(25)
buffer_load_dwordx4 a[244:247], v1, s[16:19], s34 offen offset:3072 sc1
s_add_u32 s34, s34, 4096
M a[140:143],v[48:51],a[176:179]
ds_read_b128 a[172:175], v3 offset:11680
v_sub_f32 v182, v182, v16
M a[144:147],v[44:47],a[176:179]
buffer_load_dwordx4 a[240:243], v1, s[16:19], s34 offen offset:0 sc1
s_add_u32 s34, s34, 1024
M a[148:151],v[40:43],a[176:179]
v_sub_f32 v183, v183, v17
v_cvt_pk_bf16_f32 v147, v182, v183
M a[152:155],v[36:39],a[176:179]
s_waitcnt lgkmcnt(5)
buffer_load_dwordx4 v[32:35], v1, s[16:19], s34 offen offset:0 sc1
v_sub_f32 v14, v190, v174
M a[132:135],v[36:39],a[180:183]
ds_read_b128 a[176:179], v5 offset:11680
v_sub_f32 v15, v191, v175
M a[128:131],v[40:43],a[180:183]
v_cvt_pk_bf16_f32 v207, v14, v15
v_cvt_pk_bf16_f32 v195, v16, v17
M a[124:127],v[44:47],a[180:183]
v_cvt_pk_bf16_f32 v199, v174, v175
v_lshlrev_b32 v174, 16, v163
M a[120:123],v[48:51],a[180:183]
v_and_b32 v175, s38, v163
v_sub_f32 v182, v174, v18
M a[100:103],v[48:51],a[184:187]
ds_read_b128 a[180:183], v4 offset:11680
v_sub_f32 v183, v175, v19
M a[104:107],v[44:47],a[184:187]
v_sub_f32 v14, v182, v16
v_sub_f32 v15, v183, v17
M a[108:111],v[40:43],a[184:187]
v_cvt_pk_bf16_f32 v203, v14, v15
M a[112:115],v[36:39],a[184:187]
s_waitcnt lgkmcnt(5)
ds_write_b128 v13, v[192:195] offset:2880
M a[92:95],v[36:39],a[188:191]
ds_read_b128 a[184:187], v5 offset:2464
buffer_load_dwordx4 v[36:39], v1, s[16:19], s34 offen offset:1024 sc1
M a[88:91],v[40:43],a[188:191]
ds_write_b128 v13, v[196:199] offset:25408
M a[84:87],v[44:47],a[188:191]
buffer_load_dwordx4 v[40:43], v1, s[16:19], s34 offen offset:2048 sc1
M a[80:83],v[48:51],a[188:191]
s_waitcnt vmcnt(25)
ds_write_b128 v13, v[200:203] offset:47936
M a[80:83],v[68:71],a[160:163]
ds_read_b128 a[188:191], v4 offset:2464
buffer_load_dwordx4 v[44:47], v1, s[16:19], s34 offen offset:3072 sc1
M a[84:87],v[64:67],a[160:163]
s_add_u32 s34, s34, 4096
M a[88:91],v[60:63],a[160:163]
ds_write_b128 v12, v[204:207] offset:2880
M a[92:95],v[56:59],a[160:163]
buffer_load_dwordx4 v[48:51], v1, s[16:19], s34 offen offset:0 sc1
M a[96:99],v[52:55],a[160:163]
s_waitcnt lgkmcnt(9)
M a[116:119],v[52:55],a[164:167]
ds_read_b128 a[160:163], v2 offset:2528
M a[112:115],v[56:59],a[164:167]
M a[108:111],v[60:63],a[164:167]
M a[104:107],v[64:67],a[164:167]
M a[100:103],v[68:71],a[164:167]
M a[120:123],v[68:71],a[168:171]
ds_read_b128 a[164:167], v3 offset:2528
M a[124:127],v[64:67],a[168:171]
M a[128:131],v[60:63],a[168:171]
M a[132:135],v[56:59],a[168:171]
M a[136:139],v[52:55],a[168:171]
s_waitcnt lgkmcnt(9)
M a[156:159],v[52:55],a[172:175]
ds_read_b128 a[168:171], v2 offset:11744
buffer_load_dwordx4 v[52:55], v1, s[16:19], s34 offen offset:1024 sc1
M a[152:155],v[56:59],a[172:175]
M a[148:151],v[60:63],a[172:175]
buffer_load_dwordx4 v[56:59], v1, s[16:19], s34 offen offset:2048 sc1
M a[144:147],v[64:67],a[172:175]
M a[140:143],v[68:71],a[172:175]
s_waitcnt vmcnt(25)
buffer_load_dwordx4 v[60:63], v1, s[16:19], s34 offen offset:3072 sc1
s_add_u32 s34, s34, 4096
M a[140:143],v[84:87],a[176:179]
ds_read_b128 a[172:175], v3 offset:11744
M a[144:147],v[80:83],a[176:179]
buffer_load_dwordx4 v[64:67], v1, s[16:19], s34 offen offset:0 sc1
s_add_u32 s34, s34, 1024
M a[148:151],v[76:79],a[176:179]
M a[152:155],v[72:75],a[176:179]
s_waitcnt lgkmcnt(8)
buffer_load_dwordx4 v[68:71], v1, s[16:19], s34 offen offset:0 sc1
M a[132:135],v[72:75],a[180:183]
ds_read_b128 a[176:179], v5 offset:11744
M a[128:131],v[76:79],a[180:183]
M a[124:127],v[80:83],a[180:183]
M a[120:123],v[84:87],a[180:183]
M a[100:103],v[84:87],a[184:187]
ds_read_b128 a[180:183], v4 offset:11744
M a[104:107],v[80:83],a[184:187]
M a[108:111],v[76:79],a[184:187]
M a[112:115],v[72:75],a[184:187]
s_waitcnt lgkmcnt(5)
M a[92:95],v[72:75],a[188:191]
ds_read_b128 a[184:187], v5 offset:2528
buffer_load_dwordx4 v[72:75], v1, s[16:19], s34 offen offset:1024 sc1
M a[88:91],v[76:79],a[188:191]
M a[84:87],v[80:83],a[188:191]
buffer_load_dwordx4 v[76:79], v1, s[16:19], s34 offen offset:2048 sc1
M a[80:83],v[84:87],a[188:191]
s_waitcnt vmcnt(25)
s_waitcnt lgkmcnt(0)
s_barrier
M a[80:83],a[200:203],a[160:163]
ds_read_b128 a[188:191], v4 offset:2528
buffer_load_dwordx4 v[80:83], v1, s[16:19], s34 offen offset:3072 sc1
M a[84:87],a[196:199],a[160:163]
v_add_u32 v2, s8, v2
v_add_u32 v3, s8, v3
M a[88:91],a[192:195],a[160:163]
v_add_u32 v4, s8, v4
v_add_u32 v5, s8, v5
M a[92:95],v[92:95],a[160:163]
v_add_u32 v6, s8, v6
v_add_u32 v7, s8, v7
M a[96:99],v[88:91],a[160:163]
s_waitcnt lgkmcnt(5)
v_add_u32 v8, s8, v8
v_add_u32 v9, s8, v9
M a[116:119],v[88:91],a[164:167]
ds_read_b128 a[160:163], v2 offset:2880
s_add_u32 s34, s34, 4096
M a[112:115],v[92:95],a[164:167]
s_mul_i32 s3, s28, 5120
s_add_u32 s3, s3, 51200
M a[108:111],a[192:195],a[164:167]
buffer_load_dwordx4 v[84:87], v1, s[16:19], s34 offen offset:0 sc1
v_add_u32 v14, s3, v1
M a[104:107],a[196:199],a[164:167]
s_xor_b32 s3, s28, 2
s_mul_i32 s3, s3, 5120
M a[100:103],a[200:203],a[164:167]
s_add_u32 s3, s3, 51200
v_add_u32 v15, s3, v1
M a[120:123],a[200:203],a[168:171]
ds_read_b128 a[164:167], v3 offset:2880
M a[124:127],a[196:199],a[168:171]
M a[128:131],a[192:195],a[168:171]
M a[132:135],v[92:95],a[168:171]
M a[136:139],v[88:91],a[168:171]
s_waitcnt lgkmcnt(5)
M a[156:159],v[88:91],a[172:175]
ds_read_b128 a[168:171], v2 offset:12096
buffer_load_dwordx4 v[88:91], v1, s[16:19], s34 offen offset:1024 sc1
M a[152:155],v[92:95],a[172:175]
M a[148:151],a[192:195],a[172:175]
buffer_load_dwordx4 v[92:95], v1, s[16:19], s34 offen offset:2048 sc1
M a[144:147],a[196:199],a[172:175]
M a[140:143],a[200:203],a[172:175]
s_waitcnt vmcnt(25)
buffer_load_dwordx4 a[192:195], v1, s[16:19], s34 offen offset:3072 sc1
s_add_u32 s34, s34, 4096
M a[140:143],a[216:219],a[176:179]
ds_read_b128 a[172:175], v3 offset:12096
M a[144:147],a[212:215],a[176:179]
buffer_load_dwordx4 a[196:199], v1, s[16:19], s34 offen offset:0 sc1
s_add_u32 s34, s34, 1024
M a[148:151],a[208:211],a[176:179]
M a[152:155],a[204:207],a[176:179]
s_waitcnt lgkmcnt(5)
buffer_load_dwordx4 a[200:203], v1, s[16:19], s34 offen offset:0 sc1
M a[132:135],a[204:207],a[180:183]
ds_read_b128 a[176:179], v5 offset:12096
M a[128:131],a[208:211],a[180:183]
M a[124:127],a[212:215],a[180:183]
M a[120:123],a[216:219],a[180:183]
ds_write_b128 v10, v[124:127] offset:0
M a[100:103],a[216:219],a[184:187]
ds_read_b128 a[180:183], v4 offset:12096
M a[104:107],a[212:215],a[184:187]
M a[108:111],a[208:211],a[184:187]
ds_write_b128 v10, v[96:99] offset:22528
M a[112:115],a[204:207],a[184:187]
s_waitcnt lgkmcnt(7)
M a[92:95],a[204:207],a[188:191]
ds_read_b128 a[184:187], v5 offset:2880
buffer_load_dwordx4 a[204:207], v1, s[16:19], s34 offen offset:1024 sc1
M a[88:91],a[208:211],a[188:191]
ds_write_b128 v10, v[128:131] offset:576
M a[84:87],a[212:215],a[188:191]
buffer_load_dwordx4 a[208:211], v1, s[16:19], s34 offen offset:2048 sc1
M a[80:83],a[216:219],a[188:191]
s_waitcnt vmcnt(25)
v_mfma_f32_16x16x32_bf16 v[176:179], a[236:239], a[160:163], 0
ds_read_b128 a[188:191], v4 offset:2880
buffer_load_dwordx4 a[212:215], v1, s[16:19], s34 offen offset:3072 sc1
v_mfma_f32_16x16x32_bf16 v[180:183], a[232:235], a[160:163], 0
s_add_u32 s34, s34, 4096
v_mfma_f32_16x16x32_bf16 v[184:187], a[228:231], a[160:163], 0
ds_write_b128 v10, v[100:103] offset:23104
v_mfma_f32_16x16x32_bf16 v[188:191], a[224:227], a[160:163], 0
buffer_load_dwordx4 a[216:219], v1, s[16:19], s34 offen offset:0 sc1
v_mfma_f32_16x16x32_bf16 v[192:195], a[220:223], a[160:163], 0
s_waitcnt lgkmcnt(9)
v_mfma_f32_16x16x32_bf16 v[212:215], a[220:223], a[164:167], 0
ds_read_b128 a[160:163], v2 offset:2944
v_mfma_f32_16x16x32_bf16 v[208:211], a[224:227], a[164:167], 0
ds_write_b128 v10, v[132:135] offset:1152
v_mfma_f32_16x16x32_bf16 v[204:207], a[228:231], a[164:167], 0
v_mfma_f32_16x16x32_bf16 v[200:203], a[232:235], a[164:167], 0
v_mfma_f32_16x16x32_bf16 v[196:199], a[236:239], a[164:167], 0
ds_write_b128 v10, v[104:107] offset:23680
v_mfma_f32_16x16x32_bf16 v[216:219], a[236:239], a[168:171], 0
ds_read_b128 a[164:167], v3 offset:2944
v_mfma_f32_16x16x32_bf16 v[220:223], a[232:235], a[168:171], 0
v_mfma_f32_16x16x32_bf16 v[224:227], a[228:231], a[168:171], 0
ds_write_b128 v10, v[136:139] offset:1728
v_mfma_f32_16x16x32_bf16 v[228:231], a[224:227], a[168:171], 0
v_mfma_f32_16x16x32_bf16 v[232:235], a[220:223], a[168:171], 0
s_waitcnt lgkmcnt(12)
v_mfma_f32_16x16x32_bf16 v[252:255], a[220:223], a[172:175], 0
ds_read_b128 a[168:171], v2 offset:12160
buffer_load_dwordx4 a[220:223], v1, s[16:19], s34 offen offset:1024 sc1
v_mfma_f32_16x16x32_bf16 v[248:251], a[224:227], a[172:175], 0
ds_write_b128 v10, v[108:111] offset:24256
v_mfma_f32_16x16x32_bf16 v[244:247], a[228:231], a[172:175], 0
buffer_load_dwordx4 a[224:227], v1, s[16:19], s34 offen offset:2048 sc1
v_mfma_f32_16x16x32_bf16 v[240:243], a[232:235], a[172:175], 0
v_mfma_f32_16x16x32_bf16 v[236:239], a[236:239], a[172:175], 0
s_waitcnt vmcnt(25)
buffer_load_dwordx4 a[228:231], v1, s[16:19], s34 offen offset:3072 sc1
s_add_u32 s34, s34, 4096
M v[236:239],a[252:255],a[176:179]
ds_read_b128 a[172:175], v3 offset:12160
M v[240:243],a[248:251],a[176:179]
buffer_load_dwordx4 a[232:235], v1, s[16:19], s34 offen offset:0 sc1
s_add_u32 s34, s34, 1024
M v[244:247],a[244:247],a[176:179]
ds_write_b128 v10, v[140:143] offset:2304
M v[248:251],a[240:243],a[176:179]
s_waitcnt lgkmcnt(12)
buffer_load_dwordx4 a[236:239], v1, s[16:19], s34 offen offset:0 sc1
M v[228:231],a[240:243],a[180:183]
ds_read_b128 a[176:179], v5 offset:12160
M v[224:227],a[244:247],a[180:183]
ds_write_b128 v10, v[112:115] offset:24832
M v[220:223],a[248:251],a[180:183]
M v[216:219],a[252:255],a[180:183]
M v[196:199],a[252:255],a[184:187]
ds_read_b128 a[180:183], v4 offset:12160
M v[200:203],a[248:251],a[184:187]
ds_write_b128 v10, v[144:147] offset:2880
M v[204:207],a[244:247],a[184:187]
M v[208:211],a[240:243],a[184:187]
s_waitcnt lgkmcnt(12)
M v[188:191],a[240:243],a[188:191]
ds_read_b128 a[184:187], v5 offset:2944
buffer_load_dwordx4 a[240:243], v1, s[16:19], s34 offen offset:1024 sc1
M v[184:187],a[244:247],a[188:191]
ds_write_b128 v10, v[116:119] offset:25408
M v[180:183],a[248:251],a[188:191]
buffer_load_dwordx4 a[244:247], v1, s[16:19], s34 offen offset:2048 sc1
M v[176:179],a[252:255],a[188:191]
s_waitcnt vmcnt(25)
M v[176:179],v[32:35],a[160:163]
ds_read_b128 a[188:191], v4 offset:2944
buffer_load_dwordx4 a[248:251], v1, s[16:19], s34 offen offset:3072 sc1
M v[180:183],v[36:39],a[160:163]
s_add_u32 s34, s34, 4096
M v[184:187],v[40:43],a[160:163]
M v[188:191],v[44:47],a[160:163]
buffer_load_dwordx4 a[252:255], v1, s[16:19], s34 offen offset:0 sc1
M v[192:195],v[48:51],a[160:163]
s_waitcnt lgkmcnt(10)
M v[212:215],v[48:51],a[164:167]
ds_read_b128 a[160:163], v2 offset:3008
M v[208:211],v[44:47],a[164:167]
M v[204:207],v[40:43],a[164:167]
M v[200:203],v[36:39],a[164:167]
M v[196:199],v[32:35],a[164:167]
M v[216:219],v[32:35],a[168:171]
ds_read_b128 a[164:167], v3 offset:3008
M v[220:223],v[36:39],a[168:171]
M v[224:227],v[40:43],a[168:171]
M v[228:231],v[44:47],a[168:171]
M v[232:235],v[48:51],a[168:171]
s_waitcnt lgkmcnt(8)
M v[252:255],v[48:51],a[172:175]
ds_read_b128 a[168:171], v2 offset:12224
buffer_load_dwordx4 v[48:51], v1, s[16:19], s34 offen offset:1024 sc1
M v[248:251],v[44:47],a[172:175]
M v[244:247],v[40:43],a[172:175]
buffer_load_dwordx4 v[44:47], v1, s[16:19], s34 offen offset:2048 sc1
M v[240:243],v[36:39],a[172:175]
M v[236:239],v[32:35],a[172:175]
s_waitcnt vmcnt(25)
buffer_load_dwordx4 v[40:43], v1, s[16:19], s34 offen offset:3072 sc1
s_add_u32 s34, s34, 4096
M v[236:239],v[52:55],a[176:179]
ds_read_b128 a[172:175], v3 offset:12224
M v[240:243],v[56:59],a[176:179]
buffer_load_dwordx4 v[36:39], v1, s[16:19], s34 offen offset:0 sc1
s_add_u32 s34, s34, 1024
M v[244:247],v[60:63],a[176:179]
M v[248:251],v[64:67],a[176:179]
s_waitcnt lgkmcnt(6)
buffer_load_dwordx4 v[32:35], v1, s[16:19], s34 offen offset:0 sc1
M v[228:231],v[64:67],a[180:183]
ds_read_b128 a[176:179], v5 offset:12224
M v[224:227],v[60:63],a[180:183]
M v[220:223],v[56:59],a[180:183]
M v[216:219],v[52:55],a[180:183]
M v[196:199],v[52:55],a[184:187]
ds_read_b128 a[180:183], v4 offset:12224
M v[200:203],v[56:59],a[184:187]
M v[204:207],v[60:63],a[184:187]
M v[208:211],v[64:67],a[184:187]
s_waitcnt lgkmcnt(5)
M v[188:191],v[64:67],a[188:191]
ds_read_b128 a[184:187], v5 offset:3008
buffer_load_dwordx4 v[64:67], v1, s[16:19], s34 offen offset:1024 sc1
M v[184:187],v[60:63],a[188:191]
M v[180:183],v[56:59],a[188:191]
buffer_load_dwordx4 v[60:63], v1, s[16:19], s34 offen offset:2048 sc1
M v[176:179],v[52:55],a[188:191]
s_waitcnt vmcnt(25)
s_waitcnt lgkmcnt(0)
s_barrier
M v[176:179],v[68:71],a[160:163]
ds_read_b128 a[188:191], v4 offset:3008
buffer_load_dwordx4 v[56:59], v1, s[16:19], s34 offen offset:3072 sc1
M v[180:183],v[72:75],a[160:163]
s_add_u32 s34, s34, 4096
M v[184:187],v[76:79],a[160:163]
ds_write_b64 v14, a[36:37] offset:0
M v[188:191],v[80:83],a[160:163]
buffer_load_dwordx4 v[52:55], v1, s[16:19], s34 offen offset:0 sc1
M v[192:195],v[84:87],a[160:163]
s_waitcnt lgkmcnt(6)
ds_write_b64 v14, a[38:39] offset:8
M v[212:215],v[84:87],a[164:167]
ds_read_b128 a[160:163], v2 offset:3072
M v[208:211],v[80:83],a[164:167]
ds_write_b64 v14, a[76:77] offset:1024
M v[204:207],v[76:79],a[164:167]
ds_write_b64 v14, a[78:79] offset:1032
M v[200:203],v[72:75],a[164:167]
ds_write_b64 v14, a[16:17] offset:2048
M v[196:199],v[68:71],a[164:167]
ds_write_b64 v14, a[18:19] offset:2056
M v[216:219],v[68:71],a[168:171]
ds_read_b128 a[164:167], v3 offset:3072
M v[220:223],v[72:75],a[168:171]
ds_write_b64 v14, a[56:57] offset:3072
M v[224:227],v[76:79],a[168:171]
ds_write_b64 v14, a[58:59] offset:3080
M v[228:231],v[80:83],a[168:171]
ds_write_b64 v14, a[20:21] offset:4096
M v[232:235],v[84:87],a[168:171]
s_waitcnt lgkmcnt(14)
ds_write_b64 v14, a[22:23] offset:4104
M v[252:255],v[84:87],a[172:175]
ds_read_b128 a[168:171], v2 offset:12288
buffer_load_dwordx4 v[84:87], v1, s[16:19], s34 offen offset:1024 sc1
M v[248:251],v[80:83],a[172:175]
M v[244:247],v[76:79],a[172:175]
buffer_load_dwordx4 v[80:83], v1, s[16:19], s34 offen offset:2048 sc1
M v[240:243],v[72:75],a[172:175]
M v[236:239],v[68:71],a[172:175]
s_waitcnt vmcnt(25)
buffer_load_dwordx4 v[76:79], v1, s[16:19], s34 offen offset:3072 sc1
s_add_u32 s34, s34, 4096
M v[236:239],v[88:91],a[176:179]
ds_read_b128 a[172:175], v3 offset:12288
M v[240:243],v[92:95],a[176:179]
buffer_load_dwordx4 v[72:75], v1, s[16:19], s34 offen offset:0 sc1
s_add_u32 s34, s34, 1024
M v[244:247],a[192:195],a[176:179]
M v[248:251],a[196:199],a[176:179]
s_waitcnt lgkmcnt(15)
buffer_load_dwordx4 v[68:71], v1, s[16:19], s34 offen offset:0 sc1
M v[228:231],a[196:199],a[180:183]
ds_read_b128 a[176:179], v5 offset:12288
M v[224:227],a[192:195],a[180:183]
M v[220:223],v[92:95],a[180:183]
M v[216:219],v[88:91],a[180:183]
M v[196:199],v[88:91],a[184:187]
ds_read_b128 a[180:183], v4 offset:12288
M v[200:203],v[92:95],a[184:187]
M v[204:207],a[192:195],a[184:187]
M v[208:211],a[196:199],a[184:187]
s_waitcnt lgkmcnt(13)
M v[188:191],a[196:199],a[188:191]
ds_read_b128 a[184:187], v5 offset:3072
buffer_load_dwordx4 a[196:199], v1, s[16:19], s34 offen offset:1024 sc1
M v[184:187],a[192:195],a[188:191]
M v[180:183],v[92:95],a[188:191]
buffer_load_dwordx4 a[192:195], v1, s[16:19], s34 offen offset:2048 sc1
M v[176:179],v[88:91],a[188:191]
s_waitcnt vmcnt(25)
M v[176:179],a[200:203],a[160:163]
ds_read_b128 a[188:191], v4 offset:3072
buffer_load_dwordx4 v[92:95], v1, s[16:19], s34 offen offset:3072 sc1
M v[180:183],a[204:207],a[160:163]
s_add_u32 s34, s34, 4096
M v[184:187],a[208:211],a[160:163]
M v[188:191],a[212:215],a[160:163]
buffer_load_dwordx4 v[88:91], v1, s[16:19], s34 offen offset:0 sc1
M v[192:195],a[216:219],a[160:163]
s_waitcnt lgkmcnt(5)
M v[212:215],a[216:219],a[164:167]
ds_read_b128 a[160:163], v6 offset:3136
M v[208:211],a[212:215],a[164:167]
M v[204:207],a[208:211],a[164:167]
M v[200:203],a[204:207],a[164:167]
M v[196:199],a[200:203],a[164:167]
M v[216:219],a[200:203],a[168:171]
ds_read_b128 a[164:167], v7 offset:3136
M v[220:223],a[204:207],a[168:171]
M v[224:227],a[208:211],a[168:171]
M v[228:231],a[212:215],a[168:171]
M v[232:235],a[216:219],a[168:171]
s_waitcnt lgkmcnt(5)
M v[252:255],a[216:219],a[172:175]
ds_read_b128 a[168:171], v6 offset:12352
buffer_load_dwordx4 a[216:219], v1, s[16:19], s34 offen offset:1024 sc1
M v[248:251],a[212:215],a[172:175]
M v[244:247],a[208:211],a[172:175]
buffer_load_dwordx4 a[212:215], v1, s[16:19], s34 offen offset:2048 sc1
M v[240:243],a[204:207],a[172:175]
M v[236:239],a[200:203],a[172:175]
s_waitcnt vmcnt(25)
buffer_load_dwordx4 a[208:211], v1, s[16:19], s34 offen offset:3072 sc1
s_add_u32 s34, s34, 4096
M v[236:239],a[220:223],a[176:179]
ds_read_b128 a[172:175], v7 offset:12352
M v[240:243],a[224:227],a[176:179]
buffer_load_dwordx4 a[204:207], v1, s[16:19], s34 offen offset:0 sc1
s_add_u32 s34, s34, 1024
M v[244:247],a[228:231],a[176:179]
M v[248:251],a[232:235],a[176:179]
s_waitcnt lgkmcnt(5)
buffer_load_dwordx4 a[200:203], v1, s[16:19], s34 offen offset:0 sc1
M v[228:231],a[232:235],a[180:183]
ds_read_b128 a[176:179], v9 offset:12352
M v[224:227],a[228:231],a[180:183]
M v[220:223],a[224:227],a[180:183]
M v[216:219],a[220:223],a[180:183]
M v[196:199],a[220:223],a[184:187]
ds_read_b128 a[180:183], v8 offset:12352
M v[200:203],a[224:227],a[184:187]
M v[204:207],a[228:231],a[184:187]
M v[208:211],a[232:235],a[184:187]
s_waitcnt lgkmcnt(5)
M v[188:191],a[232:235],a[188:191]
ds_read_b128 a[184:187], v9 offset:3136
buffer_load_dwordx4 a[232:235], v1, s[16:19], s34 offen offset:1024 sc1
M v[184:187],a[228:231],a[188:191]
M v[180:183],a[224:227],a[188:191]
buffer_load_dwordx4 a[228:231], v1, s[16:19], s34 offen offset:2048 sc1
M v[176:179],a[220:223],a[188:191]
s_waitcnt vmcnt(25)
s_waitcnt lgkmcnt(0)
s_barrier
M v[176:179],a[236:239],a[160:163]
ds_read_b128 a[188:191], v8 offset:3136
buffer_load_dwordx4 a[224:227], v1, s[16:19], s34 offen offset:3072 sc1
M v[180:183],a[240:243],a[160:163]
s_add_u32 s34, s34, 4096
ds_read_b128 v[132:135], v15 offset:0
M v[184:187],a[244:247],a[160:163]
ds_read_b128 v[172:175], v15 offset:1024
ds_read_b128 v[112:115], v15 offset:2048
M v[188:191],a[248:251],a[160:163]
buffer_load_dwordx4 a[220:223], v1, s[16:19], s34 offen offset:0 sc1
ds_read_b128 v[152:155], v15 offset:3072
M v[192:195],a[252:255],a[160:163]
s_waitcnt lgkmcnt(9)
ds_read_b128 v[116:119], v15 offset:4096
M v[212:215],a[252:255],a[164:167]
ds_read_b128 a[160:163], v2 offset:2336
M v[208:211],a[248:251],a[164:167]
M v[204:207],a[244:247],a[164:167]
M v[200:203],a[240:243],a[164:167]
v_accvgpr_read_b32 v16, a36
v_accvgpr_read_b32 v17, a37
M v[196:199],a[236:239],a[164:167]
v_accvgpr_read_b32 v18, a38
v_accvgpr_read_b32 v19, a39
M v[216:219],a[236:239],a[168:171]
ds_read_b128 a[164:167], v3 offset:2336
s_waitcnt lgkmcnt(6)
v_add_f32 v132, v132, v16
M v[220:223],a[240:243],a[168:171]
v_add_f32 v133, v133, v17
v_add_f32 v134, v134, v18
M v[224:227],a[244:247],a[168:171]
v_add_f32 v135, v135, v19
M v[228:231],a[248:251],a[168:171]
ds_write_b64 v15, a[60:61] offset:0
M v[232:235],a[252:255],a[168:171]
s_waitcnt lgkmcnt(11)
ds_write_b64 v15, a[62:63] offset:8
M v[252:255],a[252:255],a[172:175]
ds_read_b128 a[168:171], v2 offset:11552
buffer_load_dwordx4 a[252:255], v1, s[16:19], s34 offen offset:1024 sc1
M v[248:251],a[248:251],a[172:175]
v_accvgpr_read_b32 v16, a76
v_accvgpr_read_b32 v17, a77
M v[244:247],a[244:247],a[172:175]
buffer_load_dwordx4 a[248:251], v1, s[16:19], s34 offen offset:2048 sc1
v_accvgpr_read_b32 v18, a78
M v[240:243],a[240:243],a[172:175]
v_accvgpr_read_b32 v19, a79
M v[236:239],a[236:239],a[172:175]
s_waitcnt vmcnt(25)
buffer_load_dwordx4 a[244:247], v1, s[16:19], s34 offen offset:3072 sc1
s_add_u32 s34, s34, 4096
s_waitcnt lgkmcnt(8)
M v[236:239],v[48:51],a[176:179]
ds_read_b128 a[172:175], v3 offset:11552
v_add_f32 v172, v172, v16
M v[240:243],v[44:47],a[176:179]
buffer_load_dwordx4 a[240:243], v1, s[16:19], s34 offen offset:0 sc1
s_add_u32 s34, s34, 1024
M v[244:247],v[40:43],a[176:179]
v_add_f32 v173, v173, v17
v_add_f32 v174, v174, v18
M v[248:251],v[36:39],a[176:179]
s_waitcnt lgkmcnt(12)
buffer_load_dwordx4 a[236:239], v1, s[16:19], s34 offen offset:0 sc1
v_add_f32 v175, v175, v19
M v[228:231],v[36:39],a[180:183]
ds_read_b128 a[176:179], v5 offset:11552
M v[224:227],v[40:43],a[180:183]
ds_write_b64 v15, a[0:1] offset:1024
M v[220:223],v[44:47],a[180:183]
ds_write_b64 v15, a[2:3] offset:1032
M v[216:219],v[48:51],a[180:183]
v_accvgpr_read_b32 v16, a16
v_accvgpr_read_b32 v17, a17
M v[196:199],v[48:51],a[184:187]
ds_read_b128 a[180:183], v4 offset:11552
v_accvgpr_read_b32 v18, a18
M v[200:203],v[44:47],a[184:187]
v_accvgpr_read_b32 v19, a19
M v[204:207],v[40:43],a[184:187]
s_waitcnt lgkmcnt(12)
v_add_f32 v112, v112, v16
v_add_f32 v113, v113, v17
M v[208:211],v[36:39],a[184:187]
s_waitcnt lgkmcnt(9)
v_add_f32 v114, v114, v18
v_add_f32 v115, v115, v19
M v[188:191],v[36:39],a[188:191]
ds_read_b128 a[184:187], v5 offset:2336
buffer_load_dwordx4 v[36:39], v1, s[16:19], s34 offen offset:1024 sc1
M v[184:187],v[40:43],a[188:191]
ds_write_b64 v15, a[40:41] offset:2048
M v[180:183],v[44:47],a[188:191]
buffer_load_dwordx4 v[40:43], v1, s[16:19], s34 offen offset:2048 sc1
M v[176:179],v[48:51],a[188:191]
s_waitcnt vmcnt(25)
ds_write_b64 v15, a[42:43] offset:2056
M v[176:179],v[32:35],a[160:163]
ds_read_b128 a[188:191], v4 offset:2336
buffer_load_dwordx4 v[44:47], v1, s[16:19], s34 offen offset:3072 sc1
M v[180:183],v[64:67],a[160:163]
s_add_u32 s34, s34, 4096
v_accvgpr_read_b32 v16, a56
M v[184:187],v[60:63],a[160:163]
v_accvgpr_read_b32 v17, a57
v_accvgpr_read_b32 v18, a58
M v[188:191],v[56:59],a[160:163]
buffer_load_dwordx4 v[48:51], v1, s[16:19], s34 offen offset:0 sc1
v_accvgpr_read_b32 v19, a59
M v[192:195],v[52:55],a[160:163]
s_waitcnt lgkmcnt(9)
s_waitcnt lgkmcnt(15)
v_add_f32 v152, v152, v16
v_add_f32 v153, v153, v17
M v[212:215],v[52:55],a[164:167]
ds_read_b128 a[160:163], v2 offset:2400
v_add_f32 v154, v154, v18
M v[208:211],v[56:59],a[164:167]
v_add_f32 v155, v155, v19
M v[204:207],v[60:63],a[164:167]
ds_write_b64 v15, a[24:25] offset:3072
M v[200:203],v[64:67],a[164:167]
ds_write_b64 v15, a[26:27] offset:3080
M v[196:199],v[32:35],a[164:167]
v_accvgpr_read_b32 v16, a20
v_accvgpr_read_b32 v17, a21
M v[216:219],v[32:35],a[168:171]
ds_read_b128 a[164:167], v3 offset:2400
v_accvgpr_read_b32 v18, a22
M v[220:223],v[64:67],a[168:171]
v_accvgpr_read_b32 v19, a23
M v[224:227],v[60:63],a[168:171]
s_waitcnt lgkmcnt(15)
v_add_f32 v116, v116, v16
v_add_f32 v117, v117, v17
M v[228:231],v[56:59],a[168:171]
v_add_f32 v118, v118, v18
v_add_f32 v119, v119, v19
M v[232:235],v[52:55],a[168:171]
s_waitcnt lgkmcnt(11)
ds_write_b64 v15, a[64:65] offset:4096
M v[252:255],v[52:55],a[172:175]
ds_read_b128 a[168:171], v2 offset:11616
buffer_load_dwordx4 v[52:55], v1, s[16:19], s34 offen offset:1024 sc1
M v[248:251],v[56:59],a[172:175]
ds_write_b64 v15, a[66:67] offset:4104
M v[244:247],v[60:63],a[172:175]
buffer_load_dwordx4 v[56:59], v1, s[16:19], s34 offen offset:2048 sc1
M v[240:243],v[64:67],a[172:175]
M v[236:239],v[32:35],a[172:175]
s_waitcnt vmcnt(25)
buffer_load_dwordx4 v[60:63], v1, s[16:19], s34 offen offset:3072 sc1
s_add_u32 s34, s34, 4096
M v[236:239],v[84:87],a[176:179]
ds_read_b128 a[172:175], v3 offset:11616
M v[240:243],v[80:83],a[176:179]
buffer_load_dwordx4 v[64:67], v1, s[16:19], s34 offen offset:0 sc1
s_add_u32 s34, s34, 1024
M v[244:247],v[76:79],a[176:179]
M v[248:251],v[72:75],a[176:179]
s_waitcnt lgkmcnt(11)
buffer_load_dwordx4 v[32:35], v1, s[16:19], s34 offen offset:0 sc1
M v[228:231],v[72:75],a[180:183]
ds_read_b128 a[176:179], v5 offset:11616
M v[224:227],v[76:79],a[180:183]
M v[220:223],v[80:83],a[180:183]
M v[216:219],v[84:87],a[180:183]
M v[196:199],v[84:87],a[184:187]
ds_read_b128 a[180:183], v4 offset:11616
M v[200:203],v[80:83],a[184:187]
M v[204:207],v[76:79],a[184:187]
M v[208:211],v[72:75],a[184:187]
s_waitcnt lgkmcnt(9)
M v[188:191],v[72:75],a[188:191]
ds_read_b128 a[184:187], v5 offset:2400
buffer_load_dwordx4 v[72:75], v1, s[16:19], s34 offen offset:1024 sc1
M v[184:187],v[76:79],a[188:191]
M v[180:183],v[80:83],a[188:191]
buffer_load_dwordx4 v[76:79], v1, s[16:19], s34 offen offset:2048 sc1
M v[176:179],v[84:87],a[188:191]
s_waitcnt vmcnt(25)
M v[176:179],v[68:71],a[160:163]
ds_read_b128 a[188:191], v4 offset:2400
buffer_load_dwordx4 v[80:83], v1, s[16:19], s34 offen offset:3072 sc1
M v[180:183],a[196:199],a[160:163]
s_add_u32 s34, s34, 4096
M v[184:187],a[192:195],a[160:163]
M v[188:191],v[92:95],a[160:163]
buffer_load_dwordx4 v[84:87], v1, s[16:19], s34 offen offset:0 sc1
M v[192:195],v[88:91],a[160:163]
s_waitcnt lgkmcnt(6)
M v[212:215],v[88:91],a[164:167]
ds_read_b128 a[160:163], v2 offset:2464
M v[208:211],v[92:95],a[164:167]
M v[204:207],a[192:195],a[164:167]
M v[200:203],a[196:199],a[164:167]
M v[196:199],v[68:71],a[164:167]
M v[216:219],v[68:71],a[168:171]
ds_read_b128 a[164:167], v3 offset:2464
M v[220:223],a[196:199],a[168:171]
M v[224:227],a[192:195],a[168:171]
M v[228:231],v[92:95],a[168:171]
M v[232:235],v[88:91],a[168:171]
s_waitcnt lgkmcnt(5)
M v[252:255],v[88:91],a[172:175]
ds_read_b128 a[168:171], v2 offset:11680
buffer_load_dwordx4 v[88:91], v1, s[16:19], s34 offen offset:1024 sc1
M v[248:251],v[92:95],a[172:175]
M v[244:247],a[192:195],a[172:175]
buffer_load_dwordx4 v[92:95], v1, s[16:19], s34 offen offset:2048 sc1
M v[240:243],a[196:199],a[172:175]
M v[236:239],v[68:71],a[172:175]
s_waitcnt vmcnt(25)
buffer_load_dwordx4 a[192:195], v1, s[16:19], s34 offen offset:3072 sc1
s_add_u32 s34, s34, 4096
M v[236:239],a[216:219],a[176:179]
ds_read_b128 a[172:175], v3 offset:11680
M v[240:243],a[212:215],a[176:179]
buffer_load_dwordx4 a[196:199], v1, s[16:19], s34 offen offset:0 sc1
s_add_u32 s34, s34, 1024
M v[244:247],a[208:211],a[176:179]
M v[248:251],a[204:207],a[176:179]
s_waitcnt lgkmcnt(5)
buffer_load_dwordx4 v[68:71], v1, s[16:19], s34 offen offset:0 sc1
M v[228:231],a[204:207],a[180:183]
ds_read_b128 a[176:179], v5 offset:11680
M v[224:227],a[208:211],a[180:183]
M v[220:223],a[212:215],a[180:183]
M v[216:219],a[216:219],a[180:183]
M v[196:199],a[216:219],a[184:187]
ds_read_b128 a[180:183], v4 offset:11680
M v[200:203],a[212:215],a[184:187]
M v[204:207],a[208:211],a[184:187]
M v[208:211],a[204:207],a[184:187]
s_waitcnt lgkmcnt(5)
M v[188:191],a[204:207],a[188:191]
ds_read_b128 a[184:187], v5 offset:2464
buffer_load_dwordx4 a[204:207], v1, s[16:19], s34 offen offset:1024 sc1
M v[184:187],a[208:211],a[188:191]
M v[180:183],a[212:215],a[188:191]
buffer_load_dwordx4 a[208:211], v1, s[16:19], s34 offen offset:2048 sc1
M v[176:179],a[216:219],a[188:191]
s_waitcnt vmcnt(25)
s_waitcnt lgkmcnt(0)
s_barrier
M v[176:179],a[200:203],a[160:163]
ds_read_b128 a[188:191], v4 offset:2464
buffer_load_dwordx4 a[212:215], v1, s[16:19], s34 offen offset:3072 sc1
M v[180:183],a[232:235],a[160:163]
s_add_u32 s34, s34, 4096
ds_read_b128 v[156:159], v14 offset:0
M v[184:187],a[228:231],a[160:163]
ds_read_b128 v[96:99], v14 offset:1024
ds_read_b128 v[136:139], v14 offset:2048
M v[188:191],a[224:227],a[160:163]
buffer_load_dwordx4 a[216:219], v1, s[16:19], s34 offen offset:0 sc1
ds_read_b128 v[120:123], v14 offset:3072
M v[192:195],a[220:223],a[160:163]
s_waitcnt lgkmcnt(9)
ds_read_b128 v[160:163], v14 offset:4096
M v[212:215],a[220:223],a[164:167]
ds_read_b128 a[160:163], v2 offset:2528
M v[208:211],a[224:227],a[164:167]
M v[204:207],a[228:231],a[164:167]
M v[200:203],a[232:235],a[164:167]
v_accvgpr_read_b32 v16, a60
v_accvgpr_read_b32 v17, a61
M v[196:199],a[200:203],a[164:167]
v_accvgpr_read_b32 v18, a62
v_accvgpr_read_b32 v19, a63
M v[216:219],a[200:203],a[168:171]
ds_read_b128 a[164:167], v3 offset:2528
s_waitcnt lgkmcnt(6)
v_add_f32 v156, v156, v16
M v[220:223],a[232:235],a[168:171]
v_add_f32 v157, v157, v17
v_add_f32 v158, v158, v18
M v[224:227],a[228:231],a[168:171]
v_add_f32 v159, v159, v19
M v[228:231],a[224:227],a[168:171]
ds_write_b64 v14, a[4:5] offset:0
M v[232:235],a[220:223],a[168:171]
s_waitcnt lgkmcnt(11)
ds_write_b64 v14, a[6:7] offset:8
M v[252:255],a[220:223],a[172:175]
ds_read_b128 a[168:171], v2 offset:11744
buffer_load_dwordx4 a[220:223], v1, s[16:19], s34 offen offset:1024 sc1
M v[248:251],a[224:227],a[172:175]
v_accvgpr_read_b32 v16, a0
v_accvgpr_read_b32 v17, a1
M v[244:247],a[228:231],a[172:175]
buffer_load_dwordx4 a[224:227], v1, s[16:19], s34 offen offset:2048 sc1
v_accvgpr_read_b32 v18, a2
M v[240:243],a[232:235],a[172:175]
v_accvgpr_read_b32 v19, a3
M v[236:239],a[200:203],a[172:175]
s_waitcnt vmcnt(25)
buffer_load_dwordx4 a[228:231], v1, s[16:19], s34 offen offset:3072 sc1
s_add_u32 s34, s34, 4096
s_waitcnt lgkmcnt(8)
M v[236:239],a[252:255],a[176:179]
ds_read_b128 a[172:175], v3 offset:11744
v_add_f32 v96, v96, v16
M v[240:243],a[248:251],a[176:179]
buffer_load_dwordx4 a[232:235], v1, s[16:19], s34 offen offset:0 sc1
s_add_u32 s34, s34, 1024
M v[244:247],a[244:247],a[176:179]
v_add_f32 v97, v97, v17
v_add_f32 v98, v98, v18
M v[248:251],a[240:243],a[176:179]
s_waitcnt lgkmcnt(12)
buffer_load_dwordx4 a[200:203], v1, s[16:19], s34 offen offset:0 sc1
v_add_f32 v99, v99, v19
M v[228:231],a[240:243],a[180:183]
ds_read_b128 a[176:179], v5 offset:11744
M v[224:227],a[244:247],a[180:183]
ds_write_b64 v14, a[44:45] offset:1024
M v[220:223],a[248:251],a[180:183]
ds_write_b64 v14, a[46:47] offset:1032
M v[216:219],a[252:255],a[180:183]
v_accvgpr_read_b32 v16, a40
v_accvgpr_read_b32 v17, a41
M v[196:199],a[252:255],a[184:187]
ds_read_b128 a[180:183], v4 offset:11744
v_accvgpr_read_b32 v18, a42
M v[200:203],a[248:251],a[184:187]
v_accvgpr_read_b32 v19, a43
M v[204:207],a[244:247],a[184:187]
s_waitcnt lgkmcnt(12)
v_add_f32 v136, v136, v16
v_add_f32 v137, v137, v17
M v[208:211],a[240:243],a[184:187]
s_waitcnt lgkmcnt(9)
v_add_f32 v138, v138, v18
v_add_f32 v139, v139, v19
M v[188:191],a[240:243],a[188:191]
ds_read_b128 a[184:187], v5 offset:2528
buffer_load_dwordx4 a[240:243], v1, s[16:19], s34 offen offset:1024 sc1
M v[184:187],a[244:247],a[188:191]
ds_write_b64 v14, a[28:29] offset:2048
M v[180:183],a[248:251],a[188:191]
buffer_load_dwordx4 a[244:247], v1, s[16:19], s34 offen offset:2048 sc1
M v[176:179],a[252:255],a[188:191]
s_waitcnt vmcnt(25)
ds_write_b64 v14, a[30:31] offset:2056
M v[176:179],a[236:239],a[160:163]
ds_read_b128 a[188:191], v4 offset:2528
buffer_load_dwordx4 a[248:251], v1, s[16:19], s34 offen offset:3072 sc1
M v[180:183],v[36:39],a[160:163]
s_add_u32 s34, s34, 4096
v_accvgpr_read_b32 v16, a24
M v[184:187],v[40:43],a[160:163]
v_accvgpr_read_b32 v17, a25
v_accvgpr_read_b32 v18, a26
M v[188:191],v[44:47],a[160:163]
buffer_load_dwordx4 a[252:255], v1, s[16:19], s34 offen offset:0 sc1
v_accvgpr_read_b32 v19, a27
M v[192:195],v[48:51],a[160:163]
s_waitcnt lgkmcnt(9)
s_waitcnt lgkmcnt(15)
v_add_f32 v120, v120, v16
v_add_f32 v121, v121, v17
M v[212:215],v[48:51],a[164:167]
ds_read_b128 a[160:163], v2 offset:576
v_add_f32 v122, v122, v18
M v[208:211],v[44:47],a[164:167]
v_add_f32 v123, v123, v19
M v[204:207],v[40:43],a[164:167]
ds_write_b64 v14, a[68:69] offset:3072
M v[200:203],v[36:39],a[164:167]
ds_write_b64 v14, a[70:71] offset:3080
M v[196:199],a[236:239],a[164:167]
v_accvgpr_read_b32 v16, a64
v_accvgpr_read_b32 v17, a65
M v[216:219],a[236:239],a[168:171]
ds_read_b128 a[164:167], v3 offset:576
v_accvgpr_read_b32 v18, a66
M v[220:223],v[36:39],a[168:171]
v_accvgpr_read_b32 v19, a67
M v[224:227],v[40:43],a[168:171]
s_waitcnt lgkmcnt(15)
v_add_f32 v160, v160, v16
v_add_f32 v161, v161, v17
M v[228:231],v[44:47],a[168:171]
v_add_f32 v162, v162, v18
v_add_f32 v163, v163, v19
M v[232:235],v[48:51],a[168:171]
s_waitcnt lgkmcnt(11)
ds_write_b64 v14, a[8:9] offset:4096
M v[252:255],v[48:51],a[172:175]
ds_read_b128 a[168:171], v2 offset:9792
buffer_load_dwordx4 v[48:51], v1, s[16:19], s34 offen offset:1024 sc1
M v[248:251],v[44:47],a[172:175]
ds_write_b64 v14, a[10:11] offset:4104
M v[244:247],v[40:43],a[172:175]
buffer_load_dwordx4 v[44:47], v1, s[16:19], s34 offen offset:2048 sc1
M v[240:243],v[36:39],a[172:175]
M v[236:239],a[236:239],a[172:175]
s_waitcnt vmcnt(25)
buffer_load_dwordx4 v[40:43], v1, s[16:19], s34 offen offset:3072 sc1
s_add_u32 s34, s34, 4096
M v[236:239],v[52:55],a[176:179]
ds_read_b128 a[172:175], v3 offset:9792
M v[240:243],v[56:59],a[176:179]
buffer_load_dwordx4 v[36:39], v1, s[16:19], s34 offen offset:0 sc1
s_add_u32 s34, s34, 1024
M v[244:247],v[60:63],a[176:179]
M v[248:251],v[64:67],a[176:179]
s_waitcnt lgkmcnt(11)
buffer_load_dwordx4 a[236:239], v1, s[16:19], s34 offen offset:0 sc1
M v[228:231],v[64:67],a[180:183]
ds_read_b128 a[176:179], v5 offset:9792
M v[224:227],v[60:63],a[180:183]
M v[220:223],v[56:59],a[180:183]
M v[216:219],v[52:55],a[180:183]
M v[196:199],v[52:55],a[184:187]
ds_read_b128 a[180:183], v4 offset:9792
M v[200:203],v[56:59],a[184:187]
M v[204:207],v[60:63],a[184:187]
M v[208:211],v[64:67],a[184:187]
s_waitcnt lgkmcnt(9)
M v[188:191],v[64:67],a[188:191]
ds_read_b128 a[184:187], v5 offset:576
buffer_load_dwordx4 v[64:67], v1, s[16:19], s34 offen offset:1024 sc1
M v[184:187],v[60:63],a[188:191]
M v[180:183],v[56:59],a[188:191]
buffer_load_dwordx4 v[60:63], v1, s[16:19], s34 offen offset:2048 sc1
M v[176:179],v[52:55],a[188:191]
s_waitcnt vmcnt(25)
M v[176:179],v[32:35],a[160:163]
ds_read_b128 a[188:191], v4 offset:576
buffer_load_dwordx4 v[56:59], v1, s[16:19], s34 offen offset:3072 sc1
M v[180:183],v[72:75],a[160:163]
s_add_u32 s34, s34, 4096
M v[184:187],v[76:79],a[160:163]
M v[188:191],v[80:83],a[160:163]
buffer_load_dwordx4 v[52:55], v1, s[16:19], s34 offen offset:0 sc1
M v[192:195],v[84:87],a[160:163]
s_waitcnt lgkmcnt(6)
M v[212:215],v[84:87],a[164:167]
ds_read_b128 a[160:163], v2 offset:640
M v[208:211],v[80:83],a[164:167]
M v[204:207],v[76:79],a[164:167]
M v[200:203],v[72:75],a[164:167]
M v[196:199],v[32:35],a[164:167]
M v[216:219],v[32:35],a[168:171]
ds_read_b128 a[164:167], v3 offset:640
M v[220:223],v[72:75],a[168:171]
M v[224:227],v[76:79],a[168:171]
M v[228:231],v[80:83],a[168:171]
M v[232:235],v[84:87],a[168:171]
s_waitcnt lgkmcnt(5)
M v[252:255],v[84:87],a[172:175]
ds_read_b128 a[168:171], v2 offset:9856
buffer_load_dwordx4 v[84:87], v1, s[16:19], s34 offen offset:1024 sc1
M v[248:251],v[80:83],a[172:175]
M v[244:247],v[76:79],a[172:175]
buffer_load_dwordx4 v[80:83], v1, s[16:19], s34 offen offset:2048 sc1
M v[240:243],v[72:75],a[172:175]
M v[236:239],v[32:35],a[172:175]
s_waitcnt vmcnt(25)
buffer_load_dwordx4 v[76:79], v1, s[16:19], s34 offen offset:3072 sc1
s_add_u32 s34, s34, 4096
M v[236:239],v[88:91],a[176:179]
ds_read_b128 a[172:175], v3 offset:9856
M v[240:243],v[92:95],a[176:179]
buffer_load_dwordx4 v[72:75], v1, s[16:19], s34 offen offset:0 sc1
s_add_u32 s34, s34, 1024
M v[244:247],a[192:195],a[176:179]
M v[248:251],a[196:199],a[176:179]
s_waitcnt lgkmcnt(5)
buffer_load_dwordx4 v[32:35], v1, s[16:19], s34 offen offset:0 sc1
M v[228:231],a[196:199],a[180:183]
ds_read_b128 a[176:179], v5 offset:9856
M v[224:227],a[192:195],a[180:183]
M v[220:223],v[92:95],a[180:183]
M v[216:219],v[88:91],a[180:183]
M v[196:199],v[88:91],a[184:187]
ds_read_b128 a[180:183], v4 offset:9856
M v[200:203],v[92:95],a[184:187]
M v[204:207],a[192:195],a[184:187]
M v[208:211],a[196:199],a[184:187]
s_waitcnt lgkmcnt(5)
M v[188:191],a[196:199],a[188:191]
ds_read_b128 a[184:187], v5 offset:640
buffer_load_dwordx4 a[196:199], v1, s[16:19], s34 offen offset:1024 sc1
M v[184:187],a[192:195],a[188:191]
M v[180:183],v[92:95],a[188:191]
buffer_load_dwordx4 a[192:195], v1, s[16:19], s34 offen offset:2048 sc1
M v[176:179],v[88:91],a[188:191]
s_waitcnt vmcnt(25)
s_waitcnt lgkmcnt(0)
s_barrier
M v[176:179],v[68:71],a[160:163]
ds_read_b128 a[188:191], v4 offset:640
buffer_load_dwordx4 v[92:95], v1, s[16:19], s34 offen offset:3072 sc1
M v[180:183],a[204:207],a[160:163]
s_add_u32 s34, s34, 4096
ds_read_b128 v[100:103], v15 offset:0
M v[184:187],a[208:211],a[160:163]
ds_read_b128 v[140:143], v15 offset:1024
ds_read_b128 v[124:127], v15 offset:2048
M v[188:191],a[212:215],a[160:163]
buffer_load_dwordx4 v[88:91], v1, s[16:19], s34 offen offset:0 sc1
ds_read_b128 v[164:167], v15 offset:3072
M v[192:195],a[216:219],a[160:163]
s_waitcnt lgkmcnt(9)
ds_read_b128 v[104:107], v15 offset:4096
M v[212:215],a[216:219],a[164:167]
ds_read_b128 a[160:163], v2 offset:704
M v[208:211],a[212:215],a[164:167]
M v[204:207],a[208:211],a[164:167]
M v[200:203],a[204:207],a[164:167]
v_accvgpr_read_b32 v16, a4
v_accvgpr_read_b32 v17, a5
M v[196:199],v[68:71],a[164:167]
v_accvgpr_read_b32 v18, a6
v_accvgpr_read_b32 v19, a7
M v[216:219],v[68:71],a[168:171]
ds_read_b128 a[164:167], v3 offset:704
s_waitcnt lgkmcnt(6)
v_add_f32 v100, v100, v16
M v[220:223],a[204:207],a[168:171]
v_add_f32 v101, v101, v17
v_add_f32 v102, v102, v18
M v[224:227],a[208:211],a[168:171]
v_add_f32 v103, v103, v19
M v[228:231],a[212:215],a[168:171]
ds_write_b64 v15, a[48:49] offset:0
M v[232:235],a[216:219],a[168:171]
s_waitcnt lgkmcnt(11)
ds_write_b64 v15, a[50:51] offset:8
M v[252:255],a[216:219],a[172:175]
ds_read_b128 a[168:171], v2 offset:9920
buffer_load_dwordx4 a[216:219], v1, s[16:19], s34 offen offset:1024 sc1
M v[248:251],a[212:215],a[172:175]
v_accvgpr_read_b32 v16, a44
v_accvgpr_read_b32 v17, a45
M v[244:247],a[208:211],a[172:175]
buffer_load_dwordx4 a[212:215], v1, s[16:19], s34 offen offset:2048 sc1
v_accvgpr_read_b32 v18, a46
M v[240:243],a[204:207],a[172:175]
v_accvgpr_read_b32 v19, a47
M v[236:239],v[68:71],a[172:175]
s_waitcnt vmcnt(25)
buffer_load_dwordx4 a[208:211], v1, s[16:19], s34 offen offset:3072 sc1
s_add_u32 s34, s34, 4096
s_waitcnt lgkmcnt(8)
M v[236:239],a[220:223],a[176:179]
ds_read_b128 a[172:175], v3 offset:9920
v_add_f32 v140, v140, v16
M v[240:243],a[224:227],a[176:179]
buffer_load_dwordx4 a[204:207], v1, s[16:19], s34 offen offset:0 sc1
s_add_u32 s34, s34, 1024
M v[244:247],a[228:231],a[176:179]
v_add_f32 v141, v141, v17
v_add_f32 v142, v142, v18
M v[248:251],a[232:235],a[176:179]
s_waitcnt lgkmcnt(12)
buffer_load_dwordx4 v[68:71], v1, s[16:19], s34 offen offset:0 sc1
v_add_f32 v143, v143, v19
M v[228:231],a[232:235],a[180:183]
ds_read_b128 a[176:179], v5 offset:9920
M v[224:227],a[228:231],a[180:183]
ds_write_b64 v15, a[32:33] offset:1024
M v[220:223],a[224:227],a[180:183]
ds_write_b64 v15, a[34:35] offset:1032
M v[216:219],a[220:223],a[180:183]
v_accvgpr_read_b32 v16, a28
v_accvgpr_read_b32 v17, a29
M v[196:199],a[220:223],a[184:187]
ds_read_b128 a[180:183], v4 offset:9920
v_accvgpr_read_b32 v18, a30
M v[200:203],a[224:227],a[184:187]
v_accvgpr_read_b32 v19, a31
M v[204:207],a[228:231],a[184:187]
s_waitcnt lgkmcnt(12)
v_add_f32 v124, v124, v16
v_add_f32 v125, v125, v17
M v[208:211],a[232:235],a[184:187]
s_waitcnt lgkmcnt(9)
v_add_f32 v126, v126, v18
v_add_f32 v127, v127, v19
M v[188:191],a[232:235],a[188:191]
ds_read_b128 a[184:187], v5 offset:704
buffer_load_dwordx4 a[232:235], v1, s[16:19], s34 offen offset:1024 sc1
M v[184:187],a[228:231],a[188:191]
ds_write_b64 v15, a[72:73] offset:2048
M v[180:183],a[224:227],a[188:191]
buffer_load_dwordx4 a[228:231], v1, s[16:19], s34 offen offset:2048 sc1
M v[176:179],a[220:223],a[188:191]
s_waitcnt vmcnt(25)
ds_write_b64 v15, a[74:75] offset:2056
M v[176:179],a[200:203],a[160:163]
ds_read_b128 a[188:191], v4 offset:704
buffer_load_dwordx4 a[224:227], v1, s[16:19], s34 offen offset:3072 sc1
M v[180:183],a[240:243],a[160:163]
s_add_u32 s34, s34, 4096
v_accvgpr_read_b32 v16, a68
M v[184:187],a[244:247],a[160:163]
v_accvgpr_read_b32 v17, a69
v_accvgpr_read_b32 v18, a70
M v[188:191],a[248:251],a[160:163]
buffer_load_dwordx4 a[220:223], v1, s[16:19], s34 offen offset:0 sc1
v_accvgpr_read_b32 v19, a71
M v[192:195],a[252:255],a[160:163]
s_waitcnt lgkmcnt(9)
s_waitcnt lgkmcnt(15)
v_add_f32 v164, v164, v16
v_add_f32 v165, v165, v17
M v[212:215],a[252:255],a[164:167]
ds_read_b128 a[160:163], v2 offset:768
v_add_f32 v166, v166, v18
M v[208:211],a[248:251],a[164:167]
v_add_f32 v167, v167, v19
M v[204:207],a[244:247],a[164:167]
ds_write_b64 v15, a[12:13] offset:3072
M v[200:203],a[240:243],a[164:167]
ds_write_b64 v15, a[14:15] offset:3080
M v[196:199],a[200:203],a[164:167]
v_accvgpr_read_b32 v16, a8
v_accvgpr_read_b32 v17, a9
M v[216:219],a[200:203],a[168:171]
ds_read_b128 a[164:167], v3 offset:768
v_accvgpr_read_b32 v18, a10
M v[220:223],a[240:243],a[168:171]
v_accvgpr_read_b32 v19, a11
M v[224:227],a[244:247],a[168:171]
s_waitcnt lgkmcnt(15)
v_add_f32 v104, v104, v16
v_add_f32 v105, v105, v17
M v[228:231],a[248:251],a[168:171]
v_add_f32 v106, v106, v18
v_add_f32 v107, v107, v19
M v[232:235],a[252:255],a[168:171]
s_waitcnt lgkmcnt(11)
ds_write_b64 v15, a[52:53] offset:4096
M v[252:255],a[252:255],a[172:175]
ds_read_b128 a[168:171], v2 offset:9984
buffer_load_dwordx4 a[252:255], v1, s[16:19], s34 offen offset:1024 sc1
M v[248:251],a[248:251],a[172:175]
ds_write_b64 v15, a[54:55] offset:4104
M v[244:247],a[244:247],a[172:175]
buffer_load_dwordx4 a[248:251], v1, s[16:19], s34 offen offset:2048 sc1
M v[240:243],a[240:243],a[172:175]
M v[236:239],a[200:203],a[172:175]
s_waitcnt vmcnt(25)
buffer_load_dwordx4 a[244:247], v1, s[16:19], s34 offen offset:3072 sc1
s_add_u32 s34, s34, 4096
M v[236:239],v[48:51],a[176:179]
ds_read_b128 a[172:175], v3 offset:9984
M v[240:243],v[44:47],a[176:179]
buffer_load_dwordx4 a[240:243], v1, s[16:19], s34 offen offset:0 sc1
s_add_u32 s34, s34, 1024
M v[244:247],v[40:43],a[176:179]
M v[248:251],v[36:39],a[176:179]
s_waitcnt lgkmcnt(11)
buffer_load_dwordx4 a[200:203], v1, s[16:19], s34 offen offset:0 sc1
M v[228:231],v[36:39],a[180:183]
ds_read_b128 a[176:179], v5 offset:9984
M v[224:227],v[40:43],a[180:183]
M v[220:223],v[44:47],a[180:183]
M v[216:219],v[48:51],a[180:183]
M v[196:199],v[48:51],a[184:187]
ds_read_b128 a[180:183], v4 offset:9984
M v[200:203],v[44:47],a[184:187]
M v[204:207],v[40:43],a[184:187]
M v[208:211],v[36:39],a[184:187]
s_waitcnt lgkmcnt(9)
M v[188:191],v[36:39],a[188:191]
ds_read_b128 a[184:187], v5 offset:768
buffer_load_dwordx4 v[36:39], v1, s[16:19], s34 offen offset:1024 sc1
M v[184:187],v[40:43],a[188:191]
M v[180:183],v[44:47],a[188:191]
buffer_load_dwordx4 v[40:43], v1, s[16:19], s34 offen offset:2048 sc1
M v[176:179],v[48:51],a[188:191]
s_waitcnt vmcnt(25)
M v[176:179],a[236:239],a[160:163]
ds_read_b128 a[188:191], v4 offset:768
buffer_load_dwordx4 v[44:47], v1, s[16:19], s34 offen offset:3072 sc1
M v[180:183],v[64:67],a[160:163]
s_add_u32 s34, s34, 4096
M v[184:187],v[60:63],a[160:163]
M v[188:191],v[56:59],a[160:163]
buffer_load_dwordx4 v[48:51], v1, s[16:19], s34 offen offset:0 sc1
M v[192:195],v[52:55],a[160:163]
s_waitcnt lgkmcnt(6)
M v[212:215],v[52:55],a[164:167]
ds_read_b128 a[160:163], v6 offset:832
M v[208:211],v[56:59],a[164:167]
M v[204:207],v[60:63],a[164:167]
M v[200:203],v[64:67],a[164:167]
M v[196:199],a[236:239],a[164:167]
M v[216:219],a[236:239],a[168:171]
ds_read_b128 a[164:167], v7 offset:832
M v[220:223],v[64:67],a[168:171]
M v[224:227],v[60:63],a[168:171]
M v[228:231],v[56:59],a[168:171]
M v[232:235],v[52:55],a[168:171]
s_waitcnt lgkmcnt(5)
M v[252:255],v[52:55],a[172:175]
ds_read_b128 a[168:171], v6 offset:10048
buffer_load_dwordx4 v[52:55], v1, s[16:19], s34 offen offset:1024 sc1
M v[248:251],v[56:59],a[172:175]
M v[244:247],v[60:63],a[172:175]
buffer_load_dwordx4 v[56:59], v1, s[16:19], s34 offen offset:2048 sc1
M v[240:243],v[64:67],a[172:175]
M v[236:239],a[236:239],a[172:175]
s_waitcnt vmcnt(25)
buffer_load_dwordx4 v[60:63], v1, s[16:19], s34 offen offset:3072 sc1
s_add_u32 s34, s34, 4096
M v[236:239],v[84:87],a[176:179]
ds_read_b128 a[172:175], v7 offset:10048
M v[240:243],v[80:83],a[176:179]
buffer_load_dwordx4 v[64:67], v1, s[16:19], s34 offen offset:0 sc1
s_add_u32 s34, s34, 1024
M v[244:247],v[76:79],a[176:179]
M v[248:251],v[72:75],a[176:179]
s_waitcnt lgkmcnt(5)
buffer_load_dwordx4 a[236:239], v1, s[16:19], s34 offen offset:0 sc1
M v[228:231],v[72:75],a[180:183]
ds_read_b128 a[176:179], v9 offset:10048
M v[224:227],v[76:79],a[180:183]
M v[220:223],v[80:83],a[180:183]
M v[216:219],v[84:87],a[180:183]
M v[196:199],v[84:87],a[184:187]
ds_read_b128 a[180:183], v8 offset:10048
M v[200:203],v[80:83],a[184:187]
M v[204:207],v[76:79],a[184:187]
M v[208:211],v[72:75],a[184:187]
s_waitcnt lgkmcnt(5)
M v[188:191],v[72:75],a[188:191]
ds_read_b128 a[184:187], v9 offset:832
buffer_load_dwordx4 v[72:75], v1, s[16:19], s34 offen offset:1024 sc1
M v[184:187],v[76:79],a[188:191]
M v[180:183],v[80:83],a[188:191]
buffer_load_dwordx4 v[76:79], v1, s[16:19], s34 offen offset:2048 sc1
M v[176:179],v[84:87],a[188:191]
s_waitcnt vmcnt(25)
s_waitcnt lgkmcnt(0)
s_barrier
M v[176:179],v[32:35],a[160:163]
ds_read_b128 a[188:191], v8 offset:832
buffer_load_dwordx4 v[80:83], v1, s[16:19], s34 offen offset:3072 sc1
M v[180:183],a[196:199],a[160:163]
s_add_u32 s34, s34, 4096
ds_read_b128 v[144:147], v14 offset:0
M v[184:187],a[192:195],a[160:163]
ds_read_b128 v[128:131], v14 offset:1024
ds_read_b128 v[168:171], v14 offset:2048
M v[188:191],v[92:95],a[160:163]
buffer_load_dwordx4 v[84:87], v1, s[16:19], s34 offen offset:0 sc1
ds_read_b128 v[108:111], v14 offset:3072
M v[192:195],v[88:91],a[160:163]
s_waitcnt lgkmcnt(9)
ds_read_b128 v[148:151], v14 offset:4096
M v[212:215],v[88:91],a[164:167]
ds_read_b128 a[160:163], v2 offset:32
M v[208:211],v[92:95],a[164:167]
M v[204:207],a[192:195],a[164:167]
M v[200:203],a[196:199],a[164:167]
v_accvgpr_read_b32 v16, a48
v_accvgpr_read_b32 v17, a49
M v[196:199],v[32:35],a[164:167]
v_accvgpr_read_b32 v18, a50
v_accvgpr_read_b32 v19, a51
M v[216:219],v[32:35],a[168:171]
ds_read_b128 a[164:167], v3 offset:32
s_waitcnt lgkmcnt(6)
v_add_f32 v144, v144, v16
M v[220:223],a[196:199],a[168:171]
v_add_f32 v145, v145, v17
v_add_f32 v146, v146, v18
M v[224:227],a[192:195],a[168:171]
v_add_f32 v147, v147, v19
v_accvgpr_read_b32 v16, a32
M v[228:231],v[92:95],a[168:171]
v_accvgpr_read_b32 v17, a33
v_accvgpr_read_b32 v18, a34
M v[232:235],v[88:91],a[168:171]
s_waitcnt lgkmcnt(10)
v_accvgpr_read_b32 v19, a35
M v[252:255],v[88:91],a[172:175]
ds_read_b128 a[168:171], v2 offset:9248
buffer_load_dwordx4 v[88:91], v1, s[16:19], s34 offen offset:1024 sc1
s_waitcnt lgkmcnt(6)
M v[248:251],v[92:95],a[172:175]
v_add_f32 v128, v128, v16
v_add_f32 v129, v129, v17
M v[244:247],a[192:195],a[172:175]
buffer_load_dwordx4 v[92:95], v1, s[16:19], s34 offen offset:2048 sc1
v_add_f32 v130, v130, v18
M v[240:243],a[196:199],a[172:175]
v_add_f32 v131, v131, v19
v_accvgpr_read_b32 v16, a72
M v[236:239],v[32:35],a[172:175]
s_waitcnt vmcnt(25)
buffer_load_dwordx4 a[192:195], v1, s[16:19], s34 offen offset:3072 sc1
s_add_u32 s34, s34, 4096
M v[236:239],a[216:219],a[176:179]
ds_read_b128 a[172:175], v3 offset:9248
v_accvgpr_read_b32 v17, a73
M v[240:243],a[212:215],a[176:179]
buffer_load_dwordx4 a[196:199], v1, s[16:19], s34 offen offset:0 sc1
s_add_u32 s34, s34, 1024
M v[244:247],a[208:211],a[176:179]
v_accvgpr_read_b32 v18, a74
v_accvgpr_read_b32 v19, a75
M v[248:251],a[204:207],a[176:179]
s_waitcnt lgkmcnt(10)
buffer_load_dwordx4 v[32:35], v1, s[16:19], s34 offen offset:0 sc1
s_waitcnt lgkmcnt(6)
v_add_f32 v168, v168, v16
M v[228:231],a[204:207],a[180:183]
ds_read_b128 a[176:179], v5 offset:9248
v_add_f32 v169, v169, v17
M v[224:227],a[208:211],a[180:183]
v_add_f32 v170, v170, v18
v_add_f32 v171, v171, v19
M v[220:223],a[212:215],a[180:183]
v_accvgpr_read_b32 v16, a12
v_accvgpr_read_b32 v17, a13
M v[216:219],a[216:219],a[180:183]
v_accvgpr_read_b32 v18, a14
v_accvgpr_read_b32 v19, a15
M v[196:199],a[216:219],a[184:187]
ds_read_b128 a[180:183], v4 offset:9248
s_waitcnt lgkmcnt(7)
v_add_f32 v108, v108, v16
M v[200:203],a[212:215],a[184:187]
v_add_f32 v109, v109, v17
v_add_f32 v110, v110, v18
M v[204:207],a[208:211],a[184:187]
v_add_f32 v111, v111, v19
v_accvgpr_read_b32 v16, a52
M v[208:211],a[204:207],a[184:187]
s_waitcnt lgkmcnt(5)
v_accvgpr_read_b32 v17, a53
v_accvgpr_read_b32 v18, a54
M v[188:191],a[204:207],a[188:191]
ds_read_b128 a[184:187], v5 offset:32
buffer_load_dwordx4 a[204:207], v1, s[16:19], s34 offen offset:1024 sc1
M v[184:187],a[208:211],a[188:191]
v_accvgpr_read_b32 v19, a55
M v[180:183],a[212:215],a[188:191]
buffer_load_dwordx4 a[208:211], v1, s[16:19], s34 offen offset:2048 sc1
s_waitcnt lgkmcnt(7)
v_add_f32 v148, v148, v16
M v[176:179],a[216:219],a[188:191]
s_waitcnt vmcnt(25)
v_add_f32 v149, v149, v17
v_add_f32 v150, v150, v18
M v[176:179],v[68:71],a[160:163]
ds_read_b128 a[188:191], v4 offset:32
buffer_load_dwordx4 a[212:215], v1, s[16:19], s34 offen offset:3072 sc1
M v[180:183],a[232:235],a[160:163]
s_add_u32 s34, s34, 4096
v_add_f32 v151, v151, v19
M v[184:187],a[228:231],a[160:163]
M v[188:191],a[224:227],a[160:163]
buffer_load_dwordx4 a[216:219], v1, s[16:19], s34 offen offset:0 sc1
M v[192:195],a[220:223],a[160:163]
s_waitcnt lgkmcnt(5)
M v[212:215],a[220:223],a[164:167]
ds_read_b128 a[160:163], v2 offset:96
M v[208:211],a[224:227],a[164:167]
M v[204:207],a[228:231],a[164:167]
M v[200:203],a[232:235],a[164:167]
M v[196:199],v[68:71],a[164:167]
M v[216:219],v[68:71],a[168:171]
ds_read_b128 a[164:167], v3 offset:96
M v[220:223],a[232:235],a[168:171]
M v[224:227],a[228:231],a[168:171]
M v[228:231],a[224:227],a[168:171]
M v[232:235],a[220:223],a[168:171]
s_waitcnt lgkmcnt(5)
M v[252:255],a[220:223],a[172:175]
ds_read_b128 a[168:171], v2 offset:9312
buffer_load_dwordx4 a[220:223], v1, s[16:19], s34 offen offset:1024 sc1
M v[248:251],a[224:227],a[172:175]
M v[244:247],a[228:231],a[172:175]
M v[240:243],a[232:235],a[172:175]
buffer_load_dwordx4 a[224:227], v1, s[16:19], s34 offen offset:2048 sc1
M v[236:239],v[68:71],a[172:175]
s_waitcnt vmcnt(25)
M v[236:239],a[252:255],a[176:179]
ds_read_b128 a[172:175], v3 offset:9312
M v[240:243],a[248:251],a[176:179]
buffer_load_dwordx4 a[228:231], v1, s[16:19], s34 offen offset:3072 sc1
s_add_u32 s34, s34, 4096
M v[244:247],a[244:247],a[176:179]
M v[248:251],a[240:243],a[176:179]
s_waitcnt lgkmcnt(5)
M v[228:231],a[240:243],a[180:183]
ds_read_b128 a[176:179], v5 offset:9312
buffer_load_dwordx4 a[232:235], v1, s[16:19], s34 offen offset:0 sc1
M v[224:227],a[244:247],a[180:183]
s_add_u32 s34, s34, 1024
M v[220:223],a[248:251],a[180:183]
M v[216:219],a[252:255],a[180:183]
M v[196:199],a[252:255],a[184:187]
ds_read_b128 a[180:183], v4 offset:9312
buffer_load_dwordx4 v[68:71], v1, s[16:19], s34 offen offset:0 sc1
M v[200:203],a[248:251],a[184:187]
M v[204:207],a[244:247],a[184:187]
M v[208:211],a[240:243],a[184:187]
s_waitcnt lgkmcnt(5)
M v[188:191],a[240:243],a[188:191]
ds_read_b128 a[184:187], v5 offset:96
buffer_load_dwordx4 a[240:243], v1, s[16:19], s34 offen offset:1024 sc1
M v[184:187],a[244:247],a[188:191]
M v[180:183],a[248:251],a[188:191]
M v[176:179],a[252:255],a[188:191]
s_waitcnt vmcnt(24)
buffer_load_dwordx4 a[244:247], v1, s[16:19], s34 offen offset:2048 sc1
M v[176:179],a[200:203],a[160:163]
ds_read_b128 a[188:191], v4 offset:96
M v[180:183],v[36:39],a[160:163]
M v[184:187],v[40:43],a[160:163]
buffer_load_dwordx4 a[248:251], v1, s[16:19], s34 offen offset:3072 sc1
s_add_u32 s34, s34, 4096
M v[188:191],v[44:47],a[160:163]
M v[192:195],v[48:51],a[160:163]
s_waitcnt lgkmcnt(5)
M v[212:215],v[48:51],a[164:167]
ds_read_b128 a[160:163], v2 offset:160
buffer_load_dwordx4 a[252:255], v1, s[16:19], s34 offen offset:0 sc1
M v[208:211],v[44:47],a[164:167]
M v[204:207],v[40:43],a[164:167]
M v[200:203],v[36:39],a[164:167]
M v[196:199],a[200:203],a[164:167]
M v[216:219],a[200:203],a[168:171]
ds_read_b128 a[164:167], v3 offset:160
M v[220:223],v[36:39],a[168:171]
M v[224:227],v[40:43],a[168:171]
M v[228:231],v[44:47],a[168:171]
M v[232:235],v[48:51],a[168:171]
s_waitcnt lgkmcnt(5)
M v[252:255],v[48:51],a[172:175]
ds_read_b128 a[168:171], v2 offset:9376
buffer_load_dwordx4 v[48:51], v1, s[16:19], s34 offen offset:1024 sc1
M v[248:251],v[44:47],a[172:175]
M v[244:247],v[40:43],a[172:175]
M v[240:243],v[36:39],a[172:175]
buffer_load_dwordx4 v[44:47], v1, s[16:19], s34 offen offset:2048 sc1
M v[236:239],a[200:203],a[172:175]
s_waitcnt vmcnt(25)
M v[236:239],v[52:55],a[176:179]
ds_read_b128 a[172:175], v3 offset:9376
M v[240:243],v[56:59],a[176:179]
buffer_load_dwordx4 v[40:43], v1, s[16:19], s34 offen offset:3072 sc1
s_add_u32 s34, s34, 4096
M v[244:247],v[60:63],a[176:179]
M v[248:251],v[64:67],a[176:179]
s_waitcnt lgkmcnt(5)
M v[228:231],v[64:67],a[180:183]
ds_read_b128 a[176:179], v5 offset:9376
buffer_load_dwordx4 v[36:39], v1, s[16:19], s34 offen offset:0 sc1
M v[224:227],v[60:63],a[180:183]
s_add_u32 s34, s34, 1024
M v[220:223],v[56:59],a[180:183]
M v[216:219],v[52:55],a[180:183]
M v[196:199],v[52:55],a[184:187]
ds_read_b128 a[180:183], v4 offset:9376
buffer_load_dwordx4 a[200:203], v1, s[16:19], s34 offen offset:0 sc1
M v[200:203],v[56:59],a[184:187]
M v[204:207],v[60:63],a[184:187]
M v[208:211],v[64:67],a[184:187]
s_waitcnt lgkmcnt(5)
M v[188:191],v[64:67],a[188:191]
ds_read_b128 a[184:187], v5 offset:160
buffer_load_dwordx4 v[64:67], v1, s[16:19], s34 offen offset:1024 sc1
M v[184:187],v[60:63],a[188:191]
M v[180:183],v[56:59],a[188:191]
M v[176:179],v[52:55],a[188:191]
s_waitcnt vmcnt(24)
buffer_load_dwordx4 v[60:63], v1, s[16:19], s34 offen offset:2048 sc1
s_getpc_b64 s[4:5]
L_pc2:
M v[176:179],a[236:239],a[160:163]
ds_read_b128 a[188:191], v4 offset:160
s_lshr_b32 s3, s100, 3
M v[180:183],v[72:75],a[160:163]
s_lshl_b32 s3, s3, 2
s_add_u32 s3, s3, s28
M v[184:187],v[76:79],a[160:163]
buffer_load_dwordx4 v[56:59], v1, s[16:19], s34 offen offset:3072 sc1
s_add_u32 s34, s34, 4096
M v[188:191],v[80:83],a[160:163]
s_lshl_b32 s3, s3, 8
v_and_b32 v24, 3, v0
M v[192:195],v[84:87],a[160:163]
s_waitcnt lgkmcnt(5)
v_lshlrev_b32 v24, 6, v24
v_add_u32 v24, s3, v24
M v[212:215],v[84:87],a[164:167]
ds_read_b128 a[160:163], v2 offset:224
buffer_load_dwordx4 v[52:55], v1, s[16:19], s34 offen offset:0 sc1
M v[208:211],v[80:83],a[164:167]
v_min_u32 v24, L_codeend-L_pc2-4, v24
M v[204:207],v[76:79],a[164:167]
global_load_dword v25, v24, s[4:5]
M v[200:203],v[72:75],a[164:167]
M v[196:199],a[236:239],a[164:167]
M v[216:219],a[236:239],a[168:171]
ds_read_b128 a[164:167], v3 offset:224
M v[220:223],v[72:75],a[168:171]
M v[224:227],v[76:79],a[168:171]
M v[228:231],v[80:83],a[168:171]
M v[232:235],v[84:87],a[168:171]
s_waitcnt lgkmcnt(5)
M v[252:255],v[84:87],a[172:175]
ds_read_b128 a[168:171], v2 offset:9440
buffer_load_dwordx4 v[84:87], v1, s[16:19], s34 offen offset:1024 sc1
M v[248:251],v[80:83],a[172:175]
M v[244:247],v[76:79],a[172:175]
M v[240:243],v[72:75],a[172:175]
buffer_load_dwordx4 v[80:83], v1, s[16:19], s34 offen offset:2048 sc1
M v[236:239],a[236:239],a[172:175]
s_waitcnt vmcnt(26)
M v[236:239],v[88:91],a[176:179]
ds_read_b128 a[172:175], v3 offset:9440
M v[240:243],v[92:95],a[176:179]
buffer_load_dwordx4 v[76:79], v1, s[16:19], s34 offen offset:3072 sc1
s_add_u32 s34, s34, 4096
M v[244:247],a[192:195],a[176:179]
M v[248:251],a[196:199],a[176:179]
s_waitcnt lgkmcnt(5)
M v[228:231],a[196:199],a[180:183]
ds_read_b128 a[176:179], v5 offset:9440
buffer_load_dwordx4 v[72:75], v1, s[16:19], s34 offen offset:0 sc1
M v[224:227],a[192:195],a[180:183]
s_add_u32 s34, s34, 1024
M v[220:223],v[92:95],a[180:183]
M v[216:219],v[88:91],a[180:183]
M v[196:199],v[88:91],a[184:187]
ds_read_b128 a[180:183], v4 offset:9440
buffer_load_dwordx4 a[236:239], v1, s[16:19], s34 offen offset:0 sc1
M v[200:203],v[92:95],a[184:187]
M v[204:207],a[192:195],a[184:187]
M v[208:211],a[196:199],a[184:187]
s_waitcnt lgkmcnt(5)
M v[188:191],a[196:199],a[188:191]
ds_read_b128 a[184:187], v5 offset:224
buffer_load_dwordx4 a[196:199], v1, s[16:19], s34 offen offset:1024 sc1
M v[184:187],a[192:195],a[188:191]
M v[180:183],v[92:95],a[188:191]
M v[176:179],v[88:91],a[188:191]
s_waitcnt vmcnt(25)
buffer_load_dwordx4 a[192:195], v1, s[16:19], s34 offen offset:2048 sc1
M v[176:179],v[32:35],a[160:163]
ds_read_b128 a[188:191], v4 offset:224
M v[180:183],a[204:207],a[160:163]
v_add_u32 v2, s11, v2
v_add_u32 v3, s11, v3
M v[184:187],a[208:211],a[160:163]
v_add_u32 v4, s11, v4
v_add_u32 v5, s11, v5
M v[188:191],a[212:215],a[160:163]
v_add_u32 v6, s11, v6
v_add_u32 v7, s11, v7
M v[192:195],a[216:219],a[160:163]
s_waitcnt lgkmcnt(5)
v_add_u32 v8, s11, v8
v_add_u32 v9, s11, v9
M v[212:215],a[216:219],a[164:167]
ds_read_b128 a[160:163], v2 offset:2880
buffer_load_dwordx4 v[92:95], v1, s[16:19], s34 offen offset:3072 sc1
M v[208:211],a[212:215],a[164:167]
s_add_u32 s34, s34, 4096
s_mul_i32 s3, s28, 10240
M v[204:207],a[208:211],a[164:167]
s_add_u32 s3, s3, 51200
v_add_u32 v14, s3, v1
M v[200:203],a[204:207],a[164:167]
s_xor_b32 s3, s28, 2
s_mul_i32 s3, s3, 10240
M v[196:199],v[32:35],a[164:167]
buffer_load_dwordx4 v[88:91], v1, s[16:19], s34 offen offset:0 sc1
s_add_u32 s3, s3, 51200
M v[216:219],v[32:35],a[168:171]
ds_read_b128 a[164:167], v3 offset:2880
v_add_u32 v15, s3, v1
M v[220:223],a[204:207],a[168:171]
M v[224:227],a[208:211],a[168:171]
v_add_f32 v112, v112, v192
v_add_f32 v113, v113, v193
M v[228:231],a[212:215],a[168:171]
v_add_f32 v114, v114, v194
v_add_f32 v115, v115, v195
M v[232:235],a[216:219],a[168:171]
s_waitcnt lgkmcnt(5)
v_add_f32 v132, v132, v212
v_add_f32 v133, v133, v213
M v[252:255],a[216:219],a[172:175]
ds_read_b128 a[168:171], v2 offset:12096
buffer_load_dwordx4 a[216:219], v1, s[16:19], s34 offen offset:1024 sc1
M v[248:251],a[212:215],a[172:175]
v_add_f32 v134, v134, v214
v_add_f32 v135, v135, v215
M v[244:247],a[208:211],a[172:175]
M v[240:243],a[204:207],a[172:175]
buffer_load_dwordx4 a[212:215], v1, s[16:19], s34 offen offset:2048 sc1
M v[236:239],v[32:35],a[172:175]
s_waitcnt vmcnt(26)
M v[236:239],a[220:223],a[176:179]
ds_read_b128 a[172:175], v3 offset:12096
M v[240:243],a[224:227],a[176:179]
buffer_load_dwordx4 a[208:211], v1, s[16:19], s34 offen offset:3072 sc1
s_add_u32 s34, s34, 4096
M v[244:247],a[228:231],a[176:179]
v_add_f32 v152, v152, v232
v_add_f32 v153, v153, v233
M v[248:251],a[232:235],a[176:179]
s_waitcnt lgkmcnt(5)
v_add_f32 v154, v154, v234
v_add_f32 v155, v155, v235
M v[228:231],a[232:235],a[180:183]
ds_read_b128 a[176:179], v5 offset:12096
buffer_load_dwordx4 a[204:207], v1, s[16:19], s34 offen offset:0 sc1
M v[224:227],a[228:231],a[180:183]
s_add_u32 s34, s34, 1024
v_add_f32 v172, v172, v252
M v[220:223],a[224:227],a[180:183]
v_add_f32 v173, v173, v253
v_add_f32 v174, v174, v254
M v[216:219],a[220:223],a[180:183]
v_add_f32 v175, v175, v255
M v[196:199],a[220:223],a[184:187]
ds_read_b128 a[180:183], v4 offset:12096
buffer_load_dwordx4 v[32:35], v1, s[16:19], s34 offen offset:0 sc1
M v[200:203],a[224:227],a[184:187]
v_add_f32 v156, v156, v236
v_add_f32 v157, v157, v237
M v[204:207],a[228:231],a[184:187]
v_add_f32 v158, v158, v238
v_add_f32 v159, v159, v239
M v[208:211],a[232:235],a[184:187]
s_waitcnt lgkmcnt(5)
v_add_f32 v160, v160, v240
v_add_f32 v161, v161, v241
M v[188:191],a[232:235],a[188:191]
ds_read_b128 a[184:187], v5 offset:2880
buffer_load_dwordx4 a[232:235], v1, s[16:19], s34 offen offset:1024 sc1
M v[184:187],a[228:231],a[188:191]
v_add_f32 v162, v162, v242
v_add_f32 v163, v163, v243
M v[180:183],a[224:227],a[188:191]
v_add_f32 v164, v164, v244
v_add_f32 v165, v165, v245
M v[176:179],a[220:223],a[188:191]
s_waitcnt vmcnt(25)
buffer_load_dwordx4 a[228:231], v1, s[16:19], s34 offen offset:2048 sc1
v_add_f32 v166, v166, v246
M v[96:99],v[68:71],a[160:163]
ds_read_b128 a[188:191], v4 offset:2880
v_add_f32 v167, v167, v247
M v[100:103],a[240:243],a[160:163]
v_add_f32 v168, v168, v248
v_add_f32 v169, v169, v249
M v[104:107],a[244:247],a[160:163]
buffer_load_dwordx4 a[224:227], v1, s[16:19], s34 offen offset:3072 sc1
s_add_u32 s34, s34, 4096
M v[108:111],a[248:251],a[160:163]
v_add_f32 v170, v170, v250
v_add_f32 v171, v171, v251
M v[112:115],a[252:255],a[160:163]
s_waitcnt lgkmcnt(5)
v_add_f32 v148, v148, v228
v_add_f32 v149, v149, v229
M v[132:135],a[252:255],a[164:167]
ds_read_b128 a[160:163], v2 offset:2944
buffer_load_dwordx4 a[220:223], v1, s[16:19], s34 offen offset:0 sc1
M v[128:131],a[248:251],a[164:167]
v_add_f32 v150, v150, v230
v_add_f32 v151, v151, v231
M v[124:127],a[244:247],a[164:167]
v_add_f32 v144, v144, v224
v_add_f32 v145, v145, v225
M v[120:123],a[240:243],a[164:167]
v_add_f32 v146, v146, v226
v_add_f32 v147, v147, v227
M v[116:119],v[68:71],a[164:167]
M v[136:139],v[68:71],a[168:171]
ds_read_b128 a[164:167], v3 offset:2944
M v[140:143],a[240:243],a[168:171]
M v[144:147],a[244:247],a[168:171]
M v[148:151],a[248:251],a[168:171]
M v[152:155],a[252:255],a[168:171]
s_waitcnt lgkmcnt(5)
M v[172:175],a[252:255],a[172:175]
ds_read_b128 a[168:171], v2 offset:12160
buffer_load_dwordx4 a[252:255], v1, s[16:19], s34 offen offset:1024 sc1
M v[168:171],a[248:251],a[172:175]
M v[164:167],a[244:247],a[172:175]
M v[160:163],a[240:243],a[172:175]
buffer_load_dwordx4 a[248:251], v1, s[16:19], s34 offen offset:2048 sc1
M v[156:159],v[68:71],a[172:175]
s_waitcnt vmcnt(26)
v_add_f32 v140, v140, v220
v_add_f32 v141, v141, v221
M v[156:159],v[48:51],a[176:179]
ds_read_b128 a[172:175], v3 offset:12160
v_add_f32 v142, v142, v222
M v[160:163],v[44:47],a[176:179]
buffer_load_dwordx4 a[244:247], v1, s[16:19], s34 offen offset:3072 sc1
s_add_u32 s34, s34, 4096
M v[164:167],v[40:43],a[176:179]
v_add_f32 v143, v143, v223
v_add_f32 v136, v136, v216
M v[168:171],v[36:39],a[176:179]
s_waitcnt lgkmcnt(5)
v_add_f32 v137, v137, v217
v_add_f32 v138, v138, v218
M v[148:151],v[36:39],a[180:183]
ds_read_b128 a[176:179], v5 offset:12160
buffer_load_dwordx4 a[240:243], v1, s[16:19], s34 offen offset:0 sc1
M v[144:147],v[40:43],a[180:183]
s_add_u32 s34, s34, 1024
M v[140:143],v[44:47],a[180:183]
M v[136:139],v[48:51],a[180:183]
M v[116:119],v[48:51],a[184:187]
ds_read_b128 a[180:183], v4 offset:12160
buffer_load_dwordx4 v[68:71], v1, s[16:19], s34 offen offset:0 sc1
M v[120:123],v[44:47],a[184:187]
M v[124:127],v[40:43],a[184:187]
M v[128:131],v[36:39],a[184:187]
s_waitcnt lgkmcnt(5)
M v[108:111],v[36:39],a[188:191]
ds_read_b128 a[184:187], v5 offset:2944
buffer_load_dwordx4 v[36:39], v1, s[16:19], s34 offen offset:1024 sc1
M v[104:107],v[40:43],a[188:191]
M v[100:103],v[44:47],a[188:191]
M v[96:99],v[48:51],a[188:191]
s_waitcnt vmcnt(25)
buffer_load_dwordx4 v[40:43], v1, s[16:19], s34 offen offset:2048 sc1
v_add_f32 v139, v139, v219
M v[96:99],a[200:203],a[160:163]
ds_read_b128 a[188:191], v4 offset:2944
v_add_f32 v116, v116, v196
M v[100:103],v[64:67],a[160:163]
v_add_f32 v117, v117, v197
v_add_f32 v118, v118, v198
M v[104:107],v[60:63],a[160:163]
buffer_load_dwordx4 v[44:47], v1, s[16:19], s34 offen offset:3072 sc1
s_add_u32 s34, s34, 4096
M v[108:111],v[56:59],a[160:163]
v_add_f32 v119, v119, v199
v_add_f32 v120, v120, v200
M v[112:115],v[52:55],a[160:163]
s_waitcnt lgkmcnt(5)
v_add_f32 v121, v121, v201
v_add_f32 v122, v122, v202
M v[132:135],v[52:55],a[164:167]
ds_read_b128 a[160:163], v2 offset:3008
buffer_load_dwordx4 a[0:3], v1, s[16:19], s34 offen offset:0 sc1
M v[128:131],v[56:59],a[164:167]
M v[124:127],v[60:63],a[164:167]
M v[120:123],v[64:67],a[164:167]
buffer_load_dwordx4 a[4:7], v1, s[16:19], s34 offen offset:1024 sc1
M v[116:119],a[200:203],a[164:167]
M v[136:139],a[200:203],a[168:171]
ds_read_b128 a[164:167], v3 offset:3008
M v[140:143],v[64:67],a[168:171]
buffer_load_dwordx4 a[8:11], v1, s[16:19], s34 offen offset:2048 sc1
M v[144:147],v[60:63],a[168:171]
M v[148:151],v[56:59],a[168:171]
M v[152:155],v[52:55],a[168:171]
s_waitcnt lgkmcnt(5)
buffer_load_dwordx4 a[12:15], v1, s[16:19], s34 offen offset:3072 sc1
s_add_u32 s34, s34, 4096
M v[172:175],v[52:55],a[172:175]
ds_read_b128 a[168:171], v2 offset:12224
M v[168:171],v[56:59],a[172:175]
v_add_f32 v123, v123, v203
v_add_f32 v124, v124, v204
M v[164:167],v[60:63],a[172:175]
buffer_load_dwordx4 a[16:19], v1, s[16:19], s34 offen offset:0 sc1
s_add_u32 s34, s34, 1024
M v[160:163],v[64:67],a[172:175]
v_add_f32 v125, v125, v205
v_add_f32 v126, v126, v206
M v[156:159],a[200:203],a[172:175]
s_waitcnt vmcnt(27)
v_add_f32 v127, v127, v207
v_add_f32 v128, v128, v208
M v[156:159],v[84:87],a[176:179]
ds_read_b128 a[172:175], v3 offset:12224
buffer_load_dwordx4 a[20:23], v1, s[16:19], s34 offen offset:0 sc1
M v[160:163],v[80:83],a[176:179]
v_add_f32 v129, v129, v209
v_add_f32 v130, v130, v210
M v[164:167],v[76:79],a[176:179]
v_add_f32 v131, v131, v211
v_add_f32 v108, v108, v188
M v[168:171],v[72:75],a[176:179]
s_waitcnt lgkmcnt(5)
buffer_load_dwordx4 a[24:27], v1, s[16:19], s34 offen offset:1024 sc1
v_add_f32 v109, v109, v189
M v[148:151],v[72:75],a[180:183]
ds_read_b128 a[176:179], v5 offset:12224
v_add_f32 v110, v110, v190
M v[144:147],v[76:79],a[180:183]
v_add_f32 v111, v111, v191
v_add_f32 v104, v104, v184
M v[140:143],v[80:83],a[180:183]
buffer_load_dwordx4 a[28:31], v1, s[16:19], s34 offen offset:2048 sc1
v_add_f32 v105, v105, v185
M v[136:139],v[84:87],a[180:183]
v_add_f32 v106, v106, v186
v_add_f32 v107, v107, v187
M v[116:119],v[84:87],a[184:187]
ds_read_b128 a[180:183], v4 offset:12224
v_add_f32 v100, v100, v180
M v[120:123],v[80:83],a[184:187]
buffer_load_dwordx4 v[48:51], v1, s[16:19], s34 offen offset:3072 sc1
s_add_u32 s34, s34, 4096
M v[124:127],v[76:79],a[184:187]
v_add_f32 v101, v101, v181
v_add_f32 v102, v102, v182
M v[128:131],v[72:75],a[184:187]
s_waitcnt lgkmcnt(5)
v_add_f32 v103, v103, v183
v_add_f32 v96, v96, v176
M v[108:111],v[72:75],a[188:191]
ds_read_b128 a[184:187], v5 offset:3008
buffer_load_dwordx4 v[52:55], v1, s[16:19], s34 offen offset:0 sc1
M v[104:107],v[76:79],a[188:191]
M v[100:103],v[80:83],a[188:191]
M v[96:99],v[84:87],a[188:191]
s_waitcnt vmcnt(27)
buffer_load_dwordx4 v[56:59], v1, s[16:19], s34 offen offset:1024 sc1
s_waitcnt lgkmcnt(0)
s_barrier
M v[96:99],a[236:239],a[160:163]
ds_read_b128 a[188:191], v4 offset:3008
M v[100:103],a[196:199],a[160:163]
ds_write_b64 v14, a[116:117] offset:0
M v[104:107],a[192:195],a[160:163]
buffer_load_dwordx4 v[60:63], v1, s[16:19], s34 offen offset:2048 sc1
M v[108:111],v[92:95],a[160:163]
ds_write_b64 v14, a[118:119] offset:8
M v[112:115],v[88:91],a[160:163]
s_waitcnt lgkmcnt(7)
ds_write_b64 v14, a[156:157] offset:1024
M v[132:135],v[88:91],a[164:167]
ds_read_b128 a[160:163], v2 offset:3072
buffer_load_dwordx4 v[64:67], v1, s[16:19], s34 offen offset:3072 sc1
M v[128:131],v[92:95],a[164:167]
s_add_u32 s34, s34, 4096
M v[124:127],a[192:195],a[164:167]
ds_write_b64 v14, a[158:159] offset:1032
M v[120:123],a[196:199],a[164:167]
v_add_f32 v97, v97, v177
v_add_f32 v98, v98, v178
M v[116:119],a[236:239],a[164:167]
buffer_load_dwordx4 a[200:203], v1, s[16:19], s34 offen offset:0 sc1
s_add_u32 s34, s34, 1024
M v[136:139],a[236:239],a[168:171]
ds_read_b128 a[164:167], v3 offset:3072
v_add_f32 v99, v99, v179
M v[140:143],a[196:199],a[168:171]
ds_write_b64 v14, a[96:97] offset:2048
M v[144:147],a[192:195],a[168:171]
buffer_load_dwordx4 v[72:75], v1, s[16:19], s34 offen offset:0 sc1
M v[148:151],v[92:95],a[168:171]
ds_write_b64 v14, a[98:99] offset:2056
M v[152:155],v[88:91],a[168:171]
s_waitcnt lgkmcnt(11)
ds_write_b64 v14, a[136:137] offset:3072
M v[172:175],v[88:91],a[172:175]
ds_read_b128 a[168:171], v2 offset:12288
buffer_load_dwordx4 v[76:79], v1, s[16:19], s34 offen offset:1024 sc1
M v[168:171],v[92:95],a[172:175]
ds_write_b64 v14, a[138:139] offset:3080
M v[164:167],a[192:195],a[172:175]
ds_write_b64 v14, a[100:101] offset:4096
M v[160:163],a[196:199],a[172:175]
buffer_load_dwordx4 v[80:83], v1, s[16:19], s34 offen offset:2048 sc1
M v[156:159],a[236:239],a[172:175]
s_waitcnt vmcnt(30)
ds_write_b64 v14, a[102:103] offset:4104
M v[156:159],a[216:219],a[176:179]
ds_read_b128 a[172:175], v3 offset:12288
M v[160:163],a[212:215],a[176:179]
buffer_load_dwordx4 v[84:87], v1, s[16:19], s34 offen offset:3072 sc1
s_add_u32 s34, s34, 4096
M v[164:167],a[208:211],a[176:179]
ds_write_b64 v14, a[140:141] offset:5120
M v[168:171],a[204:207],a[176:179]
s_waitcnt lgkmcnt(15)
ds_write_b64 v14, a[142:143] offset:5128
M v[148:151],a[204:207],a[180:183]
ds_read_b128 a[176:179], v5 offset:12288
buffer_load_dwordx4 v[88:91], v1, s[16:19], s34 offen offset:0 sc1
M v[144:147],a[208:211],a[180:183]
ds_write_b64 v14, a[80:81] offset:6144
M v[140:143],a[212:215],a[180:183]
ds_write_b64 v14, a[82:83] offset:6152
M v[136:139],a[216:219],a[180:183]
buffer_load_dwordx4 v[92:95], v1, s[16:19], s34 offen offset:1024 sc1
M v[116:119],a[216:219],a[184:187]
ds_read_b128 a[180:183], v4 offset:12288
M v[120:123],a[212:215],a[184:187]
ds_write_b64 v14, a[120:121] offset:7168
M v[124:127],a[208:211],a[184:187]
buffer_load_dwordx4 a[192:195], v1, s[16:19], s34 offen offset:2048 sc1
M v[128:131],a[204:207],a[184:187]
s_waitcnt lgkmcnt(15)
ds_write_b64 v14, a[122:123] offset:7176
M v[108:111],a[204:207],a[188:191]
ds_read_b128 a[184:187], v5 offset:3072
M v[104:107],a[208:211],a[188:191]
buffer_load_dwordx4 a[196:199], v1, s[16:19], s34 offen offset:3072 sc1
s_add_u32 s34, s34, 4096
M v[100:103],a[212:215],a[188:191]
ds_write_b64 v14, a[104:105] offset:8192
M v[96:99],a[216:219],a[188:191]
s_waitcnt vmcnt(30)
ds_write_b64 v14, a[106:107] offset:8200
M v[96:99],v[32:35],a[160:163]
ds_read_b128 a[188:191], v4 offset:3072
buffer_load_dwordx4 a[236:239], v1, s[16:19], s34 offen offset:0 sc1
M v[100:103],a[232:235],a[160:163]
s_add_u32 s34, s34, 1024
M v[104:107],a[228:231],a[160:163]
ds_write_b64 v14, a[144:145] offset:9216
M v[108:111],a[224:227],a[160:163]
ds_write_b64 v14, a[146:147] offset:9224
M v[112:115],a[220:223],a[160:163]
s_waitcnt lgkmcnt(15)
buffer_load_dwordx4 a[204:207], v1, s[16:19], s34 offen offset:0 sc1
M v[132:135],a[220:223],a[164:167]
ds_read_b128 a[160:163], v6 offset:3136
M v[128:131],a[224:227],a[164:167]
M v[124:127],a[228:231],a[164:167]
buffer_load_dwordx4 a[208:211], v1, s[16:19], s34 offen offset:1024 sc1
M v[120:123],a[232:235],a[164:167]
M v[116:119],v[32:35],a[164:167]
M v[136:139],v[32:35],a[168:171]
ds_read_b128 a[164:167], v7 offset:3136
buffer_load_dwordx4 a[212:215], v1, s[16:19], s34 offen offset:2048 sc1
M v[140:143],a[232:235],a[168:171]
M v[144:147],a[228:231],a[168:171]
M v[148:151],a[224:227],a[168:171]
buffer_load_dwordx4 a[216:219], v1, s[16:19], s34 offen offset:3072 sc1
s_add_u32 s34, s34, 4096
M v[152:155],a[220:223],a[168:171]
s_waitcnt lgkmcnt(13)
M v[172:175],a[220:223],a[172:175]
ds_read_b128 a[168:171], v6 offset:12352
M v[168:171],a[224:227],a[172:175]
buffer_load_dwordx4 a[220:223], v1, s[16:19], s34 offen offset:0 sc1
M v[164:167],a[228:231],a[172:175]
M v[160:163],a[232:235],a[172:175]
M v[156:159],v[32:35],a[172:175]
s_waitcnt vmcnt(32)
buffer_load_dwordx4 a[224:227], v1, s[16:19], s34 offen offset:1024 sc1
M v[156:159],a[252:255],a[176:179]
ds_read_b128 a[172:175], v7 offset:12352
M v[160:163],a[248:251],a[176:179]
M v[164:167],a[244:247],a[176:179]
buffer_load_dwordx4 a[228:231], v1, s[16:19], s34 offen offset:2048 sc1
M v[168:171],a[240:243],a[176:179]
s_waitcnt lgkmcnt(9)
M v[148:151],a[240:243],a[180:183]
ds_read_b128 a[176:179], v9 offset:12352
M v[144:147],a[244:247],a[180:183]
buffer_load_dwordx4 a[232:235], v1, s[16:19], s34 offen offset:3072 sc1
s_add_u32 s34, s34, 4096
M v[140:143],a[248:251],a[180:183]
M v[136:139],a[252:255],a[180:183]
M v[116:119],a[252:255],a[184:187]
ds_read_b128 a[180:183], v8 offset:12352
buffer_load_dwordx4 v[32:35], v1, s[16:19], s34 offen offset:0 sc1
M v[120:123],a[248:251],a[184:187]
s_add_u32 s34, s34, 1024
M v[124:127],a[244:247],a[184:187]
M v[128:131],a[240:243],a[184:187]
s_waitcnt lgkmcnt(5)
M v[108:111],a[240:243],a[188:191]
ds_read_b128 a[184:187], v9 offset:3136
buffer_load_dwordx4 a[240:243], v1, s[16:19], s34 offen offset:0 sc1
M v[104:107],a[244:247],a[188:191]
M v[100:103],a[248:251],a[188:191]
M v[96:99],a[252:255],a[188:191]
s_waitcnt vmcnt(32)
buffer_load_dwordx4 a[244:247], v1, s[16:19], s34 offen offset:1024 sc1
M v[96:99],v[68:71],a[160:163]
ds_read_b128 a[188:191], v8 offset:3136
M v[100:103],v[36:39],a[160:163]
M v[104:107],v[40:43],a[160:163]
buffer_load_dwordx4 a[248:251], v1, s[16:19], s34 offen offset:2048 sc1
M v[108:111],v[44:47],a[160:163]
M v[112:115],a[0:3],a[160:163]
s_waitcnt lgkmcnt(5)
M v[132:135],a[0:3],a[164:167]
ds_read_b128 a[160:163], v2 offset:2336
buffer_load_dwordx4 a[252:255], v1, s[16:19], s34 offen offset:3072 sc1
M v[128:131],v[44:47],a[164:167]
s_add_u32 s34, s34, 4096
M v[124:127],v[40:43],a[164:167]
M v[120:123],v[36:39],a[164:167]
M v[116:119],v[68:71],a[164:167]
M v[136:139],v[68:71],a[168:171]
ds_read_b128 a[164:167], v3 offset:2336
M v[140:143],v[36:39],a[168:171]
M v[144:147],v[40:43],a[168:171]
M v[148:151],v[44:47],a[168:171]
M v[152:155],a[0:3],a[168:171]
s_waitcnt lgkmcnt(5)
M v[172:175],a[0:3],a[172:175]
ds_read_b128 a[168:171], v2 offset:11552
buffer_load_dwordx4 a[0:3], v1, s[16:19], s34 offen offset:0 sc1
M v[168:171],v[44:47],a[172:175]
M v[164:167],v[40:43],a[172:175]
M v[160:163],v[36:39],a[172:175]
buffer_load_dwordx4 v[44:47], v1, s[16:19], s34 offen offset:1024 sc1
M v[156:159],v[68:71],a[172:175]
s_waitcnt vmcnt(33)
M v[156:159],a[4:7],a[176:179]
ds_read_b128 a[172:175], v3 offset:11552
M v[160:163],a[8:11],a[176:179]
buffer_load_dwordx4 v[40:43], v1, s[16:19], s34 offen offset:2048 sc1
M v[164:167],a[12:15],a[176:179]
M v[168:171],a[16:19],a[176:179]
s_waitcnt lgkmcnt(5)
M v[148:151],a[16:19],a[180:183]
ds_read_b128 a[176:179], v5 offset:11552
buffer_load_dwordx4 v[36:39], v1, s[16:19], s34 offen offset:3072 sc1
M v[144:147],a[12:15],a[180:183]
s_add_u32 s34, s34, 4096
M v[140:143],a[8:11],a[180:183]
M v[136:139],a[4:7],a[180:183]
M v[116:119],a[4:7],a[184:187]
ds_read_b128 a[180:183], v4 offset:11552
buffer_load_dwordx4 v[68:71], v1, s[16:19], s34 offen offset:0 sc1
M v[120:123],a[8:11],a[184:187]
s_add_u32 s34, s34, 1024
M v[124:127],a[12:15],a[184:187]
M v[128:131],a[16:19],a[184:187]
s_waitcnt lgkmcnt(5)
M v[108:111],a[16:19],a[188:191]
ds_read_b128 a[184:187], v5 offset:2336
buffer_load_dwordx4 a[16:19], v1, s[16:19], s34 offen offset:0 sc1
M v[104:107],a[12:15],a[188:191]
M v[100:103],a[8:11],a[188:191]
M v[96:99],a[4:7],a[188:191]
s_waitcnt vmcnt(32)
buffer_load_dwordx4 a[12:15], v1, s[16:19], s34 offen offset:1024 sc1
s_waitcnt lgkmcnt(0)
s_barrier
M v[96:99],a[20:23],a[160:163]
ds_read_b128 a[188:191], v4 offset:2336
ds_read_b128 v[16:19], v15 offset:0
M v[100:103],a[24:27],a[160:163]
ds_read_b128 v[20:23], v15 offset:1024
ds_read_b128 v[24:27], v15 offset:2048
M v[104:107],a[28:31],a[160:163]
buffer_load_dwordx4 a[8:11], v1, s[16:19], s34 offen offset:2048 sc1
ds_read_b128 v[28:31], v15 offset:3072
M v[108:111],v[48:51],a[160:163]
v_accvgpr_read_b32 v10, a116
v_accvgpr_read_b32 v11, a117
M v[112:115],v[52:55],a[160:163]
s_waitcnt lgkmcnt(9)
v_add_f32 v212, v212, v10
v_add_f32 v213, v213, v11
M v[132:135],v[52:55],a[164:167]
ds_read_b128 a[160:163], v2 offset:2400
buffer_load_dwordx4 a[4:7], v1, s[16:19], s34 offen offset:3072 sc1
M v[128:131],v[48:51],a[164:167]
s_add_u32 s34, s34, 4096
v_accvgpr_read_b32 v10, a118
M v[124:127],a[28:31],a[164:167]
v_accvgpr_read_b32 v11, a119
v_add_f32 v214, v214, v10
M v[120:123],a[24:27],a[164:167]
v_add_f32 v215, v215, v11
v_accvgpr_read_b32 v10, a156
M v[116:119],a[20:23],a[164:167]
v_accvgpr_read_b32 v11, a157
v_add_f32 v252, v252, v10
M v[136:139],a[20:23],a[168:171]
ds_read_b128 a[164:167], v3 offset:2400
v_add_f32 v253, v253, v11
M v[140:143],a[24:27],a[168:171]
v_accvgpr_read_b32 v10, a158
v_accvgpr_read_b32 v11, a159
M v[144:147],a[28:31],a[168:171]
v_add_f32 v254, v254, v10
v_add_f32 v255, v255, v11
M v[148:151],v[48:51],a[168:171]
s_waitcnt lgkmcnt(4)
v_add_f32 v212, v212, v16
v_add_f32 v213, v213, v17
M v[152:155],v[52:55],a[168:171]
s_waitcnt lgkmcnt(9)
v_add_f32 v214, v214, v18
v_add_f32 v215, v215, v19
M v[172:175],v[52:55],a[172:175]
ds_read_b128 a[168:171], v2 offset:11616
buffer_load_dwordx4 v[52:55], v1, s[16:19], s34 offen offset:0 sc1
M v[168:171],v[48:51],a[172:175]
v_add_f32 v252, v252, v20
v_add_f32 v253, v253, v21
M v[164:167],a[28:31],a[172:175]
v_add_f32 v254, v254, v22
v_add_f32 v255, v255, v23
M v[160:163],a[24:27],a[172:175]
buffer_load_dwordx4 v[48:51], v1, s[16:19], s34 offen offset:1024 sc1
ds_read_b128 v[16:19], v15 offset:4096
M v[156:159],a[20:23],a[172:175]
s_waitcnt vmcnt(33)
ds_read_b128 v[20:23], v15 offset:5120
M v[156:159],v[56:59],a[176:179]
ds_read_b128 a[172:175], v3 offset:11616
M v[160:163],v[60:63],a[176:179]
buffer_load_dwordx4 a[28:31], v1, s[16:19], s34 offen offset:2048 sc1
M v[164:167],v[64:67],a[176:179]
ds_write_b64 v15, a[84:85] offset:0
M v[168:171],a[200:203],a[176:179]
s_waitcnt lgkmcnt(12)
ds_write_b64 v15, a[86:87] offset:8
M v[148:151],a[200:203],a[180:183]
ds_read_b128 a[176:179], v5 offset:11616
buffer_load_dwordx4 a[24:27], v1, s[16:19], s34 offen offset:3072 sc1
M v[144:147],v[64:67],a[180:183]
s_add_u32 s34, s34, 4096
M v[140:143],v[60:63],a[180:183]
ds_write_b64 v15, a[124:125] offset:1024
M v[136:139],v[56:59],a[180:183]
ds_write_b64 v15, a[126:127] offset:1032
M v[116:119],v[56:59],a[184:187]
ds_read_b128 a[180:183], v4 offset:11616
buffer_load_dwordx4 a[20:23], v1, s[16:19], s34 offen offset:0 sc1
M v[120:123],v[60:63],a[184:187]
s_add_u32 s34, s34, 1024
v_accvgpr_read_b32 v10, a96
M v[124:127],v[64:67],a[184:187]
v_accvgpr_read_b32 v11, a97
v_add_f32 v192, v192, v10
M v[128:131],a[200:203],a[184:187]
s_waitcnt lgkmcnt(11)
v_add_f32 v193, v193, v11
v_accvgpr_read_b32 v10, a98
M v[108:111],a[200:203],a[188:191]
ds_read_b128 a[184:187], v5 offset:2400
buffer_load_dwordx4 a[200:203], v1, s[16:19], s34 offen offset:0 sc1
M v[104:107],v[64:67],a[188:191]
v_accvgpr_read_b32 v11, a99
v_add_f32 v194, v194, v10
M v[100:103],v[60:63],a[188:191]
v_add_f32 v195, v195, v11
v_accvgpr_read_b32 v10, a136
M v[96:99],v[56:59],a[188:191]
s_waitcnt vmcnt(32)
buffer_load_dwordx4 v[64:67], v1, s[16:19], s34 offen offset:1024 sc1
v_accvgpr_read_b32 v11, a137
M v[96:99],v[72:75],a[160:163]
ds_read_b128 a[188:191], v4 offset:2400
v_add_f32 v232, v232, v10
M v[100:103],v[76:79],a[160:163]
v_add_f32 v233, v233, v11
v_accvgpr_read_b32 v10, a138
M v[104:107],v[80:83],a[160:163]
buffer_load_dwordx4 v[60:63], v1, s[16:19], s34 offen offset:2048 sc1
v_accvgpr_read_b32 v11, a139
M v[108:111],v[84:87],a[160:163]
v_add_f32 v234, v234, v10
v_add_f32 v235, v235, v11
M v[112:115],v[88:91],a[160:163]
s_waitcnt lgkmcnt(11)
s_waitcnt lgkmcnt(14)
v_add_f32 v192, v192, v24
v_add_f32 v193, v193, v25
M v[132:135],v[88:91],a[164:167]
ds_read_b128 a[160:163], v2 offset:2464
buffer_load_dwordx4 v[56:59], v1, s[16:19], s34 offen offset:3072 sc1
M v[128:131],v[84:87],a[164:167]
s_add_u32 s34, s34, 4096
v_add_f32 v194, v194, v26
M v[124:127],v[80:83],a[164:167]
v_add_f32 v195, v195, v27
v_add_f32 v232, v232, v28
M v[120:123],v[76:79],a[164:167]
v_add_f32 v233, v233, v29
v_add_f32 v234, v234, v30
M v[116:119],v[72:75],a[164:167]
v_add_f32 v235, v235, v31
M v[136:139],v[72:75],a[168:171]
ds_read_b128 a[164:167], v3 offset:2464
ds_read_b128 v[24:27], v15 offset:6144
M v[140:143],v[76:79],a[168:171]
ds_read_b128 v[28:31], v15 offset:7168
M v[144:147],v[80:83],a[168:171]
ds_write_b64 v15, a[108:109] offset:2048
M v[148:151],v[84:87],a[168:171]
ds_write_b64 v15, a[110:111] offset:2056
M v[152:155],v[88:91],a[168:171]
s_waitcnt lgkmcnt(11)
ds_write_b64 v15, a[148:149] offset:3072
M v[172:175],v[88:91],a[172:175]
ds_read_b128 a[168:171], v2 offset:11680
buffer_load_dwordx4 v[88:91], v1, s[16:19], s34 offen offset:0 sc1
M v[168:171],v[84:87],a[172:175]
ds_write_b64 v15, a[150:151] offset:3080
M v[164:167],v[80:83],a[172:175]
v_accvgpr_read_b32 v10, a100
v_accvgpr_read_b32 v11, a101
M v[160:163],v[76:79],a[172:175]
buffer_load_dwordx4 v[84:87], v1, s[16:19], s34 offen offset:1024 sc1
v_add_f32 v196, v196, v10
M v[156:159],v[72:75],a[172:175]
s_waitcnt vmcnt(33)
v_add_f32 v197, v197, v11
v_accvgpr_read_b32 v10, a102
M v[156:159],v[92:95],a[176:179]
ds_read_b128 a[172:175], v3 offset:11680
v_accvgpr_read_b32 v11, a103
M v[160:163],a[192:195],a[176:179]
buffer_load_dwordx4 v[80:83], v1, s[16:19], s34 offen offset:2048 sc1
v_add_f32 v198, v198, v10
M v[164:167],a[196:199],a[176:179]
v_add_f32 v199, v199, v11
v_accvgpr_read_b32 v10, a140
M v[168:171],a[236:239],a[176:179]
s_waitcnt lgkmcnt(11)
v_accvgpr_read_b32 v11, a141
v_add_f32 v236, v236, v10
M v[148:151],a[236:239],a[180:183]
ds_read_b128 a[176:179], v5 offset:11680
buffer_load_dwordx4 v[76:79], v1, s[16:19], s34 offen offset:3072 sc1
M v[144:147],a[196:199],a[180:183]
s_add_u32 s34, s34, 4096
v_add_f32 v237, v237, v11
M v[140:143],a[192:195],a[180:183]
v_accvgpr_read_b32 v10, a142
v_accvgpr_read_b32 v11, a143
M v[136:139],v[92:95],a[180:183]
v_add_f32 v238, v238, v10
v_add_f32 v239, v239, v11
M v[116:119],v[92:95],a[184:187]
ds_read_b128 a[180:183], v4 offset:11680
buffer_load_dwordx4 v[72:75], v1, s[16:19], s34 offen offset:0 sc1
s_waitcnt lgkmcnt(15)
M v[120:123],a[192:195],a[184:187]
s_add_u32 s34, s34, 1024
v_add_f32 v196, v196, v16
M v[124:127],a[196:199],a[184:187]
v_add_f32 v197, v197, v17
v_add_f32 v198, v198, v18
M v[128:131],a[236:239],a[184:187]
s_waitcnt lgkmcnt(11)
v_add_f32 v199, v199, v19
v_add_f32 v236, v236, v20
M v[108:111],a[236:239],a[188:191]
ds_read_b128 a[184:187], v5 offset:2464
buffer_load_dwordx4 a[236:239], v1, s[16:19], s34 offen offset:0 sc1
M v[104:107],a[196:199],a[188:191]
v_add_f32 v237, v237, v21
v_add_f32 v238, v238, v22
M v[100:103],a[192:195],a[188:191]
v_add_f32 v239, v239, v23
M v[96:99],v[92:95],a[188:191]
s_waitcnt vmcnt(32)
buffer_load_dwordx4 a[196:199], v1, s[16:19], s34 offen offset:1024 sc1
ds_read_b128 v[16:19], v15 offset:8192
M v[96:99],a[204:207],a[160:163]
ds_read_b128 a[188:191], v4 offset:2464
ds_read_b128 v[20:23], v15 offset:9216
M v[100:103],a[208:211],a[160:163]
ds_write_b64 v15, a[88:89] offset:4096
M v[104:107],a[212:215],a[160:163]
buffer_load_dwordx4 a[192:195], v1, s[16:19], s34 offen offset:2048 sc1
M v[108:111],a[216:219],a[160:163]
ds_write_b64 v15, a[90:91] offset:4104
M v[112:115],a[220:223],a[160:163]
s_waitcnt lgkmcnt(10)
ds_write_b64 v15, a[128:129] offset:5120
M v[132:135],a[220:223],a[164:167]
ds_read_b128 a[160:163], v2 offset:2528
buffer_load_dwordx4 v[92:95], v1, s[16:19], s34 offen offset:3072 sc1
M v[128:131],a[216:219],a[164:167]
s_add_u32 s34, s34, 4096
M v[124:127],a[212:215],a[164:167]
ds_write_b64 v15, a[130:131] offset:5128
M v[120:123],a[208:211],a[164:167]
v_accvgpr_read_b32 v10, a80
v_accvgpr_read_b32 v11, a81
M v[116:119],a[204:207],a[164:167]
v_add_f32 v176, v176, v10
v_add_f32 v177, v177, v11
M v[136:139],a[204:207],a[168:171]
ds_read_b128 a[164:167], v3 offset:2528
v_accvgpr_read_b32 v10, a82
M v[140:143],a[208:211],a[168:171]
v_accvgpr_read_b32 v11, a83
v_add_f32 v178, v178, v10
M v[144:147],a[212:215],a[168:171]
v_add_f32 v179, v179, v11
v_accvgpr_read_b32 v10, a120
M v[148:151],a[216:219],a[168:171]
v_accvgpr_read_b32 v11, a121
v_add_f32 v216, v216, v10
M v[152:155],a[220:223],a[168:171]
s_waitcnt lgkmcnt(11)
v_add_f32 v217, v217, v11
v_accvgpr_read_b32 v10, a122
M v[172:175],a[220:223],a[172:175]
ds_read_b128 a[168:171], v2 offset:11744
buffer_load_dwordx4 a[220:223], v1, s[16:19], s34 offen offset:0 sc1
M v[168:171],a[216:219],a[172:175]
v_accvgpr_read_b32 v11, a123
v_add_f32 v218, v218, v10
M v[164:167],a[212:215],a[172:175]
v_add_f32 v219, v219, v11
M v[160:163],a[208:211],a[172:175]
buffer_load_dwordx4 a[216:219], v1, s[16:19], s34 offen offset:1024 sc1
s_waitcnt lgkmcnt(15)
v_add_f32 v176, v176, v24
M v[156:159],a[204:207],a[172:175]
s_waitcnt vmcnt(33)
v_add_f32 v177, v177, v25
v_add_f32 v178, v178, v26
M v[156:159],a[224:227],a[176:179]
ds_read_b128 a[172:175], v3 offset:11744
v_add_f32 v179, v179, v27
M v[160:163],a[228:231],a[176:179]
buffer_load_dwordx4 a[212:215], v1, s[16:19], s34 offen offset:2048 sc1
v_add_f32 v216, v216, v28
M v[164:167],a[232:235],a[176:179]
v_add_f32 v217, v217, v29
v_add_f32 v218, v218, v30
M v[168:171],v[32:35],a[176:179]
s_waitcnt lgkmcnt(11)
v_add_f32 v219, v219, v31
M v[148:151],v[32:35],a[180:183]
ds_read_b128 a[176:179], v5 offset:11744
buffer_load_dwordx4 a[208:211], v1, s[16:19], s34 offen offset:3072 sc1
M v[144:147],a[232:235],a[180:183]
s_add_u32 s34, s34, 4096
M v[140:143],a[228:231],a[180:183]
ds_write_b64 v15, a[112:113] offset:6144
M v[136:139],a[224:227],a[180:183]
ds_write_b64 v15, a[114:115] offset:6152
M v[116:119],a[224:227],a[184:187]
ds_read_b128 a[180:183], v4 offset:11744
buffer_load_dwordx4 a[204:207], v1, s[16:19], s34 offen offset:0 sc1
M v[120:123],a[228:231],a[184:187]
s_add_u32 s34, s34, 1024
M v[124:127],a[232:235],a[184:187]
ds_write_b64 v15, a[152:153] offset:7168
M v[128:131],v[32:35],a[184:187]
s_waitcnt lgkmcnt(9)
ds_write_b64 v15, a[154:155] offset:7176
M v[108:111],v[32:35],a[188:191]
ds_read_b128 a[184:187], v5 offset:2528
buffer_load_dwordx4 v[32:35], v1, s[16:19], s34 offen offset:0 sc1
M v[104:107],a[232:235],a[188:191]
v_accvgpr_read_b32 v10, a104
v_accvgpr_read_b32 v11, a105
M v[100:103],a[228:231],a[188:191]
v_add_f32 v200, v200, v10
v_add_f32 v201, v201, v11
M v[96:99],a[224:227],a[188:191]
s_waitcnt vmcnt(32)
buffer_load_dwordx4 a[232:235], v1, s[16:19], s34 offen offset:1024 sc1
v_accvgpr_read_b32 v10, a106
M v[96:99],a[240:243],a[160:163]
ds_read_b128 a[188:191], v4 offset:2528
v_accvgpr_read_b32 v11, a107
M v[100:103],a[244:247],a[160:163]
v_add_f32 v202, v202, v10
v_add_f32 v203, v203, v11
M v[104:107],a[248:251],a[160:163]
buffer_load_dwordx4 a[228:231], v1, s[16:19], s34 offen offset:2048 sc1
v_accvgpr_read_b32 v10, a144
M v[108:111],a[252:255],a[160:163]
v_accvgpr_read_b32 v11, a145
v_add_f32 v240, v240, v10
M v[112:115],a[0:3],a[160:163]
s_waitcnt lgkmcnt(9)
v_add_f32 v241, v241, v11
v_accvgpr_read_b32 v10, a146
M v[132:135],a[0:3],a[164:167]
ds_read_b128 a[160:163], v2 offset:576
buffer_load_dwordx4 a[224:227], v1, s[16:19], s34 offen offset:3072 sc1
M v[128:131],a[252:255],a[164:167]
s_add_u32 s34, s34, 4096
v_accvgpr_read_b32 v11, a147
M v[124:127],a[248:251],a[164:167]
v_add_f32 v242, v242, v10
v_add_f32 v243, v243, v11
M v[120:123],a[244:247],a[164:167]
s_waitcnt lgkmcnt(15)
v_add_f32 v200, v200, v16
v_add_f32 v201, v201, v17
M v[116:119],a[240:243],a[164:167]
v_add_f32 v202, v202, v18
v_add_f32 v203, v203, v19
M v[136:139],a[240:243],a[168:171]
ds_read_b128 a[164:167], v3 offset:576
v_add_f32 v240, v240, v20
M v[140:143],a[244:247],a[168:171]
v_add_f32 v241, v241, v21
v_add_f32 v242, v242, v22
M v[144:147],a[248:251],a[168:171]
v_add_f32 v243, v243, v23
M v[148:151],a[252:255],a[168:171]
ds_write_b64 v15, a[92:93] offset:8192
M v[152:155],a[0:3],a[168:171]
s_waitcnt lgkmcnt(10)
ds_write_b64 v15, a[94:95] offset:8200
M v[172:175],a[0:3],a[172:175]
ds_read_b128 a[168:171], v2 offset:9792
buffer_load_dwordx4 a[0:3], v1, s[16:19], s34 offen offset:0 sc1
M v[168:171],a[252:255],a[172:175]
ds_write_b64 v15, a[132:133] offset:9216
M v[164:167],a[248:251],a[172:175]
ds_write_b64 v15, a[134:135] offset:9224
M v[160:163],a[244:247],a[172:175]
buffer_load_dwordx4 a[252:255], v1, s[16:19], s34 offen offset:1024 sc1
M v[156:159],a[240:243],a[172:175]
s_waitcnt vmcnt(33)
M v[156:159],v[44:47],a[176:179]
ds_read_b128 a[172:175], v3 offset:9792
M v[160:163],v[40:43],a[176:179]
buffer_load_dwordx4 a[248:251], v1, s[16:19], s34 offen offset:2048 sc1
M v[164:167],v[36:39],a[176:179]
M v[168:171],v[68:71],a[176:179]
s_waitcnt lgkmcnt(9)
M v[148:151],v[68:71],a[180:183]
ds_read_b128 a[176:179], v5 offset:9792
buffer_load_dwordx4 a[244:247], v1, s[16:19], s34 offen offset:3072 sc1
M v[144:147],v[36:39],a[180:183]
s_add_u32 s34, s34, 4096
M v[140:143],v[40:43],a[180:183]
M v[136:139],v[44:47],a[180:183]
M v[116:119],v[44:47],a[184:187]
ds_read_b128 a[180:183], v4 offset:9792
buffer_load_dwordx4 a[240:243], v1, s[16:19], s34 offen offset:0 sc1
M v[120:123],v[40:43],a[184:187]
s_add_u32 s34, s34, 1024
M v[124:127],v[36:39],a[184:187]
M v[128:131],v[68:71],a[184:187]
s_waitcnt lgkmcnt(9)
M v[108:111],v[68:71],a[188:191]
ds_read_b128 a[184:187], v5 offset:576
buffer_load_dwordx4 v[68:71], v1, s[16:19], s34 offen offset:0 sc1
M v[104:107],v[36:39],a[188:191]
M v[100:103],v[40:43],a[188:191]
M v[96:99],v[44:47],a[188:191]
s_waitcnt vmcnt(32)
buffer_load_dwordx4 v[36:39], v1, s[16:19], s34 offen offset:1024 sc1
M v[96:99],a[16:19],a[160:163]
ds_read_b128 a[188:191], v4 offset:576
M v[100:103],a[12:15],a[160:163]
M v[104:107],a[8:11],a[160:163]
buffer_load_dwordx4 v[40:43], v1, s[16:19], s34 offen offset:2048 sc1
M v[108:111],a[4:7],a[160:163]
M v[112:115],v[52:55],a[160:163]
s_waitcnt lgkmcnt(7)
M v[132:135],v[52:55],a[164:167]
ds_read_b128 a[160:163], v2 offset:640
buffer_load_dwordx4 v[44:47], v1, s[16:19], s34 offen offset:3072 sc1
M v[128:131],a[4:7],a[164:167]
s_add_u32 s34, s34, 4096
M v[124:127],a[8:11],a[164:167]
M v[120:123],a[12:15],a[164:167]
M v[116:119],a[16:19],a[164:167]
M v[136:139],a[16:19],a[168:171]
ds_read_b128 a[164:167], v3 offset:640
M v[140:143],a[12:15],a[168:171]
M v[144:147],a[8:11],a[168:171]
M v[148:151],a[4:7],a[168:171]
M v[152:155],v[52:55],a[168:171]
s_waitcnt lgkmcnt(5)
M v[172:175],v[52:55],a[172:175]
ds_read_b128 a[168:171], v2 offset:9856
buffer_load_dwordx4 v[52:55], v1, s[16:19], s34 offen offset:0 sc1
M v[168:171],a[4:7],a[172:175]
M v[164:167],a[8:11],a[172:175]
M v[160:163],a[12:15],a[172:175]
buffer_load_dwordx4 a[4:7], v1, s[16:19], s34 offen offset:1024 sc1
M v[156:159],a[16:19],a[172:175]
s_waitcnt vmcnt(33)
M v[156:159],v[48:51],a[176:179]
ds_read_b128 a[172:175], v3 offset:9856
M v[160:163],a[28:31],a[176:179]
buffer_load_dwordx4 a[8:11], v1, s[16:19], s34 offen offset:2048 sc1
M v[164:167],a[24:27],a[176:179]
M v[168:171],a[20:23],a[176:179]
s_waitcnt lgkmcnt(5)
M v[148:151],a[20:23],a[180:183]
ds_read_b128 a[176:179], v5 offset:9856
buffer_load_dwordx4 a[12:15], v1, s[16:19], s34 offen offset:3072 sc1
M v[144:147],a[24:27],a[180:183]
s_add_u32 s34, s34, 4096
M v[140:143],a[28:31],a[180:183]
M v[136:139],v[48:51],a[180:183]
M v[116:119],v[48:51],a[184:187]
ds_read_b128 a[180:183], v4 offset:9856
buffer_load_dwordx4 a[16:19], v1, s[16:19], s34 offen offset:0 sc1
M v[120:123],a[28:31],a[184:187]
s_add_u32 s34, s34, 1024
M v[124:127],a[24:27],a[184:187]
M v[128:131],a[20:23],a[184:187]
s_waitcnt lgkmcnt(5)
M v[108:111],a[20:23],a[188:191]
ds_read_b128 a[184:187], v5 offset:640
buffer_load_dwordx4 a[20:23], v1, s[16:19], s34 offen offset:0 sc1
M v[104:107],a[24:27],a[188:191]
M v[100:103],a[28:31],a[188:191]
M v[96:99],v[48:51],a[188:191]
s_waitcnt vmcnt(32)
buffer_load_dwordx4 a[24:27], v1, s[16:19], s34 offen offset:1024 sc1
s_waitcnt lgkmcnt(0)
s_barrier
M v[96:99],a[200:203],a[160:163]
ds_read_b128 a[188:191], v4 offset:640
ds_read_b128 v[16:19], v14 offset:0
M v[100:103],v[64:67],a[160:163]
ds_read_b128 v[20:23], v14 offset:1024
ds_read_b128 v[24:27], v14 offset:2048
M v[104:107],v[60:63],a[160:163]
buffer_load_dwordx4 a[28:31], v1, s[16:19], s34 offen offset:2048 sc1
ds_read_b128 v[28:31], v14 offset:3072
M v[108:111],v[56:59],a[160:163]
v_accvgpr_read_b32 v10, a84
v_accvgpr_read_b32 v11, a85
M v[112:115],v[88:91],a[160:163]
s_waitcnt lgkmcnt(9)
v_add_f32 v180, v180, v10
v_add_f32 v181, v181, v11
M v[132:135],v[88:91],a[164:167]
ds_read_b128 a[160:163], v2 offset:704
buffer_load_dwordx4 v[48:51], v1, s[16:19], s34 offen offset:3072 sc1
M v[128:131],v[56:59],a[164:167]
s_add_u32 s34, s34, 4096
v_accvgpr_read_b32 v10, a86
M v[124:127],v[60:63],a[164:167]
v_accvgpr_read_b32 v11, a87
v_add_f32 v182, v182, v10
M v[120:123],v[64:67],a[164:167]
v_add_f32 v183, v183, v11
v_accvgpr_read_b32 v10, a124
M v[116:119],a[200:203],a[164:167]
v_accvgpr_read_b32 v11, a125
v_add_f32 v220, v220, v10
M v[136:139],a[200:203],a[168:171]
ds_read_b128 a[164:167], v3 offset:704
v_add_f32 v221, v221, v11
M v[140:143],v[64:67],a[168:171]
v_accvgpr_read_b32 v10, a126
v_accvgpr_read_b32 v11, a127
M v[144:147],v[60:63],a[168:171]
v_add_f32 v222, v222, v10
v_add_f32 v223, v223, v11
M v[148:151],v[56:59],a[168:171]
s_waitcnt lgkmcnt(4)
v_add_f32 v180, v180, v16
v_add_f32 v181, v181, v17
M v[152:155],v[88:91],a[168:171]
s_waitcnt lgkmcnt(9)
v_add_f32 v182, v182, v18
v_add_f32 v183, v183, v19
M v[172:175],v[88:91],a[172:175]
ds_read_b128 a[168:171], v2 offset:9920
buffer_load_dwordx4 v[88:91], v1, s[16:19], s34 offen offset:0 sc1
M v[168:171],v[56:59],a[172:175]
v_add_f32 v220, v220, v20
v_add_f32 v221, v221, v21
M v[164:167],v[60:63],a[172:175]
v_add_f32 v222, v222, v22
v_add_f32 v223, v223, v23
M v[160:163],v[64:67],a[172:175]
buffer_load_dwordx4 v[56:59], v1, s[16:19], s34 offen offset:1024 sc1
ds_read_b128 v[16:19], v14 offset:4096
M v[156:159],a[200:203],a[172:175]
s_waitcnt vmcnt(33)
ds_read_b128 v[20:23], v14 offset:5120
v_accvgpr_read_b32 v10, a108
M v[156:159],v[84:87],a[176:179]
ds_read_b128 a[172:175], v3 offset:9920
v_accvgpr_read_b32 v11, a109
M v[160:163],v[80:83],a[176:179]
buffer_load_dwordx4 v[60:63], v1, s[16:19], s34 offen offset:2048 sc1
v_add_f32 v204, v204, v10
M v[164:167],v[76:79],a[176:179]
v_add_f32 v205, v205, v11
v_accvgpr_read_b32 v10, a110
M v[168:171],v[72:75],a[176:179]
s_waitcnt lgkmcnt(11)
v_accvgpr_read_b32 v11, a111
v_add_f32 v206, v206, v10
M v[148:151],v[72:75],a[180:183]
ds_read_b128 a[176:179], v5 offset:9920
buffer_load_dwordx4 v[64:67], v1, s[16:19], s34 offen offset:3072 sc1
M v[144:147],v[76:79],a[180:183]
s_add_u32 s34, s34, 4096
v_add_f32 v207, v207, v11
M v[140:143],v[80:83],a[180:183]
v_accvgpr_read_b32 v10, a148
v_accvgpr_read_b32 v11, a149
M v[136:139],v[84:87],a[180:183]
v_add_f32 v244, v244, v10
v_add_f32 v245, v245, v11
M v[116:119],v[84:87],a[184:187]
ds_read_b128 a[180:183], v4 offset:9920
buffer_load_dwordx4 a[200:203], v1, s[16:19], s34 offen offset:0 sc1
M v[120:123],v[80:83],a[184:187]
s_add_u32 s34, s34, 1024
v_accvgpr_read_b32 v10, a150
M v[124:127],v[76:79],a[184:187]
v_accvgpr_read_b32 v11, a151
v_add_f32 v246, v246, v10
M v[128:131],v[72:75],a[184:187]
s_waitcnt lgkmcnt(7)
v_add_f32 v247, v247, v11
M v[108:111],v[72:75],a[188:191]
ds_read_b128 a[184:187], v5 offset:704
buffer_load_dwordx4 v[72:75], v1, s[16:19], s34 offen offset:0 sc1
s_waitcnt lgkmcnt(9)
M v[104:107],v[76:79],a[188:191]
v_add_f32 v204, v204, v24
v_add_f32 v205, v205, v25
M v[100:103],v[80:83],a[188:191]
v_add_f32 v206, v206, v26
v_add_f32 v207, v207, v27
M v[96:99],v[84:87],a[188:191]
s_waitcnt vmcnt(32)
buffer_load_dwordx4 v[76:79], v1, s[16:19], s34 offen offset:1024 sc1
v_add_f32 v244, v244, v28
M v[96:99],a[236:239],a[160:163]
ds_read_b128 a[188:191], v4 offset:704
v_add_f32 v245, v245, v29
M v[100:103],a[196:199],a[160:163]
v_add_f32 v246, v246, v30
v_add_f32 v247, v247, v31
M v[104:107],a[192:195],a[160:163]
buffer_load_dwordx4 v[80:83], v1, s[16:19], s34 offen offset:2048 sc1
ds_read_b128 v[24:27], v14 offset:6144
M v[108:111],v[92:95],a[160:163]
ds_read_b128 v[28:31], v14 offset:7168
v_accvgpr_read_b32 v10, a88
M v[112:115],a[220:223],a[160:163]
s_waitcnt lgkmcnt(9)
v_accvgpr_read_b32 v11, a89
v_add_f32 v184, v184, v10
M v[132:135],a[220:223],a[164:167]
ds_read_b128 a[160:163], v2 offset:768
buffer_load_dwordx4 v[84:87], v1, s[16:19], s34 offen offset:3072 sc1
M v[128:131],v[92:95],a[164:167]
s_add_u32 s34, s34, 4096
v_add_f32 v185, v185, v11
M v[124:127],a[192:195],a[164:167]
v_accvgpr_read_b32 v10, a90
v_accvgpr_read_b32 v11, a91
M v[120:123],a[196:199],a[164:167]
v_add_f32 v186, v186, v10
v_add_f32 v187, v187, v11
M v[116:119],a[236:239],a[164:167]
v_accvgpr_read_b32 v10, a128
v_accvgpr_read_b32 v11, a129
M v[136:139],a[236:239],a[168:171]
ds_read_b128 a[164:167], v3 offset:768
v_add_f32 v224, v224, v10
M v[140:143],a[196:199],a[168:171]
v_add_f32 v225, v225, v11
v_accvgpr_read_b32 v10, a130
M v[144:147],a[192:195],a[168:171]
v_accvgpr_read_b32 v11, a131
v_add_f32 v226, v226, v10
M v[148:151],v[92:95],a[168:171]
v_add_f32 v227, v227, v11
M v[152:155],a[220:223],a[168:171]
s_waitcnt lgkmcnt(7)
s_waitcnt lgkmcnt(9)
v_add_f32 v184, v184, v16
v_add_f32 v185, v185, v17
M v[172:175],a[220:223],a[172:175]
ds_read_b128 a[168:171], v2 offset:9984
buffer_load_dwordx4 a[220:223], v1, s[16:19], s34 offen offset:0 sc1
M v[168:171],v[92:95],a[172:175]
v_add_f32 v186, v186, v18
v_add_f32 v187, v187, v19
M v[164:167],a[192:195],a[172:175]
v_add_f32 v224, v224, v20
v_add_f32 v225, v225, v21
M v[160:163],a[196:199],a[172:175]
buffer_load_dwordx4 v[92:95], v1, s[16:19], s34 offen offset:1024 sc1
v_add_f32 v226, v226, v22
M v[156:159],a[236:239],a[172:175]
s_waitcnt vmcnt(33)
v_add_f32 v227, v227, v23
M v[156:159],a[216:219],a[176:179]
ds_read_b128 a[172:175], v3 offset:9984
ds_read_b128 v[16:19], v14 offset:8192
M v[160:163],a[212:215],a[176:179]
buffer_load_dwordx4 a[192:195], v1, s[16:19], s34 offen offset:2048 sc1
ds_read_b128 v[20:23], v14 offset:9216
M v[164:167],a[208:211],a[176:179]
v_accvgpr_read_b32 v10, a112
v_accvgpr_read_b32 v11, a113
M v[168:171],a[204:207],a[176:179]
s_waitcnt lgkmcnt(9)
v_add_f32 v208, v208, v10
v_add_f32 v209, v209, v11
M v[148:151],a[204:207],a[180:183]
ds_read_b128 a[176:179], v5 offset:9984
buffer_load_dwordx4 a[196:199], v1, s[16:19], s34 offen offset:3072 sc1
M v[144:147],a[208:211],a[180:183]
s_add_u32 s34, s34, 4096
v_accvgpr_read_b32 v10, a114
M v[140:143],a[212:215],a[180:183]
v_accvgpr_read_b32 v11, a115
v_add_f32 v210, v210, v10
M v[136:139],a[216:219],a[180:183]
v_add_f32 v211, v211, v11
v_accvgpr_read_b32 v10, a152
M v[116:119],a[216:219],a[184:187]
ds_read_b128 a[180:183], v4 offset:9984
buffer_load_dwordx4 a[236:239], v1, s[16:19], s34 offen offset:0 sc1
M v[120:123],a[212:215],a[184:187]
s_add_u32 s34, s34, 1024
v_accvgpr_read_b32 v11, a153
M v[124:127],a[208:211],a[184:187]
v_add_f32 v248, v248, v10
v_add_f32 v249, v249, v11
M v[128:131],a[204:207],a[184:187]
s_waitcnt lgkmcnt(7)
v_accvgpr_read_b32 v10, a154
v_accvgpr_read_b32 v11, a155
M v[108:111],a[204:207],a[188:191]
ds_read_b128 a[184:187], v5 offset:768
buffer_load_dwordx4 a[204:207], v1, s[16:19], s34 offen offset:0 sc1
M v[104:107],a[208:211],a[188:191]
v_add_f32 v250, v250, v10
v_add_f32 v251, v251, v11
M v[100:103],a[212:215],a[188:191]
s_waitcnt lgkmcnt(9)
v_add_f32 v208, v208, v24
v_add_f32 v209, v209, v25
M v[96:99],a[216:219],a[188:191]
s_waitcnt vmcnt(32)
buffer_load_dwordx4 a[208:211], v1, s[16:19], s34 offen offset:1024 sc1
v_add_f32 v210, v210, v26
M v[96:99],v[32:35],a[160:163]
ds_read_b128 a[188:191], v4 offset:768
v_add_f32 v211, v211, v27
M v[100:103],a[232:235],a[160:163]
v_add_f32 v248, v248, v28
v_add_f32 v249, v249, v29
M v[104:107],a[228:231],a[160:163]
buffer_load_dwordx4 a[212:215], v1, s[16:19], s34 offen offset:2048 sc1
v_add_f32 v250, v250, v30
M v[108:111],a[224:227],a[160:163]
v_add_f32 v251, v251, v31
v_accvgpr_read_b32 v10, a92
M v[112:115],a[0:3],a[160:163]
s_waitcnt lgkmcnt(7)
v_accvgpr_read_b32 v11, a93
v_add_f32 v188, v188, v10
M v[132:135],a[0:3],a[164:167]
ds_read_b128 a[160:163], v6 offset:832
buffer_load_dwordx4 a[216:219], v1, s[16:19], s34 offen offset:3072 sc1
M v[128:131],a[224:227],a[164:167]
s_add_u32 s34, s34, 4096
v_add_f32 v189, v189, v11
M v[124:127],a[228:231],a[164:167]
v_accvgpr_read_b32 v10, a94
v_accvgpr_read_b32 v11, a95
M v[120:123],a[232:235],a[164:167]
v_add_f32 v190, v190, v10
v_add_f32 v191, v191, v11
M v[116:119],v[32:35],a[164:167]
v_accvgpr_read_b32 v10, a132
v_accvgpr_read_b32 v11, a133
M v[136:139],v[32:35],a[168:171]
ds_read_b128 a[164:167], v7 offset:832
v_add_f32 v228, v228, v10
M v[140:143],a[232:235],a[168:171]
v_add_f32 v229, v229, v11
v_accvgpr_read_b32 v10, a134
M v[144:147],a[228:231],a[168:171]
v_accvgpr_read_b32 v11, a135
v_add_f32 v230, v230, v10
M v[148:151],a[224:227],a[168:171]
v_add_f32 v231, v231, v11
M v[152:155],a[0:3],a[168:171]
s_waitcnt lgkmcnt(5)
s_waitcnt lgkmcnt(6)
v_add_f32 v188, v188, v16
v_add_f32 v189, v189, v17
M v[172:175],a[0:3],a[172:175]
ds_read_b128 a[168:171], v6 offset:10048
buffer_load_dwordx4 a[0:3], v1, s[16:19], s34 offen offset:0 sc1
M v[168:171],a[224:227],a[172:175]
v_add_f32 v190, v190, v18
v_add_f32 v191, v191, v19
M v[164:167],a[228:231],a[172:175]
v_add_f32 v228, v228, v20
v_add_f32 v229, v229, v21
M v[160:163],a[232:235],a[172:175]
buffer_load_dwordx4 a[224:227], v1, s[16:19], s34 offen offset:1024 sc1
v_add_f32 v230, v230, v22
M v[156:159],v[32:35],a[172:175]
s_waitcnt vmcnt(33)
v_add_f32 v231, v231, v23
M v[156:159],a[252:255],a[176:179]
ds_read_b128 a[172:175], v7 offset:10048
M v[160:163],a[248:251],a[176:179]
buffer_load_dwordx4 a[228:231], v1, s[16:19], s34 offen offset:2048 sc1
M v[164:167],a[244:247],a[176:179]
M v[168:171],a[240:243],a[176:179]
s_waitcnt lgkmcnt(5)
M v[148:151],a[240:243],a[180:183]
ds_read_b128 a[176:179], v9 offset:10048
buffer_load_dwordx4 a[232:235], v1, s[16:19], s34 offen offset:3072 sc1
M v[144:147],a[244:247],a[180:183]
s_add_u32 s34, s34, 4096
M v[140:143],a[248:251],a[180:183]
M v[136:139],a[252:255],a[180:183]
M v[116:119],a[252:255],a[184:187]
ds_read_b128 a[180:183], v8 offset:10048
buffer_load_dwordx4 v[32:35], v1, s[16:19], s34 offen offset:0 sc1
M v[120:123],a[248:251],a[184:187]
s_add_u32 s34, s34, 1024
M v[124:127],a[244:247],a[184:187]
M v[128:131],a[240:243],a[184:187]
s_waitcnt lgkmcnt(5)
M v[108:111],a[240:243],a[188:191]
ds_read_b128 a[184:187], v9 offset:832
buffer_load_dwordx4 a[240:243], v1, s[16:19], s34 offen offset:0 sc1
M v[104:107],a[244:247],a[188:191]
M v[100:103],a[248:251],a[188:191]
M v[96:99],a[252:255],a[188:191]
s_waitcnt vmcnt(32)
buffer_load_dwordx4 a[244:247], v1, s[16:19], s34 offen offset:1024 sc1
M v[96:99],v[68:71],a[160:163]
ds_read_b128 a[188:191], v8 offset:832
M v[100:103],v[36:39],a[160:163]
M v[104:107],v[40:43],a[160:163]
buffer_load_dwordx4 a[248:251], v1, s[16:19], s34 offen offset:2048 sc1
M v[108:111],v[44:47],a[160:163]
M v[112:115],v[52:55],a[160:163]
s_waitcnt lgkmcnt(5)
M v[132:135],v[52:55],a[164:167]
ds_read_b128 a[160:163], v2 offset:32
buffer_load_dwordx4 a[252:255], v1, s[16:19], s34 offen offset:3072 sc1
M v[128:131],v[44:47],a[164:167]
s_add_u32 s34, s34, 4096
M v[124:127],v[40:43],a[164:167]
M v[120:123],v[36:39],a[164:167]
M v[116:119],v[68:71],a[164:167]
M v[136:139],v[68:71],a[168:171]
ds_read_b128 a[164:167], v3 offset:32
M v[140:143],v[36:39],a[168:171]
M v[144:147],v[40:43],a[168:171]
M v[148:151],v[44:47],a[168:171]
M v[152:155],v[52:55],a[168:171]
s_waitcnt lgkmcnt(5)
M v[172:175],v[52:55],a[172:175]
ds_read_b128 a[168:171], v2 offset:9248
buffer_load_dwordx4 v[52:55], v1, s[16:19], s34 offen offset:0 sc1
M v[168:171],v[44:47],a[172:175]
M v[164:167],v[40:43],a[172:175]
M v[160:163],v[36:39],a[172:175]
buffer_load_dwordx4 v[44:47], v1, s[16:19], s34 offen offset:1024 sc1
M v[156:159],v[68:71],a[172:175]
s_waitcnt vmcnt(33)
M v[156:159],a[4:7],a[176:179]
ds_read_b128 a[172:175], v3 offset:9248
M v[160:163],a[8:11],a[176:179]
buffer_load_dwordx4 v[40:43], v1, s[16:19], s34 offen offset:2048 sc1
M v[164:167],a[12:15],a[176:179]
M v[168:171],a[16:19],a[176:179]
s_waitcnt lgkmcnt(5)
M v[148:151],a[16:19],a[180:183]
ds_read_b128 a[176:179], v5 offset:9248
buffer_load_dwordx4 v[36:39], v1, s[16:19], s34 offen offset:3072 sc1
M v[144:147],a[12:15],a[180:183]
s_add_u32 s34, s34, 4096
M v[140:143],a[8:11],a[180:183]
M v[136:139],a[4:7],a[180:183]
M v[116:119],a[4:7],a[184:187]
ds_read_b128 a[180:183], v4 offset:9248
buffer_load_dwordx4 v[68:71], v1, s[16:19], s34 offen offset:0 sc1
M v[120:123],a[8:11],a[184:187]
s_add_u32 s34, s34, 1024
M v[124:127],a[12:15],a[184:187]
M v[128:131],a[16:19],a[184:187]
s_waitcnt lgkmcnt(5)
M v[108:111],a[16:19],a[188:191]
ds_read_b128 a[184:187], v5 offset:32
buffer_load_dwordx4 a[16:19], v1, s[16:19], s34 offen offset:0 sc1
M v[104:107],a[12:15],a[188:191]
M v[100:103],a[8:11],a[188:191]
M v[96:99],a[4:7],a[188:191]
s_waitcnt vmcnt(32)
buffer_load_dwordx4 a[12:15], v1, s[16:19], s34 offen offset:1024 sc1
s_mov_b32 s50, 0x4038aa3b
M v[96:99],a[20:23],a[160:163]
ds_read_b128 a[188:191], v4 offset:32
s_mov_b32 s51, 0x4038aa3b
M v[100:103],a[24:27],a[160:163]
s_mov_b32 s52, 0xbfb8aa3b
s_mov_b32 s53, 0xbfb8aa3b
M v[104:107],a[28:31],a[160:163]
buffer_load_dwordx4 a[8:11], v1, s[16:19], s34 offen offset:2048 sc1
s_mov_b32 s54, 1.0
M v[108:111],v[48:51],a[160:163]
s_mov_b32 s55, 1.0
s_mov_b32 s56, -2.0
M v[112:115],v[88:91],a[160:163]
s_waitcnt lgkmcnt(5)
s_mov_b32 s57, -2.0
s_mul_i32 s43, s2, 32768
M v[132:135],v[88:91],a[164:167]
ds_read_b128 a[160:163], v2 offset:96
buffer_load_dwordx4 a[4:7], v1, s[16:19], s34 offen offset:3072 sc1
M v[128:131],v[48:51],a[164:167]
s_add_u32 s34, s34, 4096
s_add_u32 s43, s43, 6553600
M v[124:127],a[28:31],a[164:167]
s_lshl_b32 s3, s28, 13
s_add_u32 s45, s43, s3
M v[120:123],a[24:27],a[164:167]
s_add_u32 s44, s45, 4096
s_add_u32 s48, s45, 32768
M v[116:119],a[20:23],a[164:167]
s_xor_b32 s3, s28, 1
s_lshl_b32 s3, s3, 13
M v[136:139],a[20:23],a[168:171]
ds_read_b128 a[164:167], v3 offset:96
s_add_u32 s49, s43, s3
M v[140:143],a[24:27],a[168:171]
s_add_u32 s49, s49, 36864
s_mul_i32 s3, s32, 16000
M v[144:147],a[28:31],a[168:171]
s_add_u32 s3, s3, s31
s_add_u32 s3, s3, 130
M v[148:151],v[48:51],a[168:171]
s_lshl_b32 s4, s29, 6
s_add_u32 s3, s3, s4
M v[152:155],v[88:91],a[168:171]
s_waitcnt lgkmcnt(5)
s_lshl_b32 s4, s30, 1
s_sub_u32 s3, s3, s4
M v[172:175],v[88:91],a[172:175]
ds_read_b128 a[168:171], v2 offset:9312
buffer_load_dwordx4 v[88:91], v1, s[16:19], s34 offen offset:0 sc1
M v[168:171],v[48:51],a[172:175]
s_mul_i32 s63, s3, 288
s_mov_b32 s36, 0x4000
M v[164:167],a[28:31],a[172:175]
s_movk_i32 s42, 576
M v[160:163],a[24:27],a[172:175]
buffer_load_dwordx4 v[48:51], v1, s[16:19], s34 offen offset:1024 sc1
M v[156:159],a[20:23],a[172:175]
s_waitcnt vmcnt(33)
M v[156:159],v[56:59],a[176:179]
ds_read_b128 a[172:175], v3 offset:9312
M v[160:163],v[60:63],a[176:179]
buffer_load_dwordx4 a[28:31], v1, s[16:19], s34 offen offset:2048 sc1
M v[164:167],v[64:67],a[176:179]
M v[168:171],a[200:203],a[176:179]
s_waitcnt lgkmcnt(5)
M v[148:151],a[200:203],a[180:183]
ds_read_b128 a[176:179], v5 offset:9312
buffer_load_dwordx4 a[24:27], v1, s[16:19], s34 offen offset:3072 sc1
M v[144:147],v[64:67],a[180:183]
s_add_u32 s34, s34, 4096
M v[140:143],v[60:63],a[180:183]
M v[136:139],v[56:59],a[180:183]
M v[116:119],v[56:59],a[184:187]
ds_read_b128 a[180:183], v4 offset:9312
buffer_load_dwordx4 a[20:23], v1, s[16:19], s34 offen offset:0 sc1
M v[120:123],v[60:63],a[184:187]
s_add_u32 s34, s34, 1024
M v[124:127],v[64:67],a[184:187]
M v[128:131],a[200:203],a[184:187]
s_waitcnt lgkmcnt(5)
M v[108:111],a[200:203],a[188:191]
ds_read_b128 a[184:187], v5 offset:96
buffer_load_dwordx4 a[200:203], v1, s[16:19], s34 offen offset:0 sc1
M v[104:107],v[64:67],a[188:191]
M v[100:103],v[60:63],a[188:191]
M v[96:99],v[56:59],a[188:191]
s_waitcnt vmcnt(32)
buffer_load_dwordx4 v[64:67], v1, s[16:19], s34 offen offset:1024 sc1
s_lshl_b32 s3, s28, 12
M v[96:99],v[72:75],a[160:163]
ds_read_b128 a[188:191], v4 offset:96
s_add_u32 s3, s3, 92160
M v[100:103],v[76:79],a[160:163]
v_add_u32 v13, s3, v1
M v[104:107],v[80:83],a[160:163]
buffer_load_dwordx4 v[60:63], v1, s[16:19], s34 offen offset:2048 sc1
s_xor_b32 s3, s28, 1
M v[108:111],v[84:87],a[160:163]
s_lshl_b32 s3, s3, 12
s_add_u32 s3, s3, 92160
M v[112:115],a[220:223],a[160:163]
s_waitcnt lgkmcnt(5)
v_add_u32 v12, s3, v1
M v[132:135],a[220:223],a[164:167]
ds_read_b128 a[160:163], v2 offset:160
buffer_load_dwordx4 v[56:59], v1, s[16:19], s34 offen offset:3072 sc1
M v[128:131],v[84:87],a[164:167]
s_add_u32 s34, s34, 4096
M v[124:127],v[80:83],a[164:167]
M v[120:123],v[76:79],a[164:167]
M v[116:119],v[72:75],a[164:167]
M v[136:139],v[72:75],a[168:171]
ds_read_b128 a[164:167], v3 offset:160
M v[140:143],v[76:79],a[168:171]
M v[144:147],v[80:83],a[168:171]
M v[148:151],v[84:87],a[168:171]
M v[152:155],a[220:223],a[168:171]
s_waitcnt lgkmcnt(5)
M v[172:175],a[220:223],a[172:175]
ds_read_b128 a[168:171], v2 offset:9376
buffer_load_dwordx4 a[220:223], v1, s[16:19], s34 offen offset:0 sc1
M v[168:171],v[84:87],a[172:175]
M v[164:167],v[80:83],a[172:175]
M v[160:163],v[76:79],a[172:175]
buffer_load_dwordx4 v[84:87], v1, s[16:19], s34 offen offset:1024 sc1
M v[156:159],v[72:75],a[172:175]
s_waitcnt vmcnt(33)
M v[156:159],v[92:95],a[176:179]
ds_read_b128 a[172:175], v3 offset:9376
M v[160:163],a[192:195],a[176:179]
buffer_load_dwordx4 v[80:83], v1, s[16:19], s34 offen offset:2048 sc1
M v[164:167],a[196:199],a[176:179]
M v[168:171],a[236:239],a[176:179]
s_waitcnt lgkmcnt(5)
M v[148:151],a[236:239],a[180:183]
ds_read_b128 a[176:179], v5 offset:9376
buffer_load_dwordx4 v[76:79], v1, s[16:19], s34 offen offset:3072 sc1
M v[144:147],a[196:199],a[180:183]
s_add_u32 s34, s34, 4096
M v[140:143],a[192:195],a[180:183]
M v[136:139],v[92:95],a[180:183]
M v[116:119],v[92:95],a[184:187]
ds_read_b128 a[180:183], v4 offset:9376
buffer_load_dwordx4 v[72:75], v1, s[16:19], s34 offen offset:0 sc1
M v[120:123],a[192:195],a[184:187]
s_add_u32 s34, s34, 1024
M v[124:127],a[196:199],a[184:187]
M v[128:131],a[236:239],a[184:187]
s_waitcnt lgkmcnt(5)
M v[108:111],a[236:239],a[188:191]
ds_read_b128 a[184:187], v5 offset:160
buffer_load_dwordx4 a[236:239], v1, s[16:19], s34 offen offset:0 sc1
M v[104:107],a[196:199],a[188:191]
M v[100:103],a[192:195],a[188:191]
M v[96:99],v[92:95],a[188:191]
s_waitcnt vmcnt(32)
buffer_load_dwordx4 a[196:199], v1, s[16:19], s34 offen offset:1024 sc1
s_mul_i32 s47, s28, 12288
M v[96:99],a[204:207],a[160:163]
ds_read_b128 a[188:191], v4 offset:160
s_add_u32 s46, s47, 108544
M v[100:103],a[208:211],a[160:163]
s_add_u32 s47, s47, 6291456
M v[104:107],a[212:215],a[160:163]
buffer_load_dwordx4 a[192:195], v1, s[16:19], s34 offen offset:2048 sc1
M v[108:111],a[216:219],a[160:163]
M v[112:115],a[0:3],a[160:163]
s_waitcnt lgkmcnt(5)
M v[132:135],a[0:3],a[164:167]
ds_read_b128 a[160:163], v2 offset:224
buffer_load_dwordx4 v[92:95], v1, s[16:19], s34 offen offset:3072 sc1
M v[128:131],a[216:219],a[164:167]
s_add_u32 s34, s34, 4096
M v[124:127],a[212:215],a[164:167]
M v[120:123],a[208:211],a[164:167]
M v[116:119],a[204:207],a[164:167]
M v[136:139],a[204:207],a[168:171]
ds_read_b128 a[164:167], v3 offset:224
M v[140:143],a[208:211],a[168:171]
M v[144:147],a[212:215],a[168:171]
M v[148:151],a[216:219],a[168:171]
M v[152:155],a[0:3],a[168:171]
s_waitcnt lgkmcnt(5)
M v[172:175],a[0:3],a[172:175]
ds_read_b128 a[168:171], v2 offset:9440
buffer_load_dwordx4 a[0:3], v1, s[16:19], s34 offen offset:0 sc1
M v[168:171],a[216:219],a[172:175]
M v[164:167],a[212:215],a[172:175]
M v[160:163],a[208:211],a[172:175]
buffer_load_dwordx4 a[216:219], v1, s[16:19], s34 offen offset:1024 sc1
M v[156:159],a[204:207],a[172:175]
s_waitcnt vmcnt(33)
M v[156:159],a[224:227],a[176:179]
ds_read_b128 a[172:175], v3 offset:9440
M v[160:163],a[228:231],a[176:179]
buffer_load_dwordx4 a[212:215], v1, s[16:19], s34 offen offset:2048 sc1
M v[164:167],a[232:235],a[176:179]
M v[168:171],v[32:35],a[176:179]
s_waitcnt lgkmcnt(5)
M v[148:151],v[32:35],a[180:183]
ds_read_b128 a[176:179], v5 offset:9440
buffer_load_dwordx4 a[208:211], v1, s[16:19], s34 offen offset:3072 sc1
M v[144:147],a[232:235],a[180:183]
s_add_u32 s34, s34, 4096
M v[140:143],a[228:231],a[180:183]
M v[136:139],a[224:227],a[180:183]
M v[116:119],a[224:227],a[184:187]
ds_read_b128 a[180:183], v4 offset:9440
buffer_load_dwordx4 a[204:207], v1, s[16:19], s34 offen offset:0 sc1
M v[120:123],a[228:231],a[184:187]
s_add_u32 s34, s34, 1024
M v[124:127],a[232:235],a[184:187]
M v[128:131],v[32:35],a[184:187]
s_waitcnt lgkmcnt(5)
M v[108:111],v[32:35],a[188:191]
ds_read_b128 a[184:187], v5 offset:224
buffer_load_dwordx4 v[32:35], v1, s[16:19], s34 offen offset:0 sc1
M v[104:107],a[232:235],a[188:191]
M v[100:103],a[228:231],a[188:191]
M v[96:99],a[224:227],a[188:191]
s_waitcnt vmcnt(32)
buffer_load_dwordx4 a[232:235], v1, s[16:19], s34 offen offset:1024 sc1
s_lshl_b32 s3, s39, 1
M v[96:99],a[240:243],a[160:163]
ds_read_b128 a[188:191], v4 offset:224
s_add_u32 s3, s3, s29
M v[100:103],a[244:247],a[160:163]
v_add_u32 v2, s9, v2
v_add_u32 v3, s9, v3
M v[104:107],a[248:251],a[160:163]
v_add_u32 v4, s9, v4
v_add_u32 v5, s9, v5
M v[108:111],a[252:255],a[160:163]
v_add_u32 v6, s9, v6
v_add_u32 v7, s9, v7
M v[112:115],v[52:55],a[160:163]
s_waitcnt lgkmcnt(5)
v_add_u32 v8, s9, v8
v_add_u32 v9, s9, v9
M v[132:135],v[52:55],a[164:167]
ds_read_b128 a[160:163], v2 offset:2880
buffer_load_dwordx4 a[228:231], v1, s[16:19], s34 offen offset:2048 sc1
M v[128:131],a[252:255],a[164:167]
s_xor_b32 s4, s3, 0
s_lshl_b32 s4, s4, 10
M v[124:127],a[248:251],a[164:167]
s_add_u32 s4, s4, 108544
v_add_u32 v24, s4, v1
M v[120:123],a[244:247],a[164:167]
buffer_load_dwordx4 a[224:227], v1, s[16:19], s34 offen offset:3072 sc1
s_add_u32 s34, s34, 4096
M v[116:119],a[240:243],a[164:167]
s_xor_b32 s4, s3, 1
s_lshl_b32 s4, s4, 10
M v[136:139],a[240:243],a[168:171]
ds_read_b128 a[164:167], v3 offset:2880
s_add_u32 s4, s4, 108544
M v[140:143],a[244:247],a[168:171]
v_add_u32 v25, s4, v1
M v[144:147],a[248:251],a[168:171]
s_xor_b32 s4, s3, 2
s_lshl_b32 s4, s4, 10
M v[148:151],a[252:255],a[168:171]
s_add_u32 s4, s4, 108544
v_add_u32 v26, s4, v1
M v[152:155],v[52:55],a[168:171]
s_waitcnt lgkmcnt(5)
s_xor_b32 s4, s3, 3
s_lshl_b32 s4, s4, 10
M v[172:175],v[52:55],a[172:175]
ds_read_b128 a[168:171], v2 offset:12096
buffer_load_dwordx4 v[52:55], v1, s[16:19], s34 offen offset:0 sc1
M v[168:171],a[252:255],a[172:175]
s_add_u32 s4, s4, 108544
v_add_u32 v27, s4, v1
M v[164:167],a[248:251],a[172:175]
s_mul_i32 s3, s39, 4608
s_add_u32 s3, s3, 145408
M v[160:163],a[244:247],a[172:175]
buffer_load_dwordx4 a[252:255], v1, s[16:19], s34 offen offset:1024 sc1
v_lshlrev_b32 v30, 3, v0
M v[156:159],a[240:243],a[172:175]
s_waitcnt vmcnt(33)
v_add_u32 v30, s3, v30
v_mov_b32 v28, 1.0
M v[156:159],v[44:47],a[176:179]
ds_read_b128 a[172:175], v3 offset:12096
v_mov_b32 v29, 1.0
M v[160:163],v[40:43],a[176:179]
buffer_load_dwordx4 a[248:251], v1, s[16:19], s34 offen offset:2048 sc1
M v[164:167],v[36:39],a[176:179]
M v[168:171],v[68:71],a[176:179]
s_waitcnt lgkmcnt(5)
M v[148:151],v[68:71],a[180:183]
ds_read_b128 a[176:179], v5 offset:12096
buffer_load_dwordx4 a[244:247], v1, s[16:19], s34 offen offset:3072 sc1
M v[144:147],v[36:39],a[180:183]
s_add_u32 s34, s34, 4096
M v[140:143],v[40:43],a[180:183]
M v[136:139],v[44:47],a[180:183]
M v[116:119],v[44:47],a[184:187]
ds_read_b128 a[180:183], v4 offset:12096
buffer_load_dwordx4 a[240:243], v1, s[16:19], s34 offen offset:0 sc1
M v[120:123],v[40:43],a[184:187]
s_add_u32 s34, s34, 1024
M v[124:127],v[36:39],a[184:187]
M v[128:131],v[68:71],a[184:187]
s_waitcnt lgkmcnt(5)
M v[108:111],v[68:71],a[188:191]
ds_read_b128 a[184:187], v5 offset:2880
buffer_load_dwordx4 v[68:71], v1, s[16:19], s34 offen offset:0 sc1
M v[104:107],v[36:39],a[188:191]
M v[100:103],v[40:43],a[188:191]
M v[96:99],v[44:47],a[188:191]
s_waitcnt vmcnt(32)
buffer_load_dwordx4 v[36:39], v1, s[16:19], s34 offen offset:1024 sc1
M v[176:179],a[16:19],a[160:163]
ds_read_b128 a[188:191], v4 offset:2880
v_mul_f32 v116, s50, v116
M v[180:183],a[12:15],a[160:163]
ds_write_b128 v13, v[132:135]
M v[184:187],a[8:11],a[160:163]
buffer_load_dwordx4 v[40:43], v1, s[16:19], s34 offen offset:2048 sc1
v_mul_f32 v117, s50, v117
M v[188:191],a[4:7],a[160:163]
ds_write_b128 v13, v[172:175] offset:1024
M v[192:195],v[88:91],a[160:163]
s_waitcnt lgkmcnt(7)
v_mul_f32 v118, s52, v118
v_mul_f32 v119, s52, v119
M v[212:215],v[88:91],a[164:167]
ds_read_b128 a[160:163], v2 offset:2944
buffer_load_dwordx4 v[44:47], v1, s[16:19], s34 offen offset:3072 sc1
M v[208:211],a[4:7],a[164:167]
s_add_u32 s34, s34, 4096
v_mul_f32 v120, s50, v120
M v[204:207],a[8:11],a[164:167]
v_exp_f32 v116, v116
M v[200:203],a[12:15],a[164:167]
v_exp_f32 v117, v117
M v[196:199],a[16:19],a[164:167]
v_exp_f32 v118, v118
M v[216:219],a[16:19],a[168:171]
ds_read_b128 a[164:167], v3 offset:2944
v_mul_f32 v121, s50, v121
M v[220:223],a[12:15],a[168:171]
v_exp_f32 v119, v119
M v[224:227],a[8:11],a[168:171]
v_add_f32 v116, 1.0, v116
v_add_f32 v117, 1.0, v117
M v[228:231],a[4:7],a[168:171]
v_add_f32 v118, 1.0, v118
v_add_f32 v119, 1.0, v119
M v[232:235],v[88:91],a[168:171]
s_waitcnt lgkmcnt(7)
v_rcp_f32 v116, v116
M v[252:255],v[88:91],a[172:175]
ds_read_b128 a[168:171], v2 offset:12160
buffer_load_dwordx4 v[88:91], v1, s[16:19], s34 offen offset:0 sc1
M v[248:251],a[4:7],a[172:175]
v_rcp_f32 v117, v117
M v[244:247],a[8:11],a[172:175]
v_rcp_f32 v118, v118
M v[240:243],a[12:15],a[172:175]
buffer_load_dwordx4 a[4:7], v1, s[16:19], s34 offen offset:1024 sc1
v_mul_f32 v122, s52, v122
M v[236:239],a[16:19],a[172:175]
s_waitcnt vmcnt(33)
v_rcp_f32 v119, v119
M v[236:239],v[48:51],a[176:179]
ds_read_b128 a[172:175], v3 offset:12160
v_fma_f32 v116, v116, -2.0, 1.0
M v[240:243],a[28:31],a[176:179]
buffer_load_dwordx4 a[8:11], v1, s[16:19], s34 offen offset:2048 sc1
v_fma_f32 v117, v117, -2.0, 1.0
M v[244:247],a[24:27],a[176:179]
v_mul_f32 v116, v116, v118
v_mul_f32 v117, v117, v119
M v[248:251],a[20:23],a[176:179]
s_waitcnt lgkmcnt(7)
v_cvt_pk_bf16_f32 v116, v116, v117
v_mul_f32 v123, s52, v123
M v[228:231],a[20:23],a[180:183]
ds_read_b128 a[176:179], v5 offset:12160
buffer_load_dwordx4 a[12:15], v1, s[16:19], s34 offen offset:3072 sc1
M v[224:227],a[24:27],a[180:183]
s_add_u32 s34, s34, 4096
v_mul_f32 v124, s50, v124
M v[220:223],a[28:31],a[180:183]
v_exp_f32 v120, v120
M v[216:219],v[48:51],a[180:183]
v_exp_f32 v121, v121
M v[196:199],v[48:51],a[184:187]
ds_read_b128 a[180:183], v4 offset:12160
buffer_load_dwordx4 a[16:19], v1, s[16:19], s34 offen offset:0 sc1
M v[200:203],a[28:31],a[184:187]
s_add_u32 s34, s34, 1024
v_mul_f32 v125, s50, v125
M v[204:207],a[24:27],a[184:187]
v_exp_f32 v122, v122
M v[208:211],a[20:23],a[184:187]
s_waitcnt lgkmcnt(5)
v_exp_f32 v123, v123
M v[188:191],a[20:23],a[188:191]
ds_read_b128 a[184:187], v5 offset:2944
buffer_load_dwordx4 a[20:23], v1, s[16:19], s34 offen offset:0 sc1
M v[184:187],a[24:27],a[188:191]
v_add_f32 v120, 1.0, v120
v_add_f32 v121, 1.0, v121
M v[180:183],a[28:31],a[188:191]
v_add_f32 v122, 1.0, v122
v_add_f32 v123, 1.0, v123
M v[176:179],v[48:51],a[188:191]
s_waitcnt vmcnt(32)
buffer_load_dwordx4 a[24:27], v1, s[16:19], s34 offen offset:1024 sc1
s_waitcnt lgkmcnt(0)
s_barrier
v_mul_f32 v126, s52, v126
M v[176:179],a[200:203],a[160:163]
ds_read_b128 a[188:191], v4 offset:2944
ds_read_b128 v[16:19], v12
M v[180:183],v[64:67],a[160:163]
ds_read_b128 v[20:23], v12 offset:1024
v_mul_f32 v127, s52, v127
M v[184:187],v[60:63],a[160:163]
buffer_load_dwordx4 a[28:31], v1, s[16:19], s34 offen offset:2048 sc1
M v[188:191],v[56:59],a[160:163]
v_rcp_f32 v120, v120
M v[192:195],a[220:223],a[160:163]
s_waitcnt lgkmcnt(7)
v_rcp_f32 v121, v121
M v[212:215],a[220:223],a[164:167]
ds_read_b128 a[160:163], v2 offset:3008
buffer_load_dwordx4 v[48:51], v1, s[16:19], s34 offen offset:3072 sc1
M v[208:211],v[56:59],a[164:167]
s_add_u32 s34, s34, 4096
M v[204:207],v[60:63],a[164:167]
v_rcp_f32 v122, v122
M v[200:203],v[64:67],a[164:167]
v_rcp_f32 v123, v123
M v[196:199],a[200:203],a[164:167]
s_waitcnt lgkmcnt(1)
v_add_f32 v112, v112, v16
v_add_f32 v113, v113, v17
M v[216:219],a[200:203],a[168:171]
ds_read_b128 a[164:167], v3 offset:3008
v_add_f32 v114, v114, v18
M v[220:223],v[64:67],a[168:171]
v_add_f32 v115, v115, v19
v_add_f32 v152, v152, v20
M v[224:227],v[60:63],a[168:171]
v_add_f32 v153, v153, v21
v_add_f32 v154, v154, v22
M v[228:231],v[56:59],a[168:171]
v_add_f32 v155, v155, v23
v_fma_f32 v120, v120, -2.0, 1.0
M v[232:235],a[220:223],a[168:171]
s_waitcnt lgkmcnt(7)
v_fma_f32 v121, v121, -2.0, 1.0
v_mul_f32 v120, v120, v122
M v[252:255],a[220:223],a[172:175]
ds_read_b128 a[168:171], v2 offset:12224
buffer_load_dwordx4 a[220:223], v1, s[16:19], s34 offen offset:0 sc1
M v[248:251],v[56:59],a[172:175]
v_mul_f32 v121, v121, v123
v_cvt_pk_bf16_f32 v117, v120, v121
M v[244:247],v[60:63],a[172:175]
v_exp_f32 v124, v124
M v[240:243],v[64:67],a[172:175]
buffer_load_dwordx4 v[56:59], v1, s[16:19], s34 offen offset:1024 sc1
v_mul_f32 v128, s50, v128
M v[236:239],a[200:203],a[172:175]
s_waitcnt vmcnt(33)
v_exp_f32 v125, v125
M v[236:239],v[84:87],a[176:179]
ds_read_b128 a[172:175], v3 offset:12224
v_mul_f32 v129, s50, v129
M v[240:243],v[80:83],a[176:179]
buffer_load_dwordx4 v[60:63], v1, s[16:19], s34 offen offset:2048 sc1
v_mul_f32 v130, s52, v130
M v[244:247],v[76:79],a[176:179]
v_exp_f32 v126, v126
M v[248:251],v[72:75],a[176:179]
s_waitcnt lgkmcnt(7)
v_exp_f32 v127, v127
M v[228:231],v[72:75],a[180:183]
ds_read_b128 a[176:179], v5 offset:12224
buffer_load_dwordx4 v[64:67], v1, s[16:19], s34 offen offset:3072 sc1
M v[224:227],v[76:79],a[180:183]
s_add_u32 s34, s34, 4096
v_add_f32 v124, 1.0, v124
M v[220:223],v[80:83],a[180:183]
v_add_f32 v125, 1.0, v125
v_add_f32 v126, 1.0, v126
M v[216:219],v[84:87],a[180:183]
v_add_f32 v127, 1.0, v127
v_mul_f32 v131, s52, v131
M v[196:199],v[84:87],a[184:187]
ds_read_b128 a[180:183], v4 offset:12224
buffer_load_dwordx4 a[200:203], v1, s[16:19], s34 offen offset:0 sc1
M v[200:203],v[80:83],a[184:187]
s_add_u32 s34, s34, 1024
M v[204:207],v[76:79],a[184:187]
v_rcp_f32 v124, v124
M v[208:211],v[72:75],a[184:187]
s_waitcnt lgkmcnt(5)
v_rcp_f32 v125, v125
M v[188:191],v[72:75],a[188:191]
ds_read_b128 a[184:187], v5 offset:3008
buffer_load_dwordx4 v[72:75], v1, s[16:19], s34 offen offset:0 sc1
M v[184:187],v[76:79],a[188:191]
v_rcp_f32 v126, v126
M v[180:183],v[80:83],a[188:191]
v_rcp_f32 v127, v127
M v[176:179],v[84:87],a[188:191]
s_waitcnt vmcnt(32)
buffer_load_dwordx4 v[76:79], v1, s[16:19], s34 offen offset:1024 sc1
v_fma_f32 v124, v124, -2.0, 1.0
M v[176:179],a[236:239],a[160:163]
ds_read_b128 a[188:191], v4 offset:3008
v_fma_f32 v125, v125, -2.0, 1.0
M v[180:183],a[196:199],a[160:163]
v_mul_f32 v124, v124, v126
v_mul_f32 v125, v125, v127
M v[184:187],a[192:195],a[160:163]
buffer_load_dwordx4 v[80:83], v1, s[16:19], s34 offen offset:2048 sc1
v_cvt_pk_bf16_f32 v118, v124, v125
M v[188:191],v[92:95],a[160:163]
v_mov_b32 v119, s62
v_mul_f32 v96, s50, v96
M v[192:195],a[0:3],a[160:163]
s_waitcnt lgkmcnt(5)
v_exp_f32 v128, v128
M v[212:215],a[0:3],a[164:167]
ds_read_b128 a[160:163], v2 offset:3072
buffer_load_dwordx4 v[84:87], v1, s[16:19], s34 offen offset:3072 sc1
M v[208:211],v[92:95],a[164:167]
s_add_u32 s34, s34, 4096
v_mul_f32 v97, s50, v97
M v[204:207],a[192:195],a[164:167]
v_exp_f32 v129, v129
M v[200:203],a[196:199],a[164:167]
v_exp_f32 v130, v130
M v[196:199],a[236:239],a[164:167]
v_exp_f32 v131, v131
M v[216:219],a[236:239],a[168:171]
ds_read_b128 a[164:167], v3 offset:3072
v_add_f32 v128, 1.0, v128
M v[220:223],a[196:199],a[168:171]
v_add_f32 v129, 1.0, v129
v_add_f32 v130, 1.0, v130
M v[224:227],a[192:195],a[168:171]
v_add_f32 v131, 1.0, v131
v_mul_f32 v98, s52, v98
M v[228:231],v[92:95],a[168:171]
v_rcp_f32 v128, v128
M v[232:235],a[0:3],a[168:171]
s_waitcnt lgkmcnt(5)
v_rcp_f32 v129, v129
M v[252:255],a[0:3],a[172:175]
ds_read_b128 a[168:171], v2 offset:12288
buffer_load_dwordx4 a[0:3], v1, s[16:19], s34 offen offset:0 sc1
M v[248:251],v[92:95],a[172:175]
v_rcp_f32 v130, v130
M v[244:247],a[192:195],a[172:175]
v_rcp_f32 v131, v131
M v[240:243],a[196:199],a[172:175]
buffer_load_dwordx4 v[92:95], v1, s[16:19], s34 offen offset:1024 sc1
v_fma_f32 v128, v128, -2.0, 1.0
M v[236:239],a[236:239],a[172:175]
s_waitcnt vmcnt(33)
v_fma_f32 v129, v129, -2.0, 1.0
v_mul_f32 v128, v128, v130
M v[236:239],a[216:219],a[176:179]
ds_read_b128 a[172:175], v3 offset:12288
v_mul_f32 v129, v129, v131
M v[240:243],a[212:215],a[176:179]
buffer_load_dwordx4 a[192:195], v1, s[16:19], s34 offen offset:2048 sc1
v_cvt_pk_bf16_f32 v128, v128, v129
M v[244:247],a[208:211],a[176:179]
v_mov_b32 v131, s62
v_mul_f32 v99, s52, v99
M v[248:251],a[204:207],a[176:179]
s_waitcnt lgkmcnt(5)
v_exp_f32 v96, v96
M v[228:231],a[204:207],a[180:183]
ds_read_b128 a[176:179], v5 offset:12288
buffer_load_dwordx4 a[196:199], v1, s[16:19], s34 offen offset:3072 sc1
M v[224:227],a[208:211],a[180:183]
s_add_u32 s34, s34, 4096
v_mul_f32 v100, s50, v100
M v[220:223],a[212:215],a[180:183]
v_exp_f32 v97, v97
M v[216:219],a[216:219],a[180:183]
v_exp_f32 v98, v98
M v[196:199],a[216:219],a[184:187]
ds_read_b128 a[180:183], v4 offset:12288
buffer_load_dwordx4 a[236:239], v1, s[16:19], s34 offen offset:0 sc1
M v[200:203],a[212:215],a[184:187]
s_add_u32 s34, s34, 1024
v_mul_f32 v101, s50, v101
M v[204:207],a[208:211],a[184:187]
v_exp_f32 v99, v99
M v[208:211],a[204:207],a[184:187]
s_waitcnt lgkmcnt(5)
v_add_f32 v96, 1.0, v96
v_add_f32 v97, 1.0, v97
M v[188:191],a[204:207],a[188:191]
ds_read_b128 a[184:187], v5 offset:3072
buffer_load_dwordx4 a[204:207], v1, s[16:19], s34 offen offset:0 sc1
M v[184:187],a[208:211],a[188:191]
v_add_f32 v98, 1.0, v98
v_add_f32 v99, 1.0, v99
M v[180:183],a[212:215],a[188:191]
v_rcp_f32 v96, v96
M v[176:179],a[216:219],a[188:191]
s_waitcnt vmcnt(32)
buffer_load_dwordx4 a[208:211], v1, s[16:19], s34 offen offset:1024 sc1
v_mul_f32 v102, s52, v102
M v[176:179],v[32:35],a[160:163]
ds_read_b128 a[188:191], v4 offset:3072
v_mul_f32 v103, s52, v103
M v[180:183],a[232:235],a[160:163]
v_rcp_f32 v97, v97
M v[184:187],a[228:231],a[160:163]
buffer_load_dwordx4 a[212:215], v1, s[16:19], s34 offen offset:2048 sc1
M v[188:191],a[224:227],a[160:163]
v_rcp_f32 v98, v98
M v[192:195],v[52:55],a[160:163]
s_waitcnt lgkmcnt(5)
v_rcp_f32 v99, v99
M v[212:215],v[52:55],a[164:167]
ds_read_b128 a[160:163], v6 offset:3136
buffer_load_dwordx4 a[216:219], v1, s[16:19], s34 offen offset:3072 sc1
M v[208:211],a[224:227],a[164:167]
s_add_u32 s34, s34, 4096
v_fma_f32 v96, v96, -2.0, 1.0
M v[204:207],a[228:231],a[164:167]
v_fma_f32 v97, v97, -2.0, 1.0
v_mul_f32 v96, v96, v98
M v[200:203],a[232:235],a[164:167]
v_mul_f32 v97, v97, v99
v_cvt_pk_bf16_f32 v96, v96, v97
M v[196:199],v[32:35],a[164:167]
v_exp_f32 v100, v100
M v[216:219],v[32:35],a[168:171]
ds_read_b128 a[164:167], v7 offset:3136
v_mul_f32 v104, s50, v104
M v[220:223],a[232:235],a[168:171]
v_exp_f32 v101, v101
M v[224:227],a[228:231],a[168:171]
v_exp_f32 v102, v102
M v[228:231],a[224:227],a[168:171]
v_exp_f32 v103, v103
M v[232:235],v[52:55],a[168:171]
s_waitcnt lgkmcnt(5)
v_add_f32 v100, 1.0, v100
v_add_f32 v101, 1.0, v101
M v[252:255],v[52:55],a[172:175]
ds_read_b128 a[168:171], v6 offset:12352
buffer_load_dwordx4 v[52:55], v1, s[16:19], s34 offen offset:0 sc1
M v[248:251],a[224:227],a[172:175]
v_add_f32 v102, 1.0, v102
v_add_f32 v103, 1.0, v103
M v[244:247],a[228:231],a[172:175]
v_rcp_f32 v100, v100
M v[240:243],a[232:235],a[172:175]
buffer_load_dwordx4 a[224:227], v1, s[16:19], s34 offen offset:1024 sc1
v_mul_f32 v105, s50, v105
M v[236:239],v[32:35],a[172:175]
s_waitcnt vmcnt(33)
v_rcp_f32 v101, v101
M v[236:239],a[252:255],a[176:179]
ds_read_b128 a[172:175], v7 offset:12352
v_mul_f32 v106, s52, v106
M v[240:243],a[248:251],a[176:179]
buffer_load_dwordx4 a[228:231], v1, s[16:19], s34 offen offset:2048 sc1
v_mul_f32 v107, s52, v107
M v[244:247],a[244:247],a[176:179]
v_rcp_f32 v102, v102
M v[248:251],a[240:243],a[176:179]
s_waitcnt lgkmcnt(5)
v_rcp_f32 v103, v103
M v[228:231],a[240:243],a[180:183]
ds_read_b128 a[176:179], v9 offset:12352
buffer_load_dwordx4 a[232:235], v1, s[16:19], s34 offen offset:3072 sc1
M v[224:227],a[244:247],a[180:183]
s_add_u32 s34, s34, 4096
v_fma_f32 v100, v100, -2.0, 1.0
M v[220:223],a[248:251],a[180:183]
v_fma_f32 v101, v101, -2.0, 1.0
v_mul_f32 v100, v100, v102
M v[216:219],a[252:255],a[180:183]
v_mul_f32 v101, v101, v103
v_cvt_pk_bf16_f32 v97, v100, v101
M v[196:199],a[252:255],a[184:187]
ds_read_b128 a[180:183], v8 offset:12352
buffer_load_dwordx4 v[32:35], v1, s[16:19], s34 offen offset:0 sc1
M v[200:203],a[248:251],a[184:187]
s_add_u32 s34, s34, 1024
v_mul_f32 v108, s50, v108
M v[204:207],a[244:247],a[184:187]
v_exp_f32 v104, v104
M v[208:211],a[240:243],a[184:187]
s_waitcnt lgkmcnt(5)
v_exp_f32 v105, v105
M v[188:191],a[240:243],a[188:191]
ds_read_b128 a[184:187], v9 offset:3136
buffer_load_dwordx4 a[240:243], v1, s[16:19], s34 offen offset:0 sc1
M v[184:187],a[244:247],a[188:191]
v_exp_f32 v106, v106
M v[180:183],a[248:251],a[188:191]
v_exp_f32 v107, v107
M v[176:179],a[252:255],a[188:191]
s_waitcnt vmcnt(32)
buffer_load_dwordx4 a[244:247], v1, s[16:19], s34 offen offset:1024 sc1
v_add_f32 v104, 1.0, v104
M v[176:179],v[68:71],a[160:163]
ds_read_b128 a[188:191], v8 offset:3136
v_add_f32 v105, 1.0, v105
M v[180:183],v[36:39],a[160:163]
v_add_f32 v106, 1.0, v106
v_add_f32 v107, 1.0, v107
M v[184:187],v[40:43],a[160:163]
buffer_load_dwordx4 a[248:251], v1, s[16:19], s34 offen offset:2048 sc1
v_mul_f32 v109, s50, v109
M v[188:191],v[44:47],a[160:163]
v_rcp_f32 v104, v104
M v[192:195],v[88:91],a[160:163]
s_waitcnt lgkmcnt(5)
v_rcp_f32 v105, v105
M v[212:215],v[88:91],a[164:167]
ds_read_b128 a[160:163], v2 offset:2336
buffer_load_dwordx4 a[252:255], v1, s[16:19], s34 offen offset:3072 sc1
M v[208:211],v[44:47],a[164:167]
s_add_u32 s34, s34, 4096
v_mul_f32 v110, s52, v110
M v[204:207],v[40:43],a[164:167]
v_rcp_f32 v106, v106
M v[200:203],v[36:39],a[164:167]
v_rcp_f32 v107, v107
M v[196:199],v[68:71],a[164:167]
v_fma_f32 v104, v104, -2.0, 1.0
v_fma_f32 v105, v105, -2.0, 1.0
M v[216:219],v[68:71],a[168:171]
ds_read_b128 a[164:167], v3 offset:2336
v_mul_f32 v104, v104, v106
M v[220:223],v[36:39],a[168:171]
v_mul_f32 v105, v105, v107
v_cvt_pk_bf16_f32 v98, v104, v105
M v[224:227],v[40:43],a[168:171]
v_mov_b32 v99, s62
v_mul_f32 v111, s52, v111
M v[228:231],v[44:47],a[168:171]
v_exp_f32 v108, v108
M v[232:235],v[88:91],a[168:171]
s_waitcnt lgkmcnt(5)
v_exp_f32 v109, v109
M v[252:255],v[88:91],a[172:175]
ds_read_b128 a[168:171], v2 offset:11552
buffer_load_dwordx4 v[88:91], v1, s[16:19], s34 offen offset:0 sc1
M v[248:251],v[44:47],a[172:175]
v_exp_f32 v110, v110
M v[244:247],v[40:43],a[172:175]
v_exp_f32 v111, v111
M v[240:243],v[36:39],a[172:175]
buffer_load_dwordx4 v[44:47], v1, s[16:19], s34 offen offset:1024 sc1
v_add_f32 v108, 1.0, v108
M v[236:239],v[68:71],a[172:175]
s_waitcnt vmcnt(33)
v_add_f32 v109, 1.0, v109
v_add_f32 v110, 1.0, v110
M v[236:239],a[4:7],a[176:179]
ds_read_b128 a[172:175], v3 offset:11552
v_add_f32 v111, 1.0, v111
M v[240:243],a[8:11],a[176:179]
buffer_load_dwordx4 v[40:43], v1, s[16:19], s34 offen offset:2048 sc1
M v[244:247],a[12:15],a[176:179]
v_rcp_f32 v108, v108
M v[248:251],a[16:19],a[176:179]
s_waitcnt lgkmcnt(5)
v_rcp_f32 v109, v109
M v[228:231],a[16:19],a[180:183]
ds_read_b128 a[176:179], v5 offset:11552
buffer_load_dwordx4 v[36:39], v1, s[16:19], s34 offen offset:3072 sc1
M v[224:227],a[12:15],a[180:183]
s_add_u32 s34, s34, 4096
M v[220:223],a[8:11],a[180:183]
v_rcp_f32 v110, v110
M v[216:219],a[4:7],a[180:183]
v_rcp_f32 v111, v111
M v[196:199],a[4:7],a[184:187]
ds_read_b128 a[180:183], v4 offset:11552
buffer_load_dwordx4 v[68:71], v1, s[16:19], s34 offen offset:0 sc1
M v[200:203],a[8:11],a[184:187]
s_add_u32 s34, s34, 1024
v_fma_f32 v108, v108, -2.0, 1.0
M v[204:207],a[12:15],a[184:187]
v_fma_f32 v109, v109, -2.0, 1.0
v_mul_f32 v108, v108, v110
M v[208:211],a[16:19],a[184:187]
s_waitcnt lgkmcnt(5)
v_mul_f32 v109, v109, v111
v_cvt_pk_bf16_f32 v108, v108, v109
M v[188:191],a[16:19],a[188:191]
ds_read_b128 a[184:187], v5 offset:2336
buffer_load_dwordx4 a[16:19], v1, s[16:19], s34 offen offset:0 sc1
M v[184:187],a[12:15],a[188:191]
v_mul_f32 v112, s50, v112
v_mul_f32 v113, s50, v113
M v[180:183],a[8:11],a[188:191]
v_mul_f32 v114, s52, v114
v_mul_f32 v115, s52, v115
M v[176:179],a[4:7],a[188:191]
s_waitcnt vmcnt(32)
buffer_load_dwordx4 a[12:15], v1, s[16:19], s34 offen offset:1024 sc1
v_mul_f32 v156, s50, v156
M v[176:179],a[20:23],a[160:163]
ds_read_b128 a[188:191], v4 offset:2336
v_mul_f32 v157, s50, v157
M v[180:183],a[24:27],a[160:163]
v_exp_f32 v112, v112
M v[184:187],a[28:31],a[160:163]
buffer_load_dwordx4 a[8:11], v1, s[16:19], s34 offen offset:2048 sc1
v_mul_f32 v158, s52, v158
M v[188:191],v[48:51],a[160:163]
v_exp_f32 v113, v113
M v[192:195],a[220:223],a[160:163]
s_waitcnt lgkmcnt(5)
v_exp_f32 v114, v114
M v[212:215],a[220:223],a[164:167]
ds_read_b128 a[160:163], v2 offset:2400
buffer_load_dwordx4 a[4:7], v1, s[16:19], s34 offen offset:3072 sc1
M v[208:211],v[48:51],a[164:167]
s_add_u32 s34, s34, 4096
v_mul_f32 v159, s52, v159
M v[204:207],a[28:31],a[164:167]
v_exp_f32 v115, v115
M v[200:203],a[24:27],a[164:167]
v_add_f32 v112, 1.0, v112
v_add_f32 v113, 1.0, v113
M v[196:199],a[20:23],a[164:167]
v_add_f32 v114, 1.0, v114
v_add_f32 v115, 1.0, v115
M v[216:219],a[20:23],a[168:171]
ds_read_b128 a[164:167], v3 offset:2400
M v[220:223],a[24:27],a[168:171]
v_rcp_f32 v112, v112
M v[224:227],a[28:31],a[168:171]
v_rcp_f32 v113, v113
M v[228:231],v[48:51],a[168:171]
v_rcp_f32 v114, v114
M v[232:235],a[220:223],a[168:171]
s_waitcnt lgkmcnt(5)
v_rcp_f32 v115, v115
M v[252:255],a[220:223],a[172:175]
ds_read_b128 a[168:171], v2 offset:11616
buffer_load_dwordx4 a[220:223], v1, s[16:19], s34 offen offset:0 sc1
M v[248:251],v[48:51],a[172:175]
v_fma_f32 v112, v112, -2.0, 1.0
v_fma_f32 v113, v113, -2.0, 1.0
M v[244:247],a[28:31],a[172:175]
v_mul_f32 v112, v112, v114
v_mul_f32 v113, v113, v115
M v[240:243],a[24:27],a[172:175]
buffer_load_dwordx4 v[48:51], v1, s[16:19], s34 offen offset:1024 sc1
v_cvt_pk_bf16_f32 v109, v112, v113
M v[236:239],a[20:23],a[172:175]
s_waitcnt vmcnt(33)
v_mov_b32 v111, s62
v_mul_f32 v160, s50, v160
M v[236:239],v[56:59],a[176:179]
ds_read_b128 a[172:175], v3 offset:11616
v_mul_f32 v161, s50, v161
M v[240:243],v[60:63],a[176:179]
buffer_load_dwordx4 a[28:31], v1, s[16:19], s34 offen offset:2048 sc1
v_mul_f32 v162, s52, v162
M v[244:247],v[64:67],a[176:179]
v_exp_f32 v156, v156
M v[248:251],a[200:203],a[176:179]
s_waitcnt lgkmcnt(5)
v_exp_f32 v157, v157
M v[228:231],a[200:203],a[180:183]
ds_read_b128 a[176:179], v5 offset:11616
buffer_load_dwordx4 a[24:27], v1, s[16:19], s34 offen offset:3072 sc1
M v[224:227],v[64:67],a[180:183]
s_add_u32 s34, s34, 4096
v_mul_f32 v163, s52, v163
M v[220:223],v[60:63],a[180:183]
v_exp_f32 v158, v158
M v[216:219],v[56:59],a[180:183]
v_exp_f32 v159, v159
M v[196:199],v[56:59],a[184:187]
ds_read_b128 a[180:183], v4 offset:11616
buffer_load_dwordx4 a[20:23], v1, s[16:19], s34 offen offset:0 sc1
M v[200:203],v[60:63],a[184:187]
s_add_u32 s34, s34, 1024
v_add_f32 v156, 1.0, v156
M v[204:207],v[64:67],a[184:187]
v_add_f32 v157, 1.0, v157
v_add_f32 v158, 1.0, v158
M v[208:211],a[200:203],a[184:187]
s_waitcnt lgkmcnt(5)
v_add_f32 v159, 1.0, v159
M v[188:191],a[200:203],a[188:191]
ds_read_b128 a[184:187], v5 offset:2400
buffer_load_dwordx4 a[200:203], v1, s[16:19], s34 offen offset:0 sc1
M v[184:187],v[64:67],a[188:191]
v_rcp_f32 v156, v156
M v[180:183],v[60:63],a[188:191]
v_rcp_f32 v157, v157
M v[176:179],v[56:59],a[188:191]
s_waitcnt vmcnt(32)
buffer_load_dwordx4 v[64:67], v1, s[16:19], s34 offen offset:1024 sc1
M v[176:179],v[72:75],a[160:163]
ds_read_b128 a[188:191], v4 offset:2400
M v[180:183],v[76:79],a[160:163]
v_rcp_f32 v158, v158
M v[184:187],v[80:83],a[160:163]
buffer_load_dwordx4 v[60:63], v1, s[16:19], s34 offen offset:2048 sc1
M v[188:191],v[84:87],a[160:163]
v_rcp_f32 v159, v159
M v[192:195],a[0:3],a[160:163]
s_waitcnt lgkmcnt(5)
v_fma_f32 v156, v156, -2.0, 1.0
v_fma_f32 v157, v157, -2.0, 1.0
M v[212:215],a[0:3],a[164:167]
ds_read_b128 a[160:163], v2 offset:2464
buffer_load_dwordx4 v[56:59], v1, s[16:19], s34 offen offset:3072 sc1
M v[208:211],v[84:87],a[164:167]
s_add_u32 s34, s34, 4096
v_mul_f32 v156, v156, v158
M v[204:207],v[80:83],a[164:167]
v_mul_f32 v157, v157, v159
v_cvt_pk_bf16_f32 v156, v156, v157
M v[200:203],v[76:79],a[164:167]
v_exp_f32 v160, v160
M v[196:199],v[72:75],a[164:167]
v_exp_f32 v161, v161
M v[216:219],v[72:75],a[168:171]
ds_read_b128 a[164:167], v3 offset:2464
v_mul_f32 v164, s50, v164
M v[220:223],v[76:79],a[168:171]
v_exp_f32 v162, v162
M v[224:227],v[80:83],a[168:171]
v_exp_f32 v163, v163
M v[228:231],v[84:87],a[168:171]
v_add_f32 v160, 1.0, v160
v_add_f32 v161, 1.0, v161
M v[232:235],a[0:3],a[168:171]
s_waitcnt lgkmcnt(5)
v_add_f32 v162, 1.0, v162
v_add_f32 v163, 1.0, v163
M v[252:255],a[0:3],a[172:175]
ds_read_b128 a[168:171], v2 offset:11680
buffer_load_dwordx4 a[0:3], v1, s[16:19], s34 offen offset:0 sc1
M v[248:251],v[84:87],a[172:175]
v_rcp_f32 v160, v160
M v[244:247],v[80:83],a[172:175]
v_rcp_f32 v161, v161
M v[240:243],v[76:79],a[172:175]
buffer_load_dwordx4 v[84:87], v1, s[16:19], s34 offen offset:1024 sc1
v_mul_f32 v165, s50, v165
M v[236:239],v[72:75],a[172:175]
s_waitcnt vmcnt(33)
v_rcp_f32 v162, v162
M v[236:239],v[92:95],a[176:179]
ds_read_b128 a[172:175], v3 offset:11680
v_mul_f32 v166, s52, v166
M v[240:243],a[192:195],a[176:179]
buffer_load_dwordx4 v[80:83], v1, s[16:19], s34 offen offset:2048 sc1
v_mul_f32 v167, s52, v167
M v[244:247],a[196:199],a[176:179]
v_rcp_f32 v163, v163
M v[248:251],a[236:239],a[176:179]
s_waitcnt lgkmcnt(5)
v_fma_f32 v160, v160, -2.0, 1.0
v_fma_f32 v161, v161, -2.0, 1.0
M v[228:231],a[236:239],a[180:183]
ds_read_b128 a[176:179], v5 offset:11680
buffer_load_dwordx4 v[76:79], v1, s[16:19], s34 offen offset:3072 sc1
M v[224:227],a[196:199],a[180:183]
s_add_u32 s34, s34, 4096
v_mul_f32 v160, v160, v162
M v[220:223],a[192:195],a[180:183]
v_mul_f32 v161, v161, v163
v_cvt_pk_bf16_f32 v157, v160, v161
M v[216:219],v[92:95],a[180:183]
v_exp_f32 v164, v164
M v[196:199],v[92:95],a[184:187]
ds_read_b128 a[180:183], v4 offset:11680
buffer_load_dwordx4 v[72:75], v1, s[16:19], s34 offen offset:0 sc1
M v[200:203],a[192:195],a[184:187]
s_add_u32 s34, s34, 1024
v_mul_f32 v168, s50, v168
M v[204:207],a[196:199],a[184:187]
v_exp_f32 v165, v165
M v[208:211],a[236:239],a[184:187]
s_waitcnt lgkmcnt(5)
v_exp_f32 v166, v166
M v[188:191],a[236:239],a[188:191]
ds_read_b128 a[184:187], v5 offset:2464
buffer_load_dwordx4 a[236:239], v1, s[16:19], s34 offen offset:0 sc1
M v[184:187],a[196:199],a[188:191]
v_exp_f32 v167, v167
M v[180:183],a[192:195],a[188:191]
v_add_f32 v164, 1.0, v164
v_add_f32 v165, 1.0, v165
M v[176:179],v[92:95],a[188:191]
s_waitcnt vmcnt(32)
buffer_load_dwordx4 a[196:199], v1, s[16:19], s34 offen offset:1024 sc1
s_waitcnt lgkmcnt(0)
s_barrier
v_add_f32 v166, 1.0, v166
M v[176:179],a[204:207],a[160:163]
ds_read_b128 a[188:191], v4 offset:2464
v_add_f32 v167, 1.0, v167
M v[180:183],a[208:211],a[160:163]
v_rcp_f32 v164, v164
M v[184:187],a[212:215],a[160:163]
buffer_load_dwordx4 a[192:195], v1, s[16:19], s34 offen offset:2048 sc1
v_mul_f32 v169, s50, v169
M v[188:191],a[216:219],a[160:163]
v_rcp_f32 v165, v165
M v[192:195],v[52:55],a[160:163]
s_waitcnt lgkmcnt(5)
v_rcp_f32 v166, v166
M v[212:215],v[52:55],a[164:167]
ds_read_b128 a[160:163], v2 offset:2528
buffer_load_dwordx4 v[92:95], v1, s[16:19], s34 offen offset:3072 sc1
M v[208:211],a[216:219],a[164:167]
s_add_u32 s34, s34, 4096
v_mul_f32 v170, s52, v170
M v[204:207],a[212:215],a[164:167]
v_rcp_f32 v167, v167
M v[200:203],a[208:211],a[164:167]
v_fma_f32 v164, v164, -2.0, 1.0
v_fma_f32 v165, v165, -2.0, 1.0
M v[196:199],a[204:207],a[164:167]
v_mul_f32 v164, v164, v166
v_mul_f32 v165, v165, v167
M v[216:219],a[204:207],a[168:171]
ds_read_b128 a[164:167], v3 offset:2528
v_cvt_pk_bf16_f32 v158, v164, v165
M v[220:223],a[208:211],a[168:171]
v_mul_f32 v171, s52, v171
v_mul_f32 v136, s50, v136
M v[224:227],a[212:215],a[168:171]
v_exp_f32 v168, v168
M v[228:231],a[216:219],a[168:171]
v_exp_f32 v169, v169
M v[232:235],v[52:55],a[168:171]
s_waitcnt lgkmcnt(5)
v_exp_f32 v170, v170
M v[252:255],v[52:55],a[172:175]
ds_read_b128 a[168:171], v2 offset:11744
buffer_load_dwordx4 v[52:55], v1, s[16:19], s34 offen offset:0 sc1
M v[248:251],a[216:219],a[172:175]
v_exp_f32 v171, v171
M v[244:247],a[212:215],a[172:175]
v_add_f32 v168, 1.0, v168
v_add_f32 v169, 1.0, v169
M v[240:243],a[208:211],a[172:175]
buffer_load_dwordx4 a[216:219], v1, s[16:19], s34 offen offset:1024 sc1
v_add_f32 v170, 1.0, v170
M v[236:239],a[204:207],a[172:175]
s_waitcnt vmcnt(33)
v_add_f32 v171, 1.0, v171
v_mul_f32 v137, s50, v137
M v[236:239],a[224:227],a[176:179]
ds_read_b128 a[172:175], v3 offset:11744
v_mul_f32 v138, s52, v138
M v[240:243],a[228:231],a[176:179]
buffer_load_dwordx4 a[212:215], v1, s[16:19], s34 offen offset:2048 sc1
v_mul_f32 v139, s52, v139
M v[244:247],a[232:235],a[176:179]
v_rcp_f32 v168, v168
M v[248:251],v[32:35],a[176:179]
s_waitcnt lgkmcnt(5)
v_rcp_f32 v169, v169
M v[228:231],v[32:35],a[180:183]
ds_read_b128 a[176:179], v5 offset:11744
buffer_load_dwordx4 a[208:211], v1, s[16:19], s34 offen offset:3072 sc1
M v[224:227],a[232:235],a[180:183]
s_add_u32 s34, s34, 4096
M v[220:223],a[228:231],a[180:183]
v_rcp_f32 v170, v170
M v[216:219],a[224:227],a[180:183]
v_rcp_f32 v171, v171
M v[196:199],a[224:227],a[184:187]
ds_read_b128 a[180:183], v4 offset:11744
buffer_load_dwordx4 a[204:207], v1, s[16:19], s34 offen offset:0 sc1
M v[200:203],a[228:231],a[184:187]
s_add_u32 s34, s34, 1024
v_fma_f32 v168, v168, -2.0, 1.0
M v[204:207],a[232:235],a[184:187]
v_fma_f32 v169, v169, -2.0, 1.0
v_mul_f32 v168, v168, v170
M v[208:211],v[32:35],a[184:187]
s_waitcnt lgkmcnt(5)
v_mul_f32 v169, v169, v171
v_cvt_pk_bf16_f32 v159, v168, v169
M v[188:191],v[32:35],a[188:191]
ds_read_b128 a[184:187], v5 offset:2528
buffer_load_dwordx4 v[32:35], v1, s[16:19], s34 offen offset:0 sc1
M v[184:187],a[232:235],a[188:191]
ds_write_b128 v13, v[156:159] offset:2048
M v[180:183],a[228:231],a[188:191]
v_exp_f32 v136, v136
M v[176:179],a[224:227],a[188:191]
s_waitcnt vmcnt(32)
buffer_load_dwordx4 a[232:235], v1, s[16:19], s34 offen offset:1024 sc1
v_mul_f32 v140, s50, v140
M v[176:179],a[240:243],a[160:163]
ds_read_b128 a[188:191], v4 offset:2528
v_mul_f32 v141, s50, v141
M v[180:183],a[244:247],a[160:163]
v_exp_f32 v137, v137
M v[184:187],a[248:251],a[160:163]
buffer_load_dwordx4 a[228:231], v1, s[16:19], s34 offen offset:2048 sc1
v_mul_f32 v142, s52, v142
M v[188:191],a[252:255],a[160:163]
v_exp_f32 v138, v138
M v[192:195],v[88:91],a[160:163]
s_waitcnt lgkmcnt(6)
v_exp_f32 v139, v139
M v[212:215],v[88:91],a[164:167]
ds_read_b128 a[160:163], v2 offset:576
buffer_load_dwordx4 a[224:227], v1, s[16:19], s34 offen offset:3072 sc1
M v[208:211],a[252:255],a[164:167]
s_add_u32 s34, s34, 4096
v_add_f32 v136, 1.0, v136
M v[204:207],a[248:251],a[164:167]
v_add_f32 v137, 1.0, v137
v_add_f32 v138, 1.0, v138
M v[200:203],a[244:247],a[164:167]
v_add_f32 v139, 1.0, v139
v_mul_f32 v143, s52, v143
M v[196:199],a[240:243],a[164:167]
v_rcp_f32 v136, v136
M v[216:219],a[240:243],a[168:171]
ds_read_b128 a[164:167], v3 offset:576
M v[220:223],a[244:247],a[168:171]
v_rcp_f32 v137, v137
M v[224:227],a[248:251],a[168:171]
v_rcp_f32 v138, v138
M v[228:231],a[252:255],a[168:171]
v_rcp_f32 v139, v139
M v[232:235],v[88:91],a[168:171]
s_waitcnt lgkmcnt(6)
v_fma_f32 v136, v136, -2.0, 1.0
v_fma_f32 v137, v137, -2.0, 1.0
M v[252:255],v[88:91],a[172:175]
ds_read_b128 a[168:171], v2 offset:9792
buffer_load_dwordx4 v[88:91], v1, s[16:19], s34 offen offset:0 sc1
M v[248:251],a[252:255],a[172:175]
v_mul_f32 v136, v136, v138
v_mul_f32 v137, v137, v139
M v[244:247],a[248:251],a[172:175]
v_cvt_pk_bf16_f32 v136, v136, v137
v_mul_f32 v144, s50, v144
M v[240:243],a[244:247],a[172:175]
buffer_load_dwordx4 a[252:255], v1, s[16:19], s34 offen offset:1024 sc1
v_mul_f32 v145, s50, v145
M v[236:239],a[240:243],a[172:175]
s_waitcnt vmcnt(33)
v_exp_f32 v140, v140
M v[236:239],v[44:47],a[176:179]
ds_read_b128 a[172:175], v3 offset:9792
v_mul_f32 v146, s52, v146
M v[240:243],v[40:43],a[176:179]
buffer_load_dwordx4 a[248:251], v1, s[16:19], s34 offen offset:2048 sc1
v_mul_f32 v147, s52, v147
M v[244:247],v[36:39],a[176:179]
v_exp_f32 v141, v141
M v[248:251],v[68:71],a[176:179]
s_waitcnt lgkmcnt(6)
v_exp_f32 v142, v142
M v[228:231],v[68:71],a[180:183]
ds_read_b128 a[176:179], v5 offset:9792
buffer_load_dwordx4 a[244:247], v1, s[16:19], s34 offen offset:3072 sc1
M v[224:227],v[36:39],a[180:183]
s_add_u32 s34, s34, 4096
M v[220:223],v[40:43],a[180:183]
v_exp_f32 v143, v143
M v[216:219],v[44:47],a[180:183]
v_add_f32 v140, 1.0, v140
v_add_f32 v141, 1.0, v141
M v[196:199],v[44:47],a[184:187]
ds_read_b128 a[180:183], v4 offset:9792
buffer_load_dwordx4 a[240:243], v1, s[16:19], s34 offen offset:0 sc1
M v[200:203],v[40:43],a[184:187]
s_add_u32 s34, s34, 1024
v_add_f32 v142, 1.0, v142
M v[204:207],v[36:39],a[184:187]
v_add_f32 v143, 1.0, v143
M v[208:211],v[68:71],a[184:187]
s_waitcnt lgkmcnt(5)
v_rcp_f32 v140, v140
M v[188:191],v[68:71],a[188:191]
ds_read_b128 a[184:187], v5 offset:576
buffer_load_dwordx4 v[68:71], v1, s[16:19], s34 offen offset:0 sc1
M v[184:187],v[36:39],a[188:191]
v_rcp_f32 v141, v141
M v[180:183],v[40:43],a[188:191]
v_rcp_f32 v142, v142
M v[176:179],v[44:47],a[188:191]
s_waitcnt vmcnt(32)
buffer_load_dwordx4 v[36:39], v1, s[16:19], s34 offen offset:1024 sc1
M v[176:179],a[16:19],a[160:163]
ds_read_b128 a[188:191], v4 offset:576
M v[180:183],a[12:15],a[160:163]
v_rcp_f32 v143, v143
M v[184:187],a[8:11],a[160:163]
buffer_load_dwordx4 v[40:43], v1, s[16:19], s34 offen offset:2048 sc1
v_fma_f32 v140, v140, -2.0, 1.0
M v[188:191],a[4:7],a[160:163]
v_fma_f32 v141, v141, -2.0, 1.0
v_mul_f32 v140, v140, v142
M v[192:195],a[220:223],a[160:163]
s_waitcnt lgkmcnt(5)
v_mul_f32 v141, v141, v143
v_cvt_pk_bf16_f32 v137, v140, v141
M v[212:215],a[220:223],a[164:167]
ds_read_b128 a[160:163], v2 offset:640
buffer_load_dwordx4 v[44:47], v1, s[16:19], s34 offen offset:3072 sc1
M v[208:211],a[4:7],a[164:167]
s_add_u32 s34, s34, 4096
v_mul_f32 v148, s50, v148
M v[204:207],a[8:11],a[164:167]
v_exp_f32 v144, v144
M v[200:203],a[12:15],a[164:167]
v_exp_f32 v145, v145
M v[196:199],a[16:19],a[164:167]
v_exp_f32 v146, v146
M v[216:219],a[16:19],a[168:171]
ds_read_b128 a[164:167], v3 offset:640
v_mul_f32 v149, s50, v149
M v[220:223],a[12:15],a[168:171]
v_exp_f32 v147, v147
M v[224:227],a[8:11],a[168:171]
v_add_f32 v144, 1.0, v144
v_add_f32 v145, 1.0, v145
M v[228:231],a[4:7],a[168:171]
v_add_f32 v146, 1.0, v146
v_add_f32 v147, 1.0, v147
M v[232:235],a[220:223],a[168:171]
s_waitcnt lgkmcnt(5)
v_rcp_f32 v144, v144
M v[252:255],a[220:223],a[172:175]
ds_read_b128 a[168:171], v2 offset:9856
buffer_load_dwordx4 a[220:223], v1, s[16:19], s34 offen offset:0 sc1
M v[248:251],a[4:7],a[172:175]
v_rcp_f32 v145, v145
M v[244:247],a[8:11],a[172:175]
v_rcp_f32 v146, v146
M v[240:243],a[12:15],a[172:175]
buffer_load_dwordx4 a[4:7], v1, s[16:19], s34 offen offset:1024 sc1
v_mul_f32 v150, s52, v150
M v[236:239],a[16:19],a[172:175]
s_waitcnt vmcnt(33)
v_rcp_f32 v147, v147
M v[236:239],v[48:51],a[176:179]
ds_read_b128 a[172:175], v3 offset:9856
v_fma_f32 v144, v144, -2.0, 1.0
M v[240:243],a[28:31],a[176:179]
buffer_load_dwordx4 a[8:11], v1, s[16:19], s34 offen offset:2048 sc1
v_fma_f32 v145, v145, -2.0, 1.0
M v[244:247],a[24:27],a[176:179]
v_mul_f32 v144, v144, v146
v_mul_f32 v145, v145, v147
M v[248:251],a[20:23],a[176:179]
s_waitcnt lgkmcnt(5)
v_cvt_pk_bf16_f32 v138, v144, v145
v_mul_f32 v151, s52, v151
M v[228:231],a[20:23],a[180:183]
ds_read_b128 a[176:179], v5 offset:9856
buffer_load_dwordx4 a[12:15], v1, s[16:19], s34 offen offset:3072 sc1
M v[224:227],a[24:27],a[180:183]
s_add_u32 s34, s34, 4096
v_mul_f32 v152, s50, v152
M v[220:223],a[28:31],a[180:183]
v_exp_f32 v148, v148
M v[216:219],v[48:51],a[180:183]
v_exp_f32 v149, v149
M v[196:199],v[48:51],a[184:187]
ds_read_b128 a[180:183], v4 offset:9856
buffer_load_dwordx4 a[16:19], v1, s[16:19], s34 offen offset:0 sc1
M v[200:203],a[28:31],a[184:187]
s_add_u32 s34, s34, 1024
v_mul_f32 v153, s50, v153
M v[204:207],a[24:27],a[184:187]
v_exp_f32 v150, v150
M v[208:211],a[20:23],a[184:187]
s_waitcnt lgkmcnt(5)
v_exp_f32 v151, v151
M v[188:191],a[20:23],a[188:191]
ds_read_b128 a[184:187], v5 offset:640
buffer_load_dwordx4 a[20:23], v1, s[16:19], s34 offen offset:0 sc1
M v[184:187],a[24:27],a[188:191]
v_add_f32 v148, 1.0, v148
v_add_f32 v149, 1.0, v149
M v[180:183],a[28:31],a[188:191]
v_add_f32 v150, 1.0, v150
v_add_f32 v151, 1.0, v151
M v[176:179],v[48:51],a[188:191]
s_waitcnt vmcnt(32)
buffer_load_dwordx4 a[24:27], v1, s[16:19], s34 offen offset:1024 sc1
v_mul_f32 v154, s52, v154
M v[176:179],a[200:203],a[160:163]
ds_read_b128 a[188:191], v4 offset:640
v_mul_f32 v155, s52, v155
M v[180:183],v[64:67],a[160:163]
v_rcp_f32 v148, v148
M v[184:187],v[60:63],a[160:163]
buffer_load_dwordx4 a[28:31], v1, s[16:19], s34 offen offset:2048 sc1
M v[188:191],v[56:59],a[160:163]
v_rcp_f32 v149, v149
M v[192:195],a[0:3],a[160:163]
s_waitcnt lgkmcnt(5)
v_rcp_f32 v150, v150
M v[212:215],a[0:3],a[164:167]
ds_read_b128 a[160:163], v2 offset:704
buffer_load_dwordx4 v[48:51], v1, s[16:19], s34 offen offset:3072 sc1
M v[208:211],v[56:59],a[164:167]
s_add_u32 s34, s34, 4096
M v[204:207],v[60:63],a[164:167]
v_rcp_f32 v151, v151
M v[200:203],v[64:67],a[164:167]
v_fma_f32 v148, v148, -2.0, 1.0
v_fma_f32 v149, v149, -2.0, 1.0
M v[196:199],a[200:203],a[164:167]
v_mul_f32 v148, v148, v150
v_mul_f32 v149, v149, v151
M v[216:219],a[200:203],a[168:171]
ds_read_b128 a[164:167], v3 offset:704
v_cvt_pk_bf16_f32 v139, v148, v149
M v[220:223],v[64:67],a[168:171]
v_exp_f32 v152, v152
M v[224:227],v[60:63],a[168:171]
v_exp_f32 v153, v153
M v[228:231],v[56:59],a[168:171]
v_exp_f32 v154, v154
M v[232:235],a[0:3],a[168:171]
s_waitcnt lgkmcnt(5)
v_exp_f32 v155, v155
M v[252:255],a[0:3],a[172:175]
ds_read_b128 a[168:171], v2 offset:9920
buffer_load_dwordx4 a[0:3], v1, s[16:19], s34 offen offset:0 sc1
M v[248:251],v[56:59],a[172:175]
v_add_f32 v152, 1.0, v152
v_add_f32 v153, 1.0, v153
M v[244:247],v[60:63],a[172:175]
v_add_f32 v154, 1.0, v154
v_add_f32 v155, 1.0, v155
M v[240:243],v[64:67],a[172:175]
buffer_load_dwordx4 v[56:59], v1, s[16:19], s34 offen offset:1024 sc1
M v[236:239],a[200:203],a[172:175]
s_waitcnt vmcnt(33)
v_rcp_f32 v152, v152
M v[236:239],v[84:87],a[176:179]
ds_read_b128 a[172:175], v3 offset:9920
M v[240:243],v[80:83],a[176:179]
buffer_load_dwordx4 v[60:63], v1, s[16:19], s34 offen offset:2048 sc1
M v[244:247],v[76:79],a[176:179]
v_rcp_f32 v153, v153
M v[248:251],v[72:75],a[176:179]
s_waitcnt lgkmcnt(5)
v_rcp_f32 v154, v154
M v[228:231],v[72:75],a[180:183]
ds_read_b128 a[176:179], v5 offset:9920
buffer_load_dwordx4 v[64:67], v1, s[16:19], s34 offen offset:3072 sc1
M v[224:227],v[76:79],a[180:183]
s_add_u32 s34, s34, 4096
M v[220:223],v[80:83],a[180:183]
v_rcp_f32 v155, v155
M v[216:219],v[84:87],a[180:183]
v_fma_f32 v152, v152, -2.0, 1.0
v_fma_f32 v153, v153, -2.0, 1.0
M v[196:199],v[84:87],a[184:187]
ds_read_b128 a[180:183], v4 offset:9920
buffer_load_dwordx4 a[200:203], v1, s[16:19], s34 offen offset:0 sc1
M v[200:203],v[80:83],a[184:187]
s_add_u32 s34, s34, 1024
v_mul_f32 v152, v152, v154
M v[204:207],v[76:79],a[184:187]
v_mul_f32 v153, v153, v155
v_cvt_pk_bf16_f32 v152, v152, v153
M v[208:211],v[72:75],a[184:187]
s_waitcnt lgkmcnt(5)
v_and_b32 v166, 15, v0
v_lshrrev_b32 v167, 4, v0
M v[188:191],v[72:75],a[188:191]
ds_read_b128 a[184:187], v5 offset:704
buffer_load_dwordx4 v[72:75], v1, s[16:19], s34 offen offset:0 sc1
M v[184:187],v[76:79],a[188:191]
v_mul_u32_u24 v166, 288, v166
M v[180:183],v[80:83],a[188:191]
s_mul_i32 s3, s28, 9728
s_add_u32 s3, s3, 6144
M v[176:179],v[84:87],a[188:191]
s_waitcnt vmcnt(32)
buffer_load_dwordx4 v[76:79], v1, s[16:19], s34 offen offset:1024 sc1
v_add_u32 v166, s3, v166
M v[176:179],a[236:239],a[160:163]
ds_read_b128 a[188:191], v4 offset:704
v_lshl_add_u32 v14, v167, 4, v166
M v[180:183],a[196:199],a[160:163]
v_lshl_add_u32 v15, v167, 3, v166
v_add_u32 v31, s3, v1
M v[184:187],a[192:195],a[160:163]
buffer_load_dwordx4 v[80:83], v1, s[16:19], s34 offen offset:2048 sc1
s_movk_i32 s42, 1728
M v[188:191],v[92:95],a[160:163]
v_mul_u32_u24 v166, 1821, v0
v_mov_b32 v165, 2130706432
M v[192:195],v[52:55],a[160:163]
s_waitcnt lgkmcnt(5)
v_lshrrev_b32 v167, 16, v166
v_mad_u32_u24 v160, v167, s42, v1
M v[212:215],v[52:55],a[164:167]
ds_read_b128 a[160:163], v2 offset:768
buffer_load_dwordx4 v[84:87], v1, s[16:19], s34 offen offset:3072 sc1
M v[208:211],v[92:95],a[164:167]
s_add_u32 s34, s34, 4096
v_add_u32 v166, 116544, v166
M v[204:207],a[192:195],a[164:167]
v_lshrrev_b32 v167, 16, v166
v_mad_u32_u24 v161, v167, s42, v1
M v[200:203],a[196:199],a[164:167]
v_add_u32 v166, 116544, v166
v_lshrrev_b32 v167, 16, v166
M v[196:199],a[236:239],a[164:167]
v_mad_u32_u24 v162, v167, s42, v1
v_add_u32 v166, 116544, v166
M v[216:219],a[236:239],a[168:171]
ds_read_b128 a[164:167], v3 offset:768
v_lshrrev_b32 v167, 16, v166
M v[220:223],a[196:199],a[168:171]
v_mad_u32_u24 v163, v167, s42, v1
v_add_u32 v166, 116544, v166
M v[224:227],a[192:195],a[168:171]
v_lshrrev_b32 v167, 16, v166
v_mad_u32_u24 v164, v167, s42, v1
M v[228:231],v[92:95],a[168:171]
v_cmp_gt_u32 s[4:5], 32, v0
M v[232:235],v[52:55],a[168:171]
s_waitcnt lgkmcnt(5)
M v[252:255],v[52:55],a[172:175]
ds_read_b128 a[168:171], v2 offset:9984
buffer_load_dwordx4 v[52:55], v1, s[16:19], s34 offen offset:0 sc1
M v[248:251],v[92:95],a[172:175]
v_cndmask_b32 v164, v165, v164, s[4:5]
M v[244:247],a[192:195],a[172:175]
s_add_u32 s8, s63, 1152
s_add_u32 s9, s63, 5248
M v[240:243],a[196:199],a[172:175]
buffer_load_dwordx4 v[92:95], v1, s[16:19], s34 offen offset:1024 sc1
s_add_u32 s10, s63, 4096
M v[236:239],a[236:239],a[172:175]
s_waitcnt vmcnt(33)
M v[236:239],a[216:219],a[176:179]
ds_read_b128 a[172:175], v3 offset:9984
M v[240:243],a[212:215],a[176:179]
buffer_load_dwordx4 a[192:195], v1, s[16:19], s34 offen offset:2048 sc1
M v[244:247],a[208:211],a[176:179]
M v[248:251],a[204:207],a[176:179]
s_waitcnt lgkmcnt(5)
M v[228:231],a[204:207],a[180:183]
ds_read_b128 a[176:179], v5 offset:9984
buffer_load_dwordx4 a[196:199], v1, s[16:19], s34 offen offset:3072 sc1
M v[224:227],a[208:211],a[180:183]
s_add_u32 s34, s34, 4096
M v[220:223],a[212:215],a[180:183]
M v[216:219],a[216:219],a[180:183]
M v[196:199],a[216:219],a[184:187]
ds_read_b128 a[180:183], v4 offset:9984
buffer_load_dwordx4 a[236:239], v1, s[16:19], s34 offen offset:0 sc1
M v[200:203],a[212:215],a[184:187]
s_add_u32 s34, s34, 1024
M v[204:207],a[208:211],a[184:187]
M v[208:211],a[204:207],a[184:187]
s_waitcnt lgkmcnt(5)
M v[188:191],a[204:207],a[188:191]
ds_read_b128 a[184:187], v5 offset:768
buffer_load_dwordx4 a[204:207], v1, s[16:19], s34 offen offset:0 sc1
M v[184:187],a[208:211],a[188:191]
M v[180:183],a[212:215],a[188:191]
M v[176:179],a[216:219],a[188:191]
s_waitcnt vmcnt(32)
buffer_load_dwordx4 a[208:211], v1, s[16:19], s34 offen offset:1024 sc1
M v[176:179],v[32:35],a[160:163]
ds_read_b128 a[188:191], v4 offset:768
M v[180:183],a[232:235],a[160:163]
M v[184:187],a[228:231],a[160:163]
buffer_load_dwordx4 a[212:215], v1, s[16:19], s34 offen offset:2048 sc1
M v[188:191],a[224:227],a[160:163]
M v[192:195],v[88:91],a[160:163]
s_waitcnt lgkmcnt(5)
M v[212:215],v[88:91],a[164:167]
ds_read_b128 a[160:163], v6 offset:832
buffer_load_dwordx4 a[216:219], v1, s[16:19], s34 offen offset:3072 sc1
M v[208:211],a[224:227],a[164:167]
s_add_u32 s34, s34, 4096
M v[204:207],a[228:231],a[164:167]
M v[200:203],a[232:235],a[164:167]
M v[196:199],v[32:35],a[164:167]
M v[216:219],v[32:35],a[168:171]
ds_read_b128 a[164:167], v7 offset:832
M v[220:223],a[232:235],a[168:171]
M v[224:227],a[228:231],a[168:171]
M v[228:231],a[224:227],a[168:171]
M v[232:235],v[88:91],a[168:171]
s_waitcnt lgkmcnt(5)
M v[252:255],v[88:91],a[172:175]
ds_read_b128 a[168:171], v6 offset:10048
buffer_load_dwordx4 v[88:91], v1, s[16:19], s34 offen offset:0 sc1
M v[248:251],a[224:227],a[172:175]
M v[244:247],a[228:231],a[172:175]
M v[240:243],a[232:235],a[172:175]
buffer_load_dwordx4 a[224:227], v1, s[16:19], s34 offen offset:1024 sc1
M v[236:239],v[32:35],a[172:175]
s_waitcnt vmcnt(33)
M v[236:239],a[252:255],a[176:179]
ds_read_b128 a[172:175], v7 offset:10048
M v[240:243],a[248:251],a[176:179]
buffer_load_dwordx4 a[228:231], v1, s[16:19], s34 offen offset:2048 sc1
M v[244:247],a[244:247],a[176:179]
M v[248:251],a[240:243],a[176:179]
s_waitcnt lgkmcnt(5)
M v[228:231],a[240:243],a[180:183]
ds_read_b128 a[176:179], v9 offset:10048
buffer_load_dwordx4 a[232:235], v1, s[16:19], s34 offen offset:3072 sc1
M v[224:227],a[244:247],a[180:183]
s_add_u32 s34, s34, 4096
M v[220:223],a[248:251],a[180:183]
M v[216:219],a[252:255],a[180:183]
M v[196:199],a[252:255],a[184:187]
ds_read_b128 a[180:183], v8 offset:10048
buffer_load_dwordx4 v[32:35], v1, s[16:19], s34 offen offset:0 sc1
M v[200:203],a[248:251],a[184:187]
s_add_u32 s34, s34, 1024
M v[204:207],a[244:247],a[184:187]
M v[208:211],a[240:243],a[184:187]
s_waitcnt lgkmcnt(5)
M v[188:191],a[240:243],a[188:191]
ds_read_b128 a[184:187], v9 offset:832
buffer_load_dwordx4 a[240:243], v1, s[16:19], s34 offen offset:0 sc1
M v[184:187],a[244:247],a[188:191]
M v[180:183],a[248:251],a[188:191]
M v[176:179],a[252:255],a[188:191]
s_waitcnt vmcnt(32)
buffer_load_dwordx4 a[244:247], v1, s[16:19], s34 offen offset:1024 sc1
M v[176:179],v[68:71],a[160:163]
ds_read_b128 a[188:191], v8 offset:832
M v[180:183],v[36:39],a[160:163]
M v[184:187],v[40:43],a[160:163]
buffer_load_dwordx4 a[248:251], v1, s[16:19], s34 offen offset:2048 sc1
M v[188:191],v[44:47],a[160:163]
M v[192:195],a[220:223],a[160:163]
s_waitcnt lgkmcnt(5)
M v[212:215],a[220:223],a[164:167]
ds_read_b128 a[160:163], v3 offset:32
buffer_load_dwordx4 a[252:255], v1, s[16:19], s34 offen offset:3072 sc1
M v[208:211],v[44:47],a[164:167]
s_add_u32 s34, s34, 4096
M v[204:207],v[40:43],a[164:167]
M v[200:203],v[36:39],a[164:167]
M v[196:199],v[68:71],a[164:167]
M v[216:219],v[68:71],a[168:171]
ds_read_b128 a[164:167], v5 offset:32
M v[220:223],v[36:39],a[168:171]
M v[224:227],v[40:43],a[168:171]
M v[228:231],v[44:47],a[168:171]
M v[232:235],a[220:223],a[168:171]
s_waitcnt lgkmcnt(5)
M v[252:255],a[220:223],a[172:175]
ds_read_b128 a[168:171], v3 offset:96
buffer_load_dwordx4 a[220:223], v1, s[16:19], s34 offen offset:0 sc1
M v[248:251],v[44:47],a[172:175]
M v[244:247],v[40:43],a[172:175]
M v[240:243],v[36:39],a[172:175]
buffer_load_dwordx4 v[44:47], v1, s[16:19], s34 offen offset:1024 sc1
M v[236:239],v[68:71],a[172:175]
s_waitcnt vmcnt(33)
M v[236:239],a[4:7],a[176:179]
ds_read_b128 a[172:175], v5 offset:96
M v[240:243],a[8:11],a[176:179]
buffer_load_dwordx4 v[40:43], v1, s[16:19], s34 offen offset:2048 sc1
M v[244:247],a[12:15],a[176:179]
M v[248:251],a[16:19],a[176:179]
s_waitcnt lgkmcnt(5)
M v[228:231],a[16:19],a[180:183]
ds_read_b128 a[176:179], v3 offset:160
buffer_load_dwordx4 v[36:39], v1, s[16:19], s34 offen offset:3072 sc1
M v[224:227],a[12:15],a[180:183]
s_add_u32 s34, s34, 4096
M v[220:223],a[8:11],a[180:183]
M v[216:219],a[4:7],a[180:183]
M v[196:199],a[4:7],a[184:187]
ds_read_b128 a[180:183], v5 offset:160
buffer_load_dwordx4 v[68:71], v1, s[16:19], s34 offen offset:0 sc1
M v[200:203],a[8:11],a[184:187]
s_add_u32 s34, s34, 1024
M v[204:207],a[12:15],a[184:187]
M v[208:211],a[16:19],a[184:187]
s_waitcnt lgkmcnt(5)
M v[188:191],a[16:19],a[188:191]
ds_read_b128 a[184:187], v3 offset:224
s_mov_b32 m0, s46
M v[184:187],a[12:15],a[188:191]
buffer_load_dwordx4 v1, s[16:19], s47 offen offset:0 sc1 lds
M v[180:183],a[8:11],a[188:191]
buffer_store_dwordx4 v[116:119], v1, s[16:19], s44 offen offset:0 sc1
M v[176:179],a[4:7],a[188:191]
s_waitcnt vmcnt(33)
s_waitcnt lgkmcnt(6)
M v[196:199],a[20:23],a[160:163]
ds_read_b128 a[188:191], v5 offset:224
M v[200:203],a[24:27],a[160:163]
buffer_load_dwordx4 v1, s[16:19], s47 offen offset:1024 sc1 lds
M v[204:207],a[28:31],a[160:163]
buffer_store_dwordx4 v[128:131], v1, s[16:19], s44 offen offset:1024 sc1
M v[208:211],v[48:51],a[160:163]
M v[212:215],a[0:3],a[160:163]
s_waitcnt vmcnt(31)
s_waitcnt lgkmcnt(6)
M v[196:199],v[56:59],a[164:167]
ds_read_b128 a[160:163], v2 offset:32
buffer_load_dwordx4 v1, s[16:19], s47 offen offset:2048 sc1 lds
M v[200:203],v[60:63],a[164:167]
buffer_store_dwordx4 v[96:99], v1, s[16:19], s45 offen offset:0 sc1
M v[204:207],v[64:67],a[164:167]
M v[208:211],a[200:203],a[164:167]
s_waitcnt vmcnt(28)
s_waitcnt lgkmcnt(6)
M v[196:199],v[72:75],a[168:171]
ds_read_b128 a[164:167], v4 offset:32
buffer_load_dwordx4 v1, s[16:19], s47 offen offset:3072 sc1 lds
M v[200:203],v[76:79],a[168:171]
buffer_store_dwordx4 v[108:111], v1, s[16:19], s45 offen offset:1024 sc1
M v[204:207],v[80:83],a[168:171]
M v[208:211],v[84:87],a[168:171]
M v[212:215],v[52:55],a[168:171]
s_waitcnt vmcnt(26)
s_waitcnt lgkmcnt(6)
s_add_u32 s46, s46, 4096
s_add_u32 s47, s47, 4096
M v[196:199],v[92:95],a[172:175]
ds_read_b128 a[168:171], v2 offset:96
s_mov_b32 m0, s46
M v[200:203],a[192:195],a[172:175]
buffer_load_dwordx4 v1, s[16:19], s47 offen offset:0 sc1 lds
M v[204:207],a[196:199],a[172:175]
M v[208:211],a[236:239],a[172:175]
s_waitcnt vmcnt(22)
s_waitcnt lgkmcnt(6)
M v[196:199],a[204:207],a[176:179]
ds_read_b128 a[172:175], v4 offset:96
M v[200:203],a[208:211],a[176:179]
buffer_load_dwordx4 v1, s[16:19], s47 offen offset:1024 sc1 lds
M v[204:207],a[212:215],a[176:179]
M v[208:211],a[216:219],a[176:179]
M v[212:215],v[88:91],a[176:179]
s_waitcnt vmcnt(19)
s_waitcnt lgkmcnt(6)
M v[196:199],a[224:227],a[180:183]
ds_read_b128 a[176:179], v2 offset:160
buffer_load_dwordx4 v1, s[16:19], s47 offen offset:2048 sc1 lds
M v[200:203],a[228:231],a[180:183]
M v[204:207],a[232:235],a[180:183]
M v[208:211],v[32:35],a[180:183]
s_waitcnt vmcnt(15)
s_waitcnt lgkmcnt(6)
M v[196:199],a[240:243],a[184:187]
ds_read_b128 a[180:183], v4 offset:160
buffer_load_dwordx4 v1, s[16:19], s47 offen offset:3072 sc1 lds
M v[200:203],a[244:247],a[184:187]
M v[204:207],a[248:251],a[184:187]
M v[208:211],a[252:255],a[184:187]
M v[212:215],a[220:223],a[184:187]
s_waitcnt vmcnt(12)
s_waitcnt lgkmcnt(6)
s_add_u32 s46, s46, 4096
s_add_u32 s47, s47, 4096
M v[196:199],v[44:47],a[188:191]
ds_read_b128 a[184:187], v2 offset:224
s_mov_b32 m0, s46
M v[200:203],v[40:43],a[188:191]
buffer_load_dwordx4 v1, s[16:19], s47 offen offset:0 sc1 lds
M v[204:207],v[36:39],a[188:191]
M v[208:211],v[68:71],a[188:191]
s_waitcnt lgkmcnt(6)
M v[176:179],a[20:23],a[160:163]
ds_read_b128 a[188:191], v4 offset:224
M v[180:183],a[24:27],a[160:163]
buffer_load_dwordx4 v1, s[16:19], s47 offen offset:1024 sc1 lds
M v[184:187],a[28:31],a[160:163]
M v[188:191],v[48:51],a[160:163]
ds_write_b128 v13, v[212:215]
M v[192:195],a[0:3],a[160:163]
s_waitcnt lgkmcnt(7)
v_mul_f32 v196, s50, v196
v_mul_f32 v197, s50, v197
M v[176:179],v[56:59],a[164:167]
ds_read_b128 a[160:163], v3 offset:9248
buffer_load_dwordx4 v1, s[16:19], s47 offen offset:2048 sc1 lds
M v[180:183],v[60:63],a[164:167]
v_mul_f32 v198, s52, v198
v_mul_f32 v199, s52, v199
M v[184:187],v[64:67],a[164:167]
v_exp_f32 v196, v196
M v[188:191],a[200:203],a[164:167]
s_waitcnt lgkmcnt(7)
v_exp_f32 v197, v197
M v[176:179],v[72:75],a[168:171]
ds_read_b128 a[164:167], v5 offset:9248
buffer_load_dwordx4 v1, s[16:19], s47 offen offset:3072 sc1 lds
M v[180:183],v[76:79],a[168:171]
v_exp_f32 v198, v198
M v[184:187],v[80:83],a[168:171]
v_exp_f32 v199, v199
M v[188:191],v[84:87],a[168:171]
v_add_f32 v196, 1.0, v196
v_add_f32 v197, 1.0, v197
M v[192:195],v[52:55],a[168:171]
s_waitcnt lgkmcnt(7)
v_add_f32 v198, 1.0, v198
v_add_f32 v199, 1.0, v199
M v[176:179],v[92:95],a[172:175]
ds_read_b128 a[168:171], v3 offset:9312
v_mul_f32 v200, s50, v200
M v[180:183],a[192:195],a[172:175]
v_rcp_f32 v196, v196
M v[184:187],a[196:199],a[172:175]
v_rcp_f32 v197, v197
M v[188:191],a[236:239],a[172:175]
s_waitcnt lgkmcnt(7)
v_rcp_f32 v198, v198
M v[176:179],a[204:207],a[176:179]
ds_read_b128 a[172:175], v5 offset:9312
v_mul_f32 v201, s50, v201
M v[180:183],a[208:211],a[176:179]
v_rcp_f32 v199, v199
M v[184:187],a[212:215],a[176:179]
v_fma_f32 v196, v196, -2.0, 1.0
v_fma_f32 v197, v197, -2.0, 1.0
M v[188:191],a[216:219],a[176:179]
v_mul_f32 v196, v196, v198
v_mul_f32 v197, v197, v199
M v[192:195],v[88:91],a[176:179]
s_waitcnt lgkmcnt(7)
v_cvt_pk_bf16_f32 v196, v196, v197
v_mul_f32 v202, s52, v202
M v[176:179],a[224:227],a[180:183]
ds_read_b128 a[176:179], v3 offset:9376
v_mul_f32 v203, s52, v203
M v[180:183],a[228:231],a[180:183]
v_exp_f32 v200, v200
M v[184:187],a[232:235],a[180:183]
v_exp_f32 v201, v201
M v[188:191],v[32:35],a[180:183]
s_waitcnt lgkmcnt(7)
v_exp_f32 v202, v202
M v[176:179],a[240:243],a[184:187]
ds_read_b128 a[180:183], v5 offset:9376
v_mul_f32 v204, s50, v204
M v[180:183],a[244:247],a[184:187]
v_exp_f32 v203, v203
M v[184:187],a[248:251],a[184:187]
s_waitcnt lgkmcnt(0)
s_barrier
ds_read_b128 v[16:19], v12
v_add_f32 v200, 1.0, v200
M v[188:191],a[252:255],a[184:187]
v_add_f32 v201, 1.0, v201
v_add_f32 v202, 1.0, v202
M v[192:195],a[220:223],a[184:187]
s_waitcnt lgkmcnt(8)
v_add_f32 v203, 1.0, v203
v_mul_f32 v205, s50, v205
M v[176:179],v[44:47],a[188:191]
ds_read_b128 a[184:187], v3 offset:9440
v_mul_f32 v206, s52, v206
M v[180:183],v[40:43],a[188:191]
v_rcp_f32 v200, v200
M v[184:187],v[36:39],a[188:191]
v_rcp_f32 v201, v201
M v[188:191],v[68:71],a[188:191]
s_waitcnt lgkmcnt(7)
v_rcp_f32 v202, v202
M v[236:239],a[20:23],a[160:163]
ds_read_b128 a[188:191], v5 offset:9440
v_mul_f32 v207, s52, v207
M v[240:243],a[24:27],a[160:163]
s_waitcnt lgkmcnt(2)
v_rcp_f32 v203, v203
M v[244:247],a[28:31],a[160:163]
v_fma_f32 v200, v200, -2.0, 1.0
v_fma_f32 v201, v201, -2.0, 1.0
M v[248:251],v[48:51],a[160:163]
v_add_f32 v192, v192, v16
v_add_f32 v193, v193, v17
M v[252:255],a[0:3],a[160:163]
s_waitcnt lgkmcnt(7)
v_add_f32 v194, v194, v18
v_add_f32 v195, v195, v19
M v[236:239],v[56:59],a[164:167]
ds_read_b128 a[160:163], v2 offset:9248
v_mul_f32 v200, v200, v202
M v[240:243],v[60:63],a[164:167]
v_mul_f32 v201, v201, v203
v_cvt_pk_bf16_f32 v197, v200, v201
M v[244:247],v[64:67],a[164:167]
v_exp_f32 v204, v204
M v[248:251],a[200:203],a[164:167]
s_waitcnt lgkmcnt(7)
v_exp_f32 v205, v205
M v[236:239],v[72:75],a[168:171]
ds_read_b128 a[164:167], v4 offset:9248
v_mul_f32 v208, s50, v208
M v[240:243],v[76:79],a[168:171]
v_exp_f32 v206, v206
M v[244:247],v[80:83],a[168:171]
v_exp_f32 v207, v207
M v[248:251],v[84:87],a[168:171]
v_add_f32 v204, 1.0, v204
v_add_f32 v205, 1.0, v205
M v[252:255],v[52:55],a[168:171]
s_waitcnt lgkmcnt(7)
v_add_f32 v206, 1.0, v206
v_add_f32 v207, 1.0, v207
M v[236:239],v[92:95],a[172:175]
ds_read_b128 a[168:171], v2 offset:9312
v_mul_f32 v209, s50, v209
M v[240:243],a[192:195],a[172:175]
v_rcp_f32 v204, v204
M v[244:247],a[196:199],a[172:175]
v_rcp_f32 v205, v205
M v[248:251],a[236:239],a[172:175]
s_waitcnt lgkmcnt(7)
v_rcp_f32 v206, v206
M v[236:239],a[204:207],a[176:179]
ds_read_b128 a[172:175], v4 offset:9312
v_mul_f32 v210, s52, v210
M v[240:243],a[208:211],a[176:179]
v_rcp_f32 v207, v207
M v[244:247],a[212:215],a[176:179]
v_fma_f32 v204, v204, -2.0, 1.0
v_fma_f32 v205, v205, -2.0, 1.0
M v[248:251],a[216:219],a[176:179]
v_mul_f32 v204, v204, v206
v_mul_f32 v205, v205, v207
M v[252:255],v[88:91],a[176:179]
s_waitcnt lgkmcnt(7)
v_cvt_pk_bf16_f32 v198, v204, v205
v_mov_b32 v199, s62
M v[236:239],a[224:227],a[180:183]
ds_read_b128 a[176:179], v2 offset:9376
v_mul_f32 v211, s52, v211
M v[240:243],a[228:231],a[180:183]
buffer_store_dwordx4 v[196:199], v1, s[16:19], s44 offen offset:2048 sc1
M v[244:247],a[232:235],a[180:183]
v_exp_f32 v208, v208
M v[248:251],v[32:35],a[180:183]
s_waitcnt lgkmcnt(6)
v_exp_f32 v209, v209
M v[236:239],a[240:243],a[184:187]
ds_read_b128 a[180:183], v4 offset:9376
v_mul_f32 v176, s50, v176
M v[240:243],a[244:247],a[184:187]
v_exp_f32 v210, v210
M v[244:247],a[248:251],a[184:187]
v_exp_f32 v211, v211
M v[248:251],a[252:255],a[184:187]
v_add_f32 v208, 1.0, v208
v_add_f32 v209, 1.0, v209
M v[252:255],a[220:223],a[184:187]
s_waitcnt lgkmcnt(6)
v_add_f32 v210, 1.0, v210
v_add_f32 v211, 1.0, v211
M v[236:239],v[44:47],a[188:191]
ds_read_b128 a[184:187], v2 offset:9440
v_mul_f32 v177, s50, v177
M v[240:243],v[40:43],a[188:191]
v_rcp_f32 v208, v208
M v[244:247],v[36:39],a[188:191]
v_rcp_f32 v209, v209
M v[248:251],v[68:71],a[188:191]
s_waitcnt lgkmcnt(6)
v_rcp_f32 v210, v210
M v[216:219],a[20:23],a[160:163]
ds_read_b128 a[188:191], v4 offset:9440
v_mul_f32 v178, s52, v178
M v[220:223],a[24:27],a[160:163]
v_rcp_f32 v211, v211
M v[224:227],a[28:31],a[160:163]
v_fma_f32 v208, v208, -2.0, 1.0
v_fma_f32 v209, v209, -2.0, 1.0
M v[228:231],v[48:51],a[160:163]
ds_write_b128 v13, v[252:255] offset:1024
M v[232:235],a[0:3],a[160:163]
s_waitcnt lgkmcnt(7)
v_mul_f32 v208, v208, v210
v_mul_f32 v209, v209, v211
M v[216:219],v[56:59],a[164:167]
v_cvt_pk_bf16_f32 v208, v208, v209
v_mov_b32 v211, s62
M v[220:223],v[60:63],a[164:167]
buffer_store_dwordx4 v[208:211], v1, s[16:19], s44 offen offset:3072 sc1
M v[224:227],v[64:67],a[164:167]
v_mul_f32 v179, s52, v179
M v[228:231],a[200:203],a[164:167]
s_waitcnt lgkmcnt(6)
v_exp_f32 v176, v176
M v[216:219],v[72:75],a[168:171]
v_exp_f32 v177, v177
M v[220:223],v[76:79],a[168:171]
v_exp_f32 v178, v178
M v[224:227],v[80:83],a[168:171]
v_exp_f32 v179, v179
M v[228:231],v[84:87],a[168:171]
v_add_f32 v176, 1.0, v176
v_add_f32 v177, 1.0, v177
M v[232:235],v[52:55],a[168:171]
s_waitcnt lgkmcnt(5)
v_add_f32 v178, 1.0, v178
v_add_f32 v179, 1.0, v179
M v[216:219],v[92:95],a[172:175]
v_rcp_f32 v176, v176
M v[220:223],a[192:195],a[172:175]
v_rcp_f32 v177, v177
M v[224:227],a[196:199],a[172:175]
v_rcp_f32 v178, v178
M v[228:231],a[236:239],a[172:175]
s_waitcnt lgkmcnt(4)
v_rcp_f32 v179, v179
M v[216:219],a[204:207],a[176:179]
v_fma_f32 v176, v176, -2.0, 1.0
v_fma_f32 v177, v177, -2.0, 1.0
M v[220:223],a[208:211],a[176:179]
v_mul_f32 v176, v176, v178
v_mul_f32 v177, v177, v179
M v[224:227],a[212:215],a[176:179]
v_cvt_pk_bf16_f32 v176, v176, v177
M v[228:231],a[216:219],a[176:179]
M v[232:235],v[88:91],a[176:179]
s_waitcnt lgkmcnt(3)
M v[216:219],a[224:227],a[180:183]
M v[220:223],a[228:231],a[180:183]
M v[224:227],a[232:235],a[180:183]
M v[228:231],v[32:35],a[180:183]
s_waitcnt lgkmcnt(2)
M v[216:219],a[240:243],a[184:187]
M v[220:223],a[244:247],a[184:187]
M v[224:227],a[248:251],a[184:187]
M v[228:231],a[252:255],a[184:187]
M v[232:235],a[220:223],a[184:187]
s_waitcnt lgkmcnt(1)
M v[216:219],v[44:47],a[188:191]
M v[220:223],v[40:43],a[188:191]
M v[224:227],v[36:39],a[188:191]
s_waitcnt vmcnt(2)
M v[228:231],v[68:71],a[188:191]
buffer_load_dwordx4 v[112:115], v1, s[16:19], s49 offen offset:0 sc1
buffer_load_dwordx4 v[116:119], v1, s[16:19], s49 offen offset:1024 sc1
buffer_load_dwordx4 v[96:99], v1, s[16:19], s48 offen offset:0 sc1
buffer_load_dwordx4 v[100:103], v1, s[16:19], s48 offen offset:1024 sc1
v_pk_mul_f32 v[180:181], v[180:181], s[50:51]
v_pk_mul_f32 v[182:183], v[182:183], s[52:53]
v_exp_f32 v180, v180
v_exp_f32 v181, v181
v_exp_f32 v182, v182
v_exp_f32 v183, v183
v_pk_add_f32 v[180:181], v[180:181], s[54:55]
v_rcp_f32 v180, v180
v_pk_add_f32 v[182:183], v[182:183], s[54:55]
v_rcp_f32 v181, v181
v_rcp_f32 v182, v182
v_rcp_f32 v183, v183
v_pk_fma_f32 v[180:181], v[180:181], s[56:57], v[28:29]
v_pk_mul_f32 v[180:181], v[180:181], v[182:183]
v_cvt_pk_bf16_f32 v177, v180, v181
v_pk_mul_f32 v[184:185], v[184:185], s[50:51]
v_pk_mul_f32 v[186:187], v[186:187], s[52:53]
v_exp_f32 v184, v184
v_exp_f32 v185, v185
v_exp_f32 v186, v186
v_exp_f32 v187, v187
v_pk_add_f32 v[184:185], v[184:185], s[54:55]
v_rcp_f32 v184, v184
v_pk_add_f32 v[186:187], v[186:187], s[54:55]
v_rcp_f32 v185, v185
v_rcp_f32 v186, v186
v_rcp_f32 v187, v187
v_pk_fma_f32 v[184:185], v[184:185], s[56:57], v[28:29]
v_pk_mul_f32 v[184:185], v[184:185], v[186:187]
v_cvt_pk_bf16_f32 v178, v184, v185
v_mov_b32 v179, s62
buffer_store_dwordx4 v[176:179], v1, s[16:19], s45 offen offset:2048 sc1
v_pk_mul_f32 v[188:189], v[188:189], s[50:51]
v_pk_mul_f32 v[190:191], v[190:191], s[52:53]
v_exp_f32 v188, v188
v_exp_f32 v189, v189
v_exp_f32 v190, v190
v_exp_f32 v191, v191
v_pk_add_f32 v[188:189], v[188:189], s[54:55]
v_rcp_f32 v188, v188
v_pk_add_f32 v[190:191], v[190:191], s[54:55]
v_rcp_f32 v189, v189
v_rcp_f32 v190, v190
v_rcp_f32 v191, v191
v_pk_fma_f32 v[188:189], v[188:189], s[56:57], v[28:29]
v_pk_mul_f32 v[188:189], v[188:189], v[190:191]
v_cvt_pk_bf16_f32 v188, v188, v189
v_pk_mul_f32 v[192:193], v[192:193], s[50:51]
v_pk_mul_f32 v[194:195], v[194:195], s[52:53]
v_exp_f32 v192, v192
v_exp_f32 v193, v193
v_exp_f32 v194, v194
v_exp_f32 v195, v195
v_pk_add_f32 v[192:193], v[192:193], s[54:55]
v_rcp_f32 v192, v192
v_pk_add_f32 v[194:195], v[194:195], s[54:55]
v_rcp_f32 v193, v193
v_rcp_f32 v194, v194
v_rcp_f32 v195, v195
v_pk_fma_f32 v[192:193], v[192:193], s[56:57], v[28:29]
v_pk_mul_f32 v[192:193], v[192:193], v[194:195]
v_cvt_pk_bf16_f32 v189, v192, v193
v_mov_b32 v191, s62
buffer_store_dwordx4 v[188:191], v1, s[16:19], s45 offen offset:3072 sc1
v_pk_mul_f32 v[236:237], v[236:237], s[50:51]
v_pk_mul_f32 v[238:239], v[238:239], s[52:53]
v_exp_f32 v236, v236
v_exp_f32 v237, v237
v_exp_f32 v238, v238
v_exp_f32 v239, v239
v_pk_add_f32 v[236:237], v[236:237], s[54:55]
v_rcp_f32 v236, v236
v_pk_add_f32 v[238:239], v[238:239], s[54:55]
v_rcp_f32 v237, v237
v_rcp_f32 v238, v238
v_rcp_f32 v239, v239
v_pk_fma_f32 v[236:237], v[236:237], s[56:57], v[28:29]
v_pk_mul_f32 v[236:237], v[236:237], v[238:239]
v_cvt_pk_bf16_f32 v236, v236, v237
v_pk_mul_f32 v[240:241], v[240:241], s[50:51]
v_pk_mul_f32 v[242:243], v[242:243], s[52:53]
v_exp_f32 v240, v240
v_exp_f32 v241, v241
v_exp_f32 v242, v242
v_exp_f32 v243, v243
v_pk_add_f32 v[240:241], v[240:241], s[54:55]
v_rcp_f32 v240, v240
v_pk_add_f32 v[242:243], v[242:243], s[54:55]
v_rcp_f32 v241, v241
v_rcp_f32 v242, v242
v_rcp_f32 v243, v243
v_pk_fma_f32 v[240:241], v[240:241], s[56:57], v[28:29]
v_pk_mul_f32 v[240:241], v[240:241], v[242:243]
v_cvt_pk_bf16_f32 v237, v240, v241
v_pk_mul_f32 v[244:245], v[244:245], s[50:51]
v_pk_mul_f32 v[246:247], v[246:247], s[52:53]
v_exp_f32 v244, v244
v_exp_f32 v245, v245
v_exp_f32 v246, v246
v_exp_f32 v247, v247
v_pk_add_f32 v[244:245], v[244:245], s[54:55]
v_rcp_f32 v244, v244
v_pk_add_f32 v[246:247], v[246:247], s[54:55]
v_rcp_f32 v245, v245
v_rcp_f32 v246, v246
v_rcp_f32 v247, v247
v_pk_fma_f32 v[244:245], v[244:245], s[56:57], v[28:29]
v_pk_mul_f32 v[244:245], v[244:245], v[246:247]
v_cvt_pk_bf16_f32 v238, v244, v245
v_pk_mul_f32 v[248:249], v[248:249], s[50:51]
v_pk_mul_f32 v[250:251], v[250:251], s[52:53]
v_exp_f32 v248, v248
v_exp_f32 v249, v249
v_exp_f32 v250, v250
v_exp_f32 v251, v251
v_pk_add_f32 v[248:249], v[248:249], s[54:55]
v_rcp_f32 v248, v248
v_pk_add_f32 v[250:251], v[250:251], s[54:55]
v_rcp_f32 v249, v249
v_rcp_f32 v250, v250
v_rcp_f32 v251, v251
v_pk_fma_f32 v[248:249], v[248:249], s[56:57], v[28:29]
v_pk_mul_f32 v[248:249], v[248:249], v[250:251]
v_cvt_pk_bf16_f32 v239, v248, v249
ds_write_b128 v13, v[236:239] offset:3072
s_waitcnt lgkmcnt(0)
s_barrier
s_cmp_eq_u32 s33, 125
s_cbranch_scc1 L_end
ds_read_b128 a[0:3], v24 offset:0
ds_read_b128 a[4:7], v24 offset:4096
ds_read_b128 a[8:11], v24 offset:8192
ds_read_b128 a[12:15], v24 offset:12288
ds_read_b128 a[16:19], v24 offset:16384
ds_read_b128 a[20:23], v24 offset:20480
ds_read_b128 a[24:27], v24 offset:24576
ds_read_b128 a[28:31], v24 offset:28672
ds_read_b128 a[32:35], v24 offset:32768
ds_read_b128 v[128:131], v12 offset:2048
ds_read_b128 v[132:135], v12 offset:3072
ds_read_b128 v[6:9], v12 offset:1024
v_pk_mul_f32 v[216:217], v[216:217], s[50:51]
v_pk_mul_f32 v[218:219], v[218:219], s[52:53]
v_exp_f32 v216, v216
v_exp_f32 v217, v217
v_exp_f32 v218, v218
v_exp_f32 v219, v219
v_pk_add_f32 v[216:217], v[216:217], s[54:55]
v_rcp_f32 v216, v216
v_pk_add_f32 v[218:219], v[218:219], s[54:55]
v_rcp_f32 v217, v217
v_rcp_f32 v218, v218
v_rcp_f32 v219, v219
v_pk_fma_f32 v[216:217], v[216:217], s[56:57], v[28:29]
v_pk_mul_f32 v[216:217], v[216:217], v[218:219]
v_cvt_pk_bf16_f32 v216, v216, v217
v_pk_mul_f32 v[220:221], v[220:221], s[50:51]
v_pk_mul_f32 v[222:223], v[222:223], s[52:53]
v_exp_f32 v220, v220
v_exp_f32 v221, v221
v_exp_f32 v222, v222
v_exp_f32 v223, v223
v_pk_add_f32 v[220:221], v[220:221], s[54:55]
v_rcp_f32 v220, v220
v_pk_add_f32 v[222:223], v[222:223], s[54:55]
v_rcp_f32 v221, v221
v_rcp_f32 v222, v222
v_rcp_f32 v223, v223
v_pk_fma_f32 v[220:221], v[220:221], s[56:57], v[28:29]
v_pk_mul_f32 v[220:221], v[220:221], v[222:223]
v_cvt_pk_bf16_f32 v217, v220, v221
v_pk_mul_f32 v[224:225], v[224:225], s[50:51]
v_pk_mul_f32 v[226:227], v[226:227], s[52:53]
v_exp_f32 v224, v224
v_exp_f32 v225, v225
v_exp_f32 v226, v226
v_exp_f32 v227, v227
v_pk_add_f32 v[224:225], v[224:225], s[54:55]
v_rcp_f32 v224, v224
v_pk_add_f32 v[226:227], v[226:227], s[54:55]
v_rcp_f32 v225, v225
v_rcp_f32 v226, v226
v_rcp_f32 v227, v227
v_pk_fma_f32 v[224:225], v[224:225], s[56:57], v[28:29]
v_pk_mul_f32 v[224:225], v[224:225], v[226:227]
v_cvt_pk_bf16_f32 v218, v224, v225
s_waitcnt lgkmcnt(0)
ds_read_b128 a[36:39], v25 offset:0
ds_read_b128 a[40:43], v25 offset:4096
v_mfma_f32_16x16x32_bf16 v[32:35], a[0:3], v[136:139], 0
ds_read_b128 a[44:47], v25 offset:8192
ds_read_b128 a[48:51], v25 offset:12288
v_add_f32 v232, v232, v6
v_mfma_f32_16x16x32_bf16 v[36:39], a[4:7], v[136:139], 0
ds_read_b128 a[52:55], v25 offset:16384
ds_read_b128 a[56:59], v25 offset:20480
v_add_f32 v233, v233, v7
v_mfma_f32_16x16x32_bf16 v[40:43], a[8:11], v[136:139], 0
ds_read_b128 a[60:63], v25 offset:24576
ds_read_b128 a[64:67], v25 offset:28672
v_add_f32 v234, v234, v8
v_mfma_f32_16x16x32_bf16 v[44:47], a[12:15], v[136:139], 0
ds_read_b128 a[68:71], v25 offset:32768
v_add_f32 v235, v235, v9
v_mul_f32 v228, s50, v228
v_mfma_f32_16x16x32_bf16 v[48:51], a[16:19], v[136:139], 0
ds_read_b128 a[108:111], v27 offset:0
v_mul_f32 v229, s50, v229
v_mul_f32 v230, s52, v230
v_mfma_f32_16x16x32_bf16 v[52:55], a[20:23], v[136:139], 0
ds_read_b128 a[112:115], v27 offset:4096
v_mul_f32 v231, s52, v231
v_mfma_f32_16x16x32_bf16 v[56:59], a[24:27], v[136:139], 0
ds_read_b128 a[116:119], v27 offset:8192
v_exp_f32 v228, v228
v_mfma_f32_16x16x32_bf16 v[60:63], a[28:31], v[136:139], 0
ds_read_b128 a[120:123], v27 offset:12288
v_exp_f32 v229, v229
v_mfma_f32_16x16x32_bf16 v[16:19], a[32:35], v[136:139], 0
ds_read_b128 a[124:127], v27 offset:16384
s_waitcnt lgkmcnt(5)
s_waitcnt vmcnt(2)
v_min3_u32 v10, v99, v103, v115
v_max3_u32 v11, v99, v103, v115
M v[32:35],a[36:39],v[128:131]
ds_read_b128 a[128:131], v27 offset:20480
v_min_u32 v10, v10, v119
v_max_u32 v11, v11, v119
M v[36:39],a[40:43],v[128:131]
ds_read_b128 a[132:135], v27 offset:24576
v_xor_b32 v10, s62, v10
v_xor_b32 v11, s62, v11
M v[40:43],a[44:47],v[128:131]
ds_read_b128 a[136:139], v27 offset:28672
v_or_b32 v10, v10, v11
v_cmp_ne_u32 vcc, 0, v10
M v[44:47],a[48:51],v[128:131]
ds_read_b128 a[140:143], v27 offset:32768
v_exp_f32 v230, v230
M v[48:51],a[52:55],v[128:131]
ds_read_b64 a[144:145], v30 offset:0
s_cmp_lg_u64 vcc, 0
s_cbranch_scc1 L_c0
L_c0_ok:
M v[52:55],a[56:59],v[128:131]
ds_read_b64 a[146:147], v30 offset:512
v_mov_b32 v115, v116
v_mov_b32 v99, v100
M v[56:59],a[60:63],v[128:131]
ds_read_b64 a[148:149], v30 offset:1024
v_mov_b32 v153, v101
M v[60:63],a[64:67],v[128:131]
ds_read_b64 a[150:151], v30 offset:1536
v_exp_f32 v231, v231
M v[16:19],a[68:71],v[128:131]
ds_read_b64 a[152:153], v30 offset:2048
s_waitcnt lgkmcnt(5)
buffer_load_dwordx4 v[120:123], v1, s[16:19], s49 offen offset:2048 sc1
buffer_load_dwordx4 v[124:127], v1, s[16:19], s49 offen offset:3072 sc1
M v[32:35],a[108:111],v[112:115]
ds_read_b64 a[154:155], v30 offset:2560
buffer_load_dwordx4 v[104:107], v1, s[16:19], s48 offen offset:2048 sc1
buffer_load_dwordx4 v[108:111], v1, s[16:19], s48 offen offset:3072 sc1
M v[36:39],a[112:115],v[112:115]
ds_read_b64 a[156:157], v30 offset:3072
v_add_f32 v228, 1.0, v228
v_add_f32 v229, 1.0, v229
M v[40:43],a[116:119],v[112:115]
ds_read_b64 a[158:159], v30 offset:3584
v_add_f32 v230, 1.0, v230
v_add_f32 v231, 1.0, v231
M v[44:47],a[120:123],v[112:115]
ds_read_b64 a[160:161], v30 offset:4096
v_rcp_f32 v228, v228
M v[48:51],a[124:127],v[112:115]
ds_read_b128 a[72:75], v26 offset:0
v_rcp_f32 v229, v229
M v[52:55],a[128:131],v[112:115]
ds_read_b128 a[76:79], v26 offset:4096
v_rcp_f32 v230, v230
M v[56:59],a[132:135],v[112:115]
ds_read_b128 a[80:83], v26 offset:8192
v_rcp_f32 v231, v231
M v[60:63],a[136:139],v[112:115]
ds_read_b128 a[84:87], v26 offset:12288
v_fma_f32 v228, v228, -2.0, 1.0
v_fma_f32 v229, v229, -2.0, 1.0
M v[16:19],a[140:143],v[112:115]
ds_read_b128 a[88:91], v26 offset:16384
s_waitcnt lgkmcnt(5)
v_mul_f32 v228, v228, v230
v_mul_f32 v229, v229, v231
v_mfma_f32_16x16x16_bf16 v[32:35], a[144:145], v[152:153], v[32:35]
ds_read_b128 a[92:95], v26 offset:20480
v_cvt_pk_bf16_f32 v219, v228, v229
v_mul_f32 v232, s50, v232
v_mfma_f32_16x16x16_bf16 v[36:39], a[146:147], v[152:153], v[36:39]
ds_read_b128 a[96:99], v26 offset:24576
v_mul_f32 v233, s50, v233
v_mul_f32 v234, s52, v234
v_mfma_f32_16x16x16_bf16 v[40:43], a[148:149], v[152:153], v[40:43]
ds_read_b128 a[100:103], v26 offset:28672
v_mul_f32 v235, s52, v235
v_mfma_f32_16x16x16_bf16 v[44:47], a[150:151], v[152:153], v[44:47]
ds_read_b128 a[104:107], v26 offset:32768
v_exp_f32 v232, v232
v_mfma_f32_16x16x16_bf16 v[48:51], a[152:153], v[152:153], v[48:51]
v_exp_f32 v233, v233
v_mfma_f32_16x16x16_bf16 v[52:55], a[154:155], v[152:153], v[52:55]
v_exp_f32 v234, v234
v_mfma_f32_16x16x16_bf16 v[56:59], a[156:157], v[152:153], v[56:59]
v_exp_f32 v235, v235
v_add_f32 v232, 1.0, v232
v_mfma_f32_16x16x16_bf16 v[60:63], a[158:159], v[152:153], v[60:63]
v_add_f32 v233, 1.0, v233
v_add_f32 v234, 1.0, v234
v_add_f32 v235, 1.0, v235
v_mfma_f32_16x16x16_bf16 v[16:19], a[160:161], v[152:153], v[16:19]
s_waitcnt lgkmcnt(0)
v_rcp_f32 v232, v232
M v[32:35],a[72:75],v[96:99]
v_rcp_f32 v233, v233
M v[36:39],a[76:79],v[96:99]
v_rcp_f32 v234, v234
M v[40:43],a[80:83],v[96:99]
v_rcp_f32 v235, v235
v_fma_f32 v232, v232, -2.0, 1.0
M v[44:47],a[84:87],v[96:99]
v_fma_f32 v233, v233, -2.0, 1.0
v_mul_f32 v232, v232, v234
v_mul_f32 v233, v233, v235
M v[48:51],a[88:91],v[96:99]
v_cvt_pk_bf16_f32 v232, v232, v233
M v[52:55],a[92:95],v[96:99]
M v[56:59],a[96:99],v[96:99]
M v[60:63],a[100:103],v[96:99]
M v[16:19],a[104:107],v[96:99]
s_waitcnt vmcnt(0)
s_waitcnt vmcnt(4)
v_min3_u32 v10, v107, v111, v123
v_max3_u32 v11, v107, v111, v123
v_min_u32 v10, v10, v127
v_mfma_f32_16x16x32_bf16 v[64:67], a[36:39], v[132:135], 0
v_max_u32 v11, v11, v127
v_xor_b32 v10, s62, v10
v_xor_b32 v11, s62, v11
v_mfma_f32_16x16x32_bf16 v[68:71], a[40:43], v[132:135], 0
v_or_b32 v10, v10, v11
v_cmp_ne_u32 vcc, 0, v10
v_cvt_pk_bf16_f32 v176, v32, v33
v_mfma_f32_16x16x32_bf16 v[72:75], a[44:47], v[132:135], 0
v_cvt_pk_bf16_f32 v177, v34, v35
v_cvt_pk_bf16_f32 v178, v36, v37
v_cvt_pk_bf16_f32 v179, v38, v39
v_mfma_f32_16x16x32_bf16 v[76:79], a[48:51], v[132:135], 0
s_cmp_lg_u64 vcc, 0
s_cbranch_scc1 L_c1
L_c1_ok:
v_mov_b32 v123, v124
v_mfma_f32_16x16x32_bf16 v[80:83], a[52:55], v[132:135], 0
v_mov_b32 v107, v108
v_mov_b32 v233, v109
v_mfma_f32_16x16x32_bf16 v[84:87], a[56:59], v[132:135], 0
ds_write_b128 v14, v[176:179] offset:0
v_mfma_f32_16x16x32_bf16 v[88:91], a[60:63], v[132:135], 0
v_cvt_pk_bf16_f32 v180, v40, v41
v_cvt_pk_bf16_f32 v181, v42, v43
v_cvt_pk_bf16_f32 v182, v44, v45
v_mfma_f32_16x16x32_bf16 v[92:95], a[64:67], v[132:135], 0
v_cvt_pk_bf16_f32 v183, v46, v47
v_mfma_f32_16x16x32_bf16 v[20:23], a[68:71], v[132:135], 0
ds_write_b128 v14, v[180:183] offset:64
M v[64:67],a[108:111],v[120:123]
v_cvt_pk_bf16_f32 v184, v48, v49
v_cvt_pk_bf16_f32 v185, v50, v51
v_cvt_pk_bf16_f32 v186, v52, v53
M v[68:71],a[112:115],v[120:123]
v_cvt_pk_bf16_f32 v187, v54, v55
M v[72:75],a[116:119],v[120:123]
ds_write_b128 v14, v[184:187] offset:128
M v[76:79],a[120:123],v[120:123]
v_cvt_pk_bf16_f32 v188, v56, v57
v_cvt_pk_bf16_f32 v189, v58, v59
v_cvt_pk_bf16_f32 v190, v60, v61
M v[80:83],a[124:127],v[120:123]
v_cvt_pk_bf16_f32 v191, v62, v63
M v[84:87],a[128:131],v[120:123]
ds_write_b128 v14, v[188:191] offset:192
M v[88:91],a[132:135],v[120:123]
v_cvt_pk_bf16_f32 v192, v16, v17
v_cvt_pk_bf16_f32 v193, v18, v19
M v[92:95],a[136:139],v[120:123]
ds_write_b64 v15, v[192:193] offset:256
M v[20:23],a[140:143],v[120:123]
ds_read_b128 v[196:199], v31 offset:0
ds_read_b128 v[200:203], v31 offset:1024
ds_read_b128 v[204:207], v31 offset:2048
M v[64:67],a[0:3],v[216:219]
ds_read_b128 v[208:211], v31 offset:3072
ds_read_b128 v[212:215], v31 offset:4096
M v[68:71],a[4:7],v[216:219]
M v[72:75],a[8:11],v[216:219]
M v[76:79],a[12:15],v[216:219]
M v[80:83],a[16:19],v[216:219]
s_waitcnt lgkmcnt(4)
buffer_store_dwordx4 v[196:199], v160, s[24:27], s8 offen offset:0 nt
M v[84:87],a[20:23],v[216:219]
M v[88:91],a[24:27],v[216:219]
s_waitcnt lgkmcnt(3)
buffer_store_dwordx4 v[200:203], v161, s[24:27], s8 offen offset:1024 nt
M v[92:95],a[28:31],v[216:219]
M v[20:23],a[32:35],v[216:219]
s_waitcnt lgkmcnt(2)
buffer_store_dwordx4 v[204:207], v162, s[24:27], s8 offen offset:2048 nt
v_mfma_f32_16x16x16_bf16 v[64:67], a[144:145], v[232:233], v[64:67]
v_mfma_f32_16x16x16_bf16 v[68:71], a[146:147], v[232:233], v[68:71]
s_waitcnt lgkmcnt(1)
buffer_store_dwordx4 v[208:211], v163, s[24:27], s8 offen offset:3072 nt
v_mfma_f32_16x16x16_bf16 v[72:75], a[148:149], v[232:233], v[72:75]
v_mfma_f32_16x16x16_bf16 v[76:79], a[150:151], v[232:233], v[76:79]
s_waitcnt lgkmcnt(0)
buffer_store_dwordx4 v[212:215], v164, s[24:27], s9 offen offset:0 nt
v_mfma_f32_16x16x16_bf16 v[80:83], a[152:153], v[232:233], v[80:83]
v_mfma_f32_16x16x16_bf16 v[84:87], a[154:155], v[232:233], v[84:87]
v_mfma_f32_16x16x16_bf16 v[88:91], a[156:157], v[232:233], v[88:91]
v_mfma_f32_16x16x16_bf16 v[92:95], a[158:159], v[232:233], v[92:95]
v_mfma_f32_16x16x16_bf16 v[20:23], a[160:161], v[232:233], v[20:23]
M v[64:67],a[72:75],v[104:107]
M v[68:71],a[76:79],v[104:107]
M v[72:75],a[80:83],v[104:107]
M v[76:79],a[84:87],v[104:107]
M v[80:83],a[88:91],v[104:107]
M v[84:87],a[92:95],v[104:107]
M v[88:91],a[96:99],v[104:107]
M v[92:95],a[100:103],v[104:107]
M v[20:23],a[104:107],v[104:107]
v_cvt_pk_bf16_f32 v176, v64, v65
v_cvt_pk_bf16_f32 v177, v66, v67
v_cvt_pk_bf16_f32 v178, v68, v69
v_cvt_pk_bf16_f32 v179, v70, v71
ds_write_b128 v14, v[176:179] offset:4608
v_cvt_pk_bf16_f32 v180, v72, v73
v_cvt_pk_bf16_f32 v181, v74, v75
v_cvt_pk_bf16_f32 v182, v76, v77
v_cvt_pk_bf16_f32 v183, v78, v79
ds_write_b128 v14, v[180:183] offset:4672
v_cvt_pk_bf16_f32 v184, v80, v81
v_cvt_pk_bf16_f32 v185, v82, v83
v_cvt_pk_bf16_f32 v186, v84, v85
v_cvt_pk_bf16_f32 v187, v86, v87
ds_write_b128 v14, v[184:187] offset:4736
v_cvt_pk_bf16_f32 v188, v88, v89
v_cvt_pk_bf16_f32 v189, v90, v91
v_cvt_pk_bf16_f32 v190, v92, v93
v_cvt_pk_bf16_f32 v191, v94, v95
ds_write_b128 v14, v[188:191] offset:4800
v_cvt_pk_bf16_f32 v192, v20, v21
v_cvt_pk_bf16_f32 v193, v22, v23
ds_write_b64 v15, v[192:193] offset:4864
ds_read_b128 v[216:219], v31 offset:4608
ds_read_b128 v[220:223], v31 offset:5632
ds_read_b128 v[224:227], v31 offset:6656
ds_read_b128 v[228:231], v31 offset:7680
ds_read_b128 v[232:235], v31 offset:8704
s_waitcnt lgkmcnt(4)
buffer_store_dwordx4 v[216:219], v160, s[24:27], s63 offen offset:0 nt
s_waitcnt lgkmcnt(3)
buffer_store_dwordx4 v[220:223], v161, s[24:27], s63 offen offset:1024 nt
s_waitcnt lgkmcnt(2)
buffer_store_dwordx4 v[224:227], v162, s[24:27], s63 offen offset:2048 nt
s_waitcnt lgkmcnt(1)
buffer_store_dwordx4 v[228:231], v163, s[24:27], s63 offen offset:3072 nt
s_waitcnt lgkmcnt(0)
buffer_store_dwordx4 v[232:235], v164, s[24:27], s10 offen offset:0 nt
L_end:
s_endpgm
L_sl1:
s_mov_b32 s6, 0x4000
L_sl1_l:
buffer_load_dwordx4 v[20:23], v1, s[16:19], s45 offen sc1
s_waitcnt vmcnt(0)
v_xor_b32 v20, s62, v20
v_xor_b32 v21, s62, v21
v_xor_b32 v22, s62, v22
v_xor_b32 v23, s62, v23
v_or3_b32 v20, v20, v21, v22
v_or_b32 v20, v20, v23
v_cmp_ne_u32 s[4:5], 0, v20
s_nop 1
s_and_b32 s5, s5, 0x7fffffff
s_cmp_eq_u64 s[4:5], 0
s_cbranch_scc1 L_sl1_ret
s_sleep 2
s_sub_u32 s6, s6, 1
s_cmp_lg_u32 s6, 0
s_cbranch_scc1 L_sl1_l
s_branch L_sl1_ret
L_sl2:
s_mov_b32 s6, 0x4000
L_sl2_l:
buffer_load_dwordx4 v[20:23], v1, s[16:19], s46 offen sc1
s_waitcnt vmcnt(0)
v_xor_b32 v20, s62, v20
v_xor_b32 v21, s62, v21
v_xor_b32 v22, s62, v22
v_xor_b32 v23, s62, v23
v_or3_b32 v20, v20, v21, v22
v_or_b32 v20, v20, v23
v_cmp_ne_u32 s[4:5], 0, v20
s_nop 1
s_and_b32 s5, s5, 0x7fffffff
s_cmp_eq_u64 s[4:5], 0
s_cbranch_scc1 L_sl2_ret
s_sleep 2
s_sub_u32 s6, s6, 1
s_cmp_lg_u32 s6, 0
s_cbranch_scc1 L_sl2_l
s_branch L_sl2_ret
L_c0:
s_sub_u32 s36, s36, 1
s_cmp_eq_u32 s36, 0
s_cbranch_scc1 L_c0_ok
buffer_load_dwordx4 v[112:115], v1, s[16:19], s49 offen offset:0 sc1
buffer_load_dwordx4 v[116:119], v1, s[16:19], s49 offen offset:1024 sc1
buffer_load_dwordx4 v[96:99], v1, s[16:19], s48 offen offset:0 sc1
buffer_load_dwordx4 v[100:103], v1, s[16:19], s48 offen offset:1024 sc1
s_waitcnt vmcnt(0)
v_min3_u32 v10, v99, v103, v115
v_max3_u32 v11, v99, v103, v115
v_min_u32 v10, v10, v119
v_max_u32 v11, v11, v119
v_xor_b32 v10, s62, v10
v_xor_b32 v11, s62, v11
v_or_b32 v10, v10, v11
v_cmp_ne_u32 vcc, 0, v10
s_nop 1
s_cmp_lg_u64 vcc, 0
s_cbranch_scc1 L_c0
s_branch L_c0_ok
L_c1:
s_sub_u32 s36, s36, 1
s_cmp_eq_u32 s36, 0
s_cbranch_scc1 L_c1_ok
buffer_load_dwordx4 v[120:123], v1, s[16:19], s49 offen offset:2048 sc1
buffer_load_dwordx4 v[124:127], v1, s[16:19], s49 offen offset:3072 sc1
buffer_load_dwordx4 v[104:107], v1, s[16:19], s48 offen offset:2048 sc1
buffer_load_dwordx4 v[108:111], v1, s[16:19], s48 offen offset:3072 sc1
s_waitcnt vmcnt(0)
v_min3_u32 v10, v107, v111, v123
v_max3_u32 v11, v107, v111, v123
v_min_u32 v10, v10, v127
v_max_u32 v11, v11, v127
v_xor_b32 v10, s62, v10
v_xor_b32 v11, s62, v11
v_or_b32 v10, v10, v11
v_cmp_ne_u32 vcc, 0, v10
s_nop 1
s_cmp_lg_u64 vcc, 0
s_cbranch_scc1 L_c1
s_branch L_c1_ok
L_codeend:
.section .rodata,"a"
.p2align 6
.amdhsa_kernel standalone__autoregressive_conv_wavenet__speech_kernel
  .amdhsa_next_free_vgpr 512
  .amdhsa_next_free_sgpr 102
  .amdhsa_accum_offset 256
  .amdhsa_group_segment_fixed_size 0
  .amdhsa_kernarg_size 48
  .amdhsa_user_sgpr_count 2
  .amdhsa_user_sgpr_kernarg_segment_ptr 1
  .amdhsa_system_sgpr_workgroup_id_x 1
.end_amdhsa_kernel
```
